```python
import torch

def _softmax(x, axis=-1):
    return torch.softmax(x, dim=axis)
def _gelu(x):
    return torch.nn.functional.gelu(x, approximate="tanh")
def _silu(x):
    return torch.nn.functional.silu(x)
def _sigmoid(x):
    return torch.sigmoid(x)
def _layernorm(x, axis=-1, eps=1e-5):
    m = x.mean(dim=axis, keepdim=True)
    v = x.var(dim=axis, keepdim=True, unbiased=False)
    return (x - m) / torch.sqrt(v + eps)
def _scatter_add(tgt, idx, src, axis=0):
    return tgt.clone().index_add_(axis, idx, src)
def _segment_sum(src, seg, n):
    out = torch.zeros((n,) + src.shape[1:], dtype=src.dtype)
    return out.index_add_(0, seg, src)
def _pad(x, pw):
    flat = tuple(v for pair in reversed(pw) for v in pair)
    return torch.nn.functional.pad(x, flat)

kernel_name = 'standalone__gqa_block_cached__near_ridge'

def setup_inputs():

    _w = (lambda a: (lambda t: t.to(torch.bfloat16) if t.is_floating_point() else t)(torch.as_tensor(a)))
    B, Sq, D = 32, 112, 640
    Hq, Hkv, Sk, Dh = 32, 32, 512, 128
    assert Hq % Hkv == 0, (Hq, Hkv)
    return {
        "x": _w((lambda *s: torch.randn(*s, dtype=torch.bfloat16) * 0.8)(B, Sq, D)),
        "k_cache": _w((lambda *s: torch.randn(*s, dtype=torch.bfloat16) * 0.8)(B, Hkv, Sk, Dh)),
        "v_cache": _w((lambda *s: torch.randn(*s, dtype=torch.bfloat16) * 0.05)(B, Hkv, Sk, Dh)),
        "wq": _w((lambda *s: torch.randn(*s, dtype=torch.bfloat16) * 0.8)(D, Hq * Dh) * (D ** -0.5)),
        "wo": _w((lambda *s: torch.randn(*s, dtype=torch.bfloat16) * 0.05)(Hq * Dh, D) * ((Hq * Dh) ** -0.5)),
    }

def reference(x, k_cache, v_cache, wq, wo):
    B, Sq, D = x.shape
    Hq, Dh = 32, 128
    Hkv = k_cache.shape[1]
    rep = Hq // Hkv
    q = (lambda x, *d: x.permute(*d))((x @ wq).reshape(B, Sq, Hq, Dh), 0, 2, 1, 3)
    k = (lambda x, n, axis: torch.repeat_interleave(x, n, dim=axis))(k_cache, rep, axis=1)
    v = (lambda x, n, axis: torch.repeat_interleave(x, n, dim=axis))(v_cache, rep, axis=1)
    scores = torch.einsum("bhqd,bhkd->bhqk", q, k) * (Dh ** -0.5)
    p = _softmax(scores, axis=-1)
    o = torch.einsum("bhqk,bhkd->bhqd", p, v)
    return (lambda x, *d: x.permute(*d))(o, 0, 2, 1, 3).reshape(B, Sq, Hq * Dh) @ wo
```

```asm
; @launch grid=(256,1,1) block=(256,1,1) lds=163840
.amdgcn_target "amdgcn-amd-amdhsa--gfx950"
.text
.globl standalone__gqa_block_cached__near_ridge_kernel
.p2align 8
.type standalone__gqa_block_cached__near_ridge_kernel,@function
standalone__gqa_block_cached__near_ridge_kernel:
    s_cmp_ge_u32 s2, 256
    s_cbranch_scc1 L_end
    s_load_dwordx16 s[80:95], s[0:1], 0
    v_lshrrev_b32 v20, 6, v0
    v_mov_b32 v1, v0
    v_and_b32 v0, 63, v0
    v_readfirstlane_b32 s3, v20
    s_getpc_b64 s[72:73]
    s_and_b32 s72, s72, 0xffffff00
    s_mov_b32 s74, 58432
    s_mov_b32 s75, 0x20000
    s_lshr_b32 s32, s2, 3
    s_lshl_b32 s32, s32, 12
    v_lshlrev_b32 v21, 4, v1
    buffer_load_dwordx4 a[224:227], v21, s[72:75], s32 offen
    s_and_b32 s39, s2, 7
    s_lshr_b32 s40, s2, 3
    s_lshr_b32 s96, s39, 0
    s_lshl_b32 s96, s96, 2
    s_lshr_b32 s32, s40, 3
    s_add_u32 s96, s96, s32
    s_and_b32 s97, s39, 0
    s_lshl_b32 s97, s97, 3
    s_and_b32 s32, s40, 7
    s_add_u32 s97, s97, s32
    s_lshl_b32 s98, s97, 2
    s_add_u32 s98, s98, s3
    s_lshl_b32 s99, s96, 5
    s_add_u32 s99, s99, s98
    v_and_b32 v18, 15, v0
    v_lshrrev_b32 v19, 4, v0
    v_lshlrev_b32 v20, 16, v19
    v_lshl_add_u32 v232, v18, 4, v20
    v_add_u32 v233, 8192, v232
    v_add_u32 v234, 16384, v232
    v_add_u32 v235, 24576, v232
    v_add_u32 v236, 32768, v232
    v_add_u32 v237, 40960, v232
    v_add_u32 v238, 49152, v232
    v_add_u32 v239, 57344, v232
    v_lshrrev_b32 v20, 4, v0
    v_and_b32 v21, 7, v0
    v_xor_b32 v20, v20, v21
    v_lshlrev_b32 v20, 4, v20
    v_lshrrev_b32 v21, 3, v0
    s_lshl_b32 s32, s3, 5
    v_add_u32 v21, s32, v21
    v_mul_u32_u24 v21, 1280, v21
    v_add_u32 v240, v20, v21
    v_xor_b32 v241, 64, v240
    v_add_u32 v241, 10240, v241
    s_lshl_b32 s38, s3, 12
    s_add_u32 s38, s38, 131072
    s_and_b32 s32, s2, 7
    s_mul_i32 s32, s32, 1
    s_mul_i32 s40, s32, 13108
    s_lshr_b32 s40, s40, 16
    s_mul_i32 s40, s40, 5
    s_sub_u32 s32, s32, s40
    s_lshl_b32 s36, s32, 20
    s_lshl_b32 s37, s32, 8
    s_mul_i32 s32, s96, 1
    s_mul_i32 s40, s97, 1
    s_add_u32 s32, s32, s40
    s_and_b32 s62, s32, 3
    s_xor_b32 s40, s62, 0
    s_lshl_b32 s52, s40, 18
    s_xor_b32 s40, s62, 1
    s_lshl_b32 s53, s40, 18
    s_xor_b32 s40, s62, 2
    s_lshl_b32 s54, s40, 18
    s_xor_b32 s40, s62, 3
    s_lshl_b32 s55, s40, 18
    s_lshr_b32 s40, s62, 1
    s_lshl_b32 s56, s40, 7
    s_xor_b32 s57, s56, 128
    s_mul_i32 s40, s96, 143360
    s_lshl_b32 s32, s98, 8
    s_waitcnt lgkmcnt(0)
    s_add_u32 s4, s80, s40
    s_addc_u32 s5, s81, 0
    s_mov_b32 s6, 143360
    s_mov_b32 s7, 0x20000
    s_add_u32 s8, s86, s32
    s_addc_u32 s9, s87, 0
    s_sub_u32 s10, 5242880, s32
    s_mov_b32 s11, 0x20000
    s_add_u32 s60, s36, s52
    s_add_u32 s61, s37, s56
    s_add_u32 m0, s38, 0
    s_nop 0
    buffer_load_dwordx4 v240, s[4:7], s61 offen lds
    s_add_u32 m0, s38, 1024
    s_nop 0
    buffer_load_dwordx4 v241, s[4:7], s61 offen lds
    s_add_u32 m0, s38, 2048
    s_add_u32 s61, s61, 20480
    buffer_load_dwordx4 v240, s[4:7], s61 offen lds
    s_add_u32 m0, s38, 3072
    s_nop 0
    buffer_load_dwordx4 v241, s[4:7], s61 offen lds
    buffer_load_dwordx4 v[24:27], v232, s[8:11], s60 offen
    buffer_load_dwordx4 v[28:31], v233, s[8:11], s60 offen
    buffer_load_dwordx4 v[32:35], v234, s[8:11], s60 offen
    buffer_load_dwordx4 v[36:39], v235, s[8:11], s60 offen
    buffer_load_dwordx4 v[40:43], v236, s[8:11], s60 offen
    buffer_load_dwordx4 v[44:47], v237, s[8:11], s60 offen
    buffer_load_dwordx4 v[48:51], v238, s[8:11], s60 offen
    buffer_load_dwordx4 v[52:55], v239, s[8:11], s60 offen
    s_add_u32 s60, s36, s53
    s_add_u32 s61, s37, s57
    s_add_u32 m0, s38, 16384
    s_nop 0
    buffer_load_dwordx4 v240, s[4:7], s61 offen lds
    s_add_u32 m0, s38, 17408
    s_nop 0
    buffer_load_dwordx4 v241, s[4:7], s61 offen lds
    s_add_u32 m0, s38, 18432
    s_add_u32 s61, s61, 20480
    buffer_load_dwordx4 v240, s[4:7], s61 offen lds
    s_add_u32 m0, s38, 19456
    s_nop 0
    buffer_load_dwordx4 v241, s[4:7], s61 offen lds
    s_add_u32 s37, s37, 256
    s_cmp_ge_u32 s37, 1280
    s_cselect_b32 s37, 0, s37
    buffer_load_dwordx4 v[56:59], v232, s[8:11], s60 offen
    buffer_load_dwordx4 v[60:63], v233, s[8:11], s60 offen
    buffer_load_dwordx4 v[64:67], v234, s[8:11], s60 offen
    buffer_load_dwordx4 v[68:71], v235, s[8:11], s60 offen
    buffer_load_dwordx4 v[72:75], v236, s[8:11], s60 offen
    buffer_load_dwordx4 v[76:79], v237, s[8:11], s60 offen
    buffer_load_dwordx4 v[80:83], v238, s[8:11], s60 offen
    buffer_load_dwordx4 v[84:87], v239, s[8:11], s60 offen
    s_add_u32 s60, s36, s54
    s_lshl_b32 s32, s99, 17
    s_lshr_b32 s40, s99, 15
    s_add_u32 s12, s82, s32
    s_addc_u32 s13, s83, s40
    s_mov_b32 s14, 131072
    s_mov_b32 s15, 0x20000
    s_add_u32 s16, s84, s32
    s_addc_u32 s17, s85, s40
    s_mov_b32 s18, 131072
    s_mov_b32 s19, 0x20000
    s_lshl_b32 s24, s3, 15
    s_add_u32 s25, s24, 4096
    s_add_u32 s26, s24, 8192
    s_add_u32 s27, s24, 12288
    s_add_u32 s28, s24, 16384
    s_add_u32 s29, s24, 20480
    s_add_u32 s30, s24, 24576
    s_add_u32 s31, s24, 28672
    v_add_u32 v20, 0, v19
    v_and_b32 v21, 7, v20
    v_lshlrev_b32 v21, 1, v21
    v_lshrrev_b32 v20, 3, v20
    v_or_b32 v20, v20, v21
    v_xor_b32 v20, v20, v18
    v_lshlrev_b32 v20, 4, v20
    v_lshl_add_u32 v2, v19, 8, v20
    v_add_u32 v20, 4, v19
    v_and_b32 v21, 7, v20
    v_lshlrev_b32 v21, 1, v21
    v_lshrrev_b32 v20, 3, v20
    v_or_b32 v20, v20, v21
    v_xor_b32 v20, v20, v18
    v_lshlrev_b32 v20, 4, v20
    v_lshl_add_u32 v3, v19, 8, v20
    v_add_u32 v20, 8, v19
    v_and_b32 v21, 7, v20
    v_lshlrev_b32 v21, 1, v21
    v_lshrrev_b32 v20, 3, v20
    v_or_b32 v20, v20, v21
    v_xor_b32 v20, v20, v18
    v_lshlrev_b32 v20, 4, v20
    v_lshl_add_u32 v4, v19, 8, v20
    v_add_u32 v20, 12, v19
    v_and_b32 v21, 7, v20
    v_lshlrev_b32 v21, 1, v21
    v_lshrrev_b32 v20, 3, v20
    v_or_b32 v20, v20, v21
    v_xor_b32 v20, v20, v18
    v_lshlrev_b32 v20, 4, v20
    v_lshl_add_u32 v5, v19, 8, v20
    s_add_u32 s68, s94, 50331648
    s_addc_u32 s69, s95, 0
    s_mov_b32 s70, 8192
    s_mov_b32 s71, 0x20000
    s_lshl_b32 s32, s96, 8
    s_lshl_b32 s40, s3, 6
    s_add_u32 s32, s32, s40
    s_lshl_b32 s40, s97, 2
    s_add_u32 s32, s32, s40
    v_mov_b32 v20, 0
    v_mov_b32 v21, s32
    buffer_store_dword v20, v21, s[68:71], 0 offen sc1
    buffer_store_dword v20, v21, s[68:71], 0 offen offset:32 sc1
    s_lshl_b32 s32, s2, 2
    s_add_u32 s32, s32, s3
    s_lshr_b32 s39, s32, 3
    s_and_b32 s40, s32, 7
    s_mul_i32 s32, s39, 40960
    s_mul_i32 s41, s40, 160
    s_add_u32 s32, s32, s41
    s_add_u32 s76, s88, s32
    s_addc_u32 s77, s89, 0
    s_sub_u32 s78, 40960, s41
    s_mov_b32 s79, 0x20000
    s_lshl_b32 s32, s40, 7
    s_add_u32 s32, s32, s39
    s_mul_i32 s32, s32, 5120
    s_add_u32 s32, s32, 41943040
    s_add_u32 s64, s94, s32
    s_addc_u32 s65, s95, 0
    s_mov_b32 s66, 5120
    s_mov_b32 s67, 0x20000
    s_movk_i32 s32, 6554
    v_add_u32 v20, 0, v0
    v_mul_lo_u32 v21, v20, s32
    v_lshrrev_b32 v21, 16, v21
    v_mul_u32_u24 v21, 1120, v21
    v_lshl_add_u32 v244, v20, 4, v21
    v_add_u32 v20, 64, v0
    v_mul_lo_u32 v21, v20, s32
    v_lshrrev_b32 v21, 16, v21
    v_mul_u32_u24 v21, 1120, v21
    v_lshl_add_u32 v245, v20, 4, v21
    v_add_u32 v20, 128, v0
    v_mul_lo_u32 v21, v20, s32
    v_lshrrev_b32 v21, 16, v21
    v_mul_u32_u24 v21, 1120, v21
    v_lshl_add_u32 v246, v20, 4, v21
    v_add_u32 v20, 192, v0
    v_mul_lo_u32 v21, v20, s32
    v_lshrrev_b32 v21, 16, v21
    v_mul_u32_u24 v21, 1120, v21
    v_lshl_add_u32 v247, v20, 4, v21
    v_add_u32 v20, 256, v0
    v_mul_lo_u32 v21, v20, s32
    v_lshrrev_b32 v21, 16, v21
    v_mul_u32_u24 v21, 1120, v21
    v_lshl_add_u32 v248, v20, 4, v21
    v_lshrrev_b32 v20, 2, v0
    v_mul_u32_u24 v20, 160, v20
    v_and_b32 v21, 3, v0
    v_lshl_add_u32 v20, v21, 3, v20
    s_lshl_b32 s63, s3, 13
    s_add_u32 s63, s63, 131072
    v_add_u32 v1, s63, v20
    v_lshrrev_b32 v20, 1, v18
    v_xor_b32 v20, v20, v19
    v_lshlrev_b32 v20, 4, v20
    v_lshl_add_u32 v20, v18, 7, v20
    v_add_u32 v20, 131072, v20
    s_and_b32 s32, s62, 1
    s_lshl_b32 s32, s32, 6
    v_xor_b32 v242, s32, v20
    v_xor_b32 v243, 64, v242
    v_and_b32 v21, 7, v18
    v_lshlrev_b32 v21, 1, v21
    v_lshrrev_b32 v20, 3, v18
    v_or_b32 v20, v20, v21
    v_lshlrev_b32 v21, 2, v19
    v_xor_b32 v20, v20, v21
    v_lshlrev_b32 v20, 4, v20
    v_lshl_add_u32 v20, v18, 8, v20
    v_add_u32 v6, s24, v20
    v_xor_b32 v7, 16, v6
    v_xor_b32 v8, 32, v6
    v_xor_b32 v9, 48, v6
    v_lshrrev_b32 v18, 2, v0
    v_and_b32 v19, 3, v0
    v_and_b32 v21, 7, v18
    v_lshlrev_b32 v21, 1, v21
    v_lshrrev_b32 v20, 3, v18
    v_or_b32 v20, v20, v21
    v_lshrrev_b32 v21, 1, v19
    v_xor_b32 v20, v20, v21
    v_lshlrev_b32 v20, 4, v20
    v_lshl_add_u32 v20, v18, 8, v20
    v_and_b32 v21, 1, v19
    v_lshl_add_u32 v20, v21, 3, v20
    v_add_u32 v10, s24, v20
    v_xor_b32 v11, 32, v10
    v_xor_b32 v12, 64, v10
    v_xor_b32 v13, 96, v10
    v_xor_b32 v14, 128, v10
    v_xor_b32 v15, 160, v10
    v_xor_b32 v16, 192, v10
    v_xor_b32 v17, 224, v10
    v_lshlrev_b32 v254, 4, v0
    v_lshlrev_b32 v250, 7, v0
    s_mov_b32 s33, 0x3e0293ee
    s_mov_b32 s34, 0x05040100
    s_mov_b32 s35, 0x07060302
    s_waitcnt vmcnt(22)
    s_barrier
    ds_read_b128 v[168:171], v242 offset:0
    ds_read_b128 v[172:175], v242 offset:2048
    ds_read_b128 v[176:179], v242 offset:4096
    ds_read_b128 v[180:183], v242 offset:6144
    ds_read_b128 v[184:187], v242 offset:8192
    ds_read_b128 v[188:191], v242 offset:10240
    ds_read_b128 v[192:195], v242 offset:12288
    s_waitcnt vmcnt(14)
    v_perm_b32 v224, v28, v24, s34
    v_perm_b32 v225, v36, v32, s34
    v_perm_b32 v226, v44, v40, s34
    v_perm_b32 v227, v52, v48, s34
    s_waitcnt lgkmcnt(0)
    s_nop 0
    v_mfma_f32_16x16x32_bf16 a[0:3], v[224:227], v[168:171], 0
    v_perm_b32 v228, v28, v24, s35
    v_mfma_f32_16x16x32_bf16 a[4:7], v[224:227], v[172:175], 0
    v_perm_b32 v229, v36, v32, s35
    v_mfma_f32_16x16x32_bf16 a[8:11], v[224:227], v[176:179], 0
    v_perm_b32 v230, v44, v40, s35
    buffer_load_dwordx4 v[88:91], v232, s[8:11], s60 offen
    v_mfma_f32_16x16x32_bf16 a[12:15], v[224:227], v[180:183], 0
    v_perm_b32 v231, v52, v48, s35
    v_mfma_f32_16x16x32_bf16 a[16:19], v[224:227], v[184:187], 0
    v_mfma_f32_16x16x32_bf16 a[20:23], v[224:227], v[188:191], 0
    v_mfma_f32_16x16x32_bf16 a[24:27], v[224:227], v[192:195], 0
    buffer_load_dwordx4 v[92:95], v233, s[8:11], s60 offen
    v_mfma_f32_16x16x32_bf16 a[28:31], v[228:231], v[168:171], 0
    v_perm_b32 v224, v29, v25, s34
    v_mfma_f32_16x16x32_bf16 a[32:35], v[228:231], v[172:175], 0
    v_perm_b32 v225, v37, v33, s34
    v_mfma_f32_16x16x32_bf16 a[36:39], v[228:231], v[176:179], 0
    v_perm_b32 v226, v45, v41, s34
    v_mfma_f32_16x16x32_bf16 a[40:43], v[228:231], v[180:183], 0
    v_perm_b32 v227, v53, v49, s34
    v_mfma_f32_16x16x32_bf16 a[44:47], v[228:231], v[184:187], 0
    buffer_load_dwordx4 v[96:99], v234, s[8:11], s60 offen
    v_mfma_f32_16x16x32_bf16 a[48:51], v[228:231], v[188:191], 0
    v_mfma_f32_16x16x32_bf16 a[52:55], v[228:231], v[192:195], 0
    v_mfma_f32_16x16x32_bf16 a[56:59], v[224:227], v[168:171], 0
    v_perm_b32 v228, v29, v25, s35
    v_mfma_f32_16x16x32_bf16 a[60:63], v[224:227], v[172:175], 0
    v_perm_b32 v229, v37, v33, s35
    v_mfma_f32_16x16x32_bf16 a[64:67], v[224:227], v[176:179], 0
    v_perm_b32 v230, v45, v41, s35
    buffer_load_dwordx4 v[100:103], v235, s[8:11], s60 offen
    v_mfma_f32_16x16x32_bf16 a[68:71], v[224:227], v[180:183], 0
    v_perm_b32 v231, v53, v49, s35
    v_mfma_f32_16x16x32_bf16 a[72:75], v[224:227], v[184:187], 0
    v_mfma_f32_16x16x32_bf16 a[76:79], v[224:227], v[188:191], 0
    v_mfma_f32_16x16x32_bf16 a[80:83], v[224:227], v[192:195], 0
    v_mfma_f32_16x16x32_bf16 a[84:87], v[228:231], v[168:171], 0
    v_perm_b32 v224, v30, v26, s34
    ds_read_b128 v[196:199], v243 offset:0
    v_mfma_f32_16x16x32_bf16 a[88:91], v[228:231], v[172:175], 0
    v_perm_b32 v225, v38, v34, s34
    v_mfma_f32_16x16x32_bf16 a[92:95], v[228:231], v[176:179], 0
    v_perm_b32 v226, v46, v42, s34
    ds_read_b128 v[200:203], v243 offset:2048
    v_mfma_f32_16x16x32_bf16 a[96:99], v[228:231], v[180:183], 0
    v_perm_b32 v227, v54, v50, s34
    ds_read_b128 v[204:207], v243 offset:4096
    v_mfma_f32_16x16x32_bf16 a[100:103], v[228:231], v[184:187], 0
    ds_read_b128 v[208:211], v243 offset:6144
    buffer_load_dwordx4 v[104:107], v236, s[8:11], s60 offen
    v_mfma_f32_16x16x32_bf16 a[104:107], v[228:231], v[188:191], 0
    ds_read_b128 v[212:215], v243 offset:8192
    v_mfma_f32_16x16x32_bf16 a[108:111], v[228:231], v[192:195], 0
    v_mfma_f32_16x16x32_bf16 a[112:115], v[224:227], v[168:171], 0
    v_perm_b32 v228, v30, v26, s35
    ds_read_b128 v[216:219], v243 offset:10240
    v_mfma_f32_16x16x32_bf16 a[116:119], v[224:227], v[172:175], 0
    v_perm_b32 v229, v38, v34, s35
    ds_read_b128 v[220:223], v243 offset:12288
    buffer_load_dwordx4 v[108:111], v237, s[8:11], s60 offen
    v_mfma_f32_16x16x32_bf16 a[120:123], v[224:227], v[176:179], 0
    v_perm_b32 v230, v46, v42, s35
    v_mfma_f32_16x16x32_bf16 a[124:127], v[224:227], v[180:183], 0
    v_perm_b32 v231, v54, v50, s35
    v_mfma_f32_16x16x32_bf16 a[128:131], v[224:227], v[184:187], 0
    v_mfma_f32_16x16x32_bf16 a[132:135], v[224:227], v[188:191], 0
    buffer_load_dwordx4 v[112:115], v238, s[8:11], s60 offen
    v_mfma_f32_16x16x32_bf16 a[136:139], v[224:227], v[192:195], 0
    v_mfma_f32_16x16x32_bf16 a[140:143], v[228:231], v[168:171], 0
    v_perm_b32 v224, v31, v27, s34
    v_mfma_f32_16x16x32_bf16 a[144:147], v[228:231], v[172:175], 0
    v_perm_b32 v225, v39, v35, s34
    v_mfma_f32_16x16x32_bf16 a[148:151], v[228:231], v[176:179], 0
    v_perm_b32 v226, v47, v43, s34
    buffer_load_dwordx4 v[116:119], v239, s[8:11], s60 offen
    v_mfma_f32_16x16x32_bf16 a[152:155], v[228:231], v[180:183], 0
    v_perm_b32 v227, v55, v51, s34
    s_add_u32 s60, s36, s55
    v_mfma_f32_16x16x32_bf16 a[156:159], v[228:231], v[184:187], 0
    v_mfma_f32_16x16x32_bf16 a[160:163], v[228:231], v[188:191], 0
    v_mfma_f32_16x16x32_bf16 a[164:167], v[228:231], v[192:195], 0
    s_mov_b32 m0, s24
    v_mfma_f32_16x16x32_bf16 a[168:171], v[224:227], v[168:171], 0
    v_perm_b32 v228, v31, v27, s35
    s_movk_i32 s42, 0
    buffer_load_dwordx4 v2, s[12:15], s42 offen offset:0 nt lds
    v_mfma_f32_16x16x32_bf16 a[172:175], v[224:227], v[172:175], 0
    v_perm_b32 v229, v39, v35, s35
    v_mfma_f32_16x16x32_bf16 a[176:179], v[224:227], v[176:179], 0
    v_perm_b32 v230, v47, v43, s35
    v_mfma_f32_16x16x32_bf16 a[180:183], v[224:227], v[180:183], 0
    v_perm_b32 v231, v55, v51, s35
    s_mov_b32 m0, s24
    v_mfma_f32_16x16x32_bf16 a[184:187], v[224:227], v[184:187], 0
    buffer_load_dwordx4 v3, s[12:15], s42 offen offset:1024 nt lds
    v_mfma_f32_16x16x32_bf16 a[188:191], v[224:227], v[188:191], 0
    v_mfma_f32_16x16x32_bf16 a[192:195], v[224:227], v[192:195], 0
    v_mfma_f32_16x16x32_bf16 a[196:199], v[228:231], v[168:171], 0
    s_waitcnt vmcnt(12)
    s_mov_b32 m0, s24
    v_mfma_f32_16x16x32_bf16 a[200:203], v[228:231], v[172:175], 0
    v_perm_b32 v224, v60, v56, s34
    buffer_load_dwordx4 v4, s[12:15], s42 offen offset:2048 nt lds
    v_mfma_f32_16x16x32_bf16 a[204:207], v[228:231], v[176:179], 0
    v_perm_b32 v225, v68, v64, s34
    v_mfma_f32_16x16x32_bf16 a[208:211], v[228:231], v[180:183], 0
    v_perm_b32 v226, v76, v72, s34
    v_mfma_f32_16x16x32_bf16 a[212:215], v[228:231], v[184:187], 0
    v_perm_b32 v227, v84, v80, s34
    v_mfma_f32_16x16x32_bf16 a[216:219], v[228:231], v[188:191], 0
    v_mfma_f32_16x16x32_bf16 a[220:223], v[228:231], v[192:195], 0
    s_waitcnt lgkmcnt(0)
    v_mfma_f32_16x16x32_bf16 a[0:3], v[224:227], v[196:199], a[0:3]
    v_perm_b32 v228, v60, v56, s35
    v_mfma_f32_16x16x32_bf16 a[4:7], v[224:227], v[200:203], a[4:7]
    v_perm_b32 v229, v68, v64, s35
    v_mfma_f32_16x16x32_bf16 a[8:11], v[224:227], v[204:207], a[8:11]
    v_perm_b32 v230, v76, v72, s35
    buffer_load_dwordx4 v[24:27], v232, s[8:11], s60 offen
    v_mfma_f32_16x16x32_bf16 a[12:15], v[224:227], v[208:211], a[12:15]
    v_perm_b32 v231, v84, v80, s35
    v_mfma_f32_16x16x32_bf16 a[16:19], v[224:227], v[212:215], a[16:19]
    v_mfma_f32_16x16x32_bf16 a[20:23], v[224:227], v[216:219], a[20:23]
    v_mfma_f32_16x16x32_bf16 a[24:27], v[224:227], v[220:223], a[24:27]
    buffer_load_dwordx4 v[28:31], v233, s[8:11], s60 offen
    v_mfma_f32_16x16x32_bf16 a[28:31], v[228:231], v[196:199], a[28:31]
    v_perm_b32 v224, v61, v57, s34
    v_mfma_f32_16x16x32_bf16 a[32:35], v[228:231], v[200:203], a[32:35]
    v_perm_b32 v225, v69, v65, s34
    v_mfma_f32_16x16x32_bf16 a[36:39], v[228:231], v[204:207], a[36:39]
    v_perm_b32 v226, v77, v73, s34
    v_mfma_f32_16x16x32_bf16 a[40:43], v[228:231], v[208:211], a[40:43]
    v_perm_b32 v227, v85, v81, s34
    v_mfma_f32_16x16x32_bf16 a[44:47], v[228:231], v[212:215], a[44:47]
    buffer_load_dwordx4 v[32:35], v234, s[8:11], s60 offen
    v_mfma_f32_16x16x32_bf16 a[48:51], v[228:231], v[216:219], a[48:51]
    v_mfma_f32_16x16x32_bf16 a[52:55], v[228:231], v[220:223], a[52:55]
    v_mfma_f32_16x16x32_bf16 a[56:59], v[224:227], v[196:199], a[56:59]
    v_perm_b32 v228, v61, v57, s35
    v_mfma_f32_16x16x32_bf16 a[60:63], v[224:227], v[200:203], a[60:63]
    v_perm_b32 v229, v69, v65, s35
    v_mfma_f32_16x16x32_bf16 a[64:67], v[224:227], v[204:207], a[64:67]
    v_perm_b32 v230, v77, v73, s35
    buffer_load_dwordx4 v[36:39], v235, s[8:11], s60 offen
    v_mfma_f32_16x16x32_bf16 a[68:71], v[224:227], v[208:211], a[68:71]
    v_perm_b32 v231, v85, v81, s35
    v_mfma_f32_16x16x32_bf16 a[72:75], v[224:227], v[212:215], a[72:75]
    v_mfma_f32_16x16x32_bf16 a[76:79], v[224:227], v[216:219], a[76:79]
    v_mfma_f32_16x16x32_bf16 a[80:83], v[224:227], v[220:223], a[80:83]
    s_waitcnt vmcnt(25)
    s_barrier
    v_mfma_f32_16x16x32_bf16 a[84:87], v[228:231], v[196:199], a[84:87]
    v_perm_b32 v224, v62, v58, s34
    ds_read_b128 v[168:171], v242 offset:16384
    v_mfma_f32_16x16x32_bf16 a[88:91], v[228:231], v[200:203], a[88:91]
    v_perm_b32 v225, v70, v66, s34
    v_mfma_f32_16x16x32_bf16 a[92:95], v[228:231], v[204:207], a[92:95]
    v_perm_b32 v226, v78, v74, s34
    ds_read_b128 v[172:175], v242 offset:18432
    v_mfma_f32_16x16x32_bf16 a[96:99], v[228:231], v[208:211], a[96:99]
    v_perm_b32 v227, v86, v82, s34
    ds_read_b128 v[176:179], v242 offset:20480
    v_mfma_f32_16x16x32_bf16 a[100:103], v[228:231], v[212:215], a[100:103]
    ds_read_b128 v[180:183], v242 offset:22528
    s_add_u32 s61, s37, s56
    v_mfma_f32_16x16x32_bf16 a[104:107], v[228:231], v[216:219], a[104:107]
    ds_read_b128 v[184:187], v242 offset:24576
    s_add_u32 m0, s38, 0
    s_nop 0
    buffer_load_dwordx4 v240, s[4:7], s61 offen lds
    v_mfma_f32_16x16x32_bf16 a[108:111], v[228:231], v[220:223], a[108:111]
    s_add_u32 m0, s38, 1024
    v_mfma_f32_16x16x32_bf16 a[112:115], v[224:227], v[196:199], a[112:115]
    v_perm_b32 v228, v62, v58, s35
    ds_read_b128 v[188:191], v242 offset:26624
    buffer_load_dwordx4 v241, s[4:7], s61 offen lds
    v_mfma_f32_16x16x32_bf16 a[116:119], v[224:227], v[200:203], a[116:119]
    v_perm_b32 v229, v70, v66, s35
    ds_read_b128 v[192:195], v242 offset:28672
    v_mfma_f32_16x16x32_bf16 a[120:123], v[224:227], v[204:207], a[120:123]
    v_perm_b32 v230, v78, v74, s35
    s_add_u32 m0, s38, 2048
    v_mfma_f32_16x16x32_bf16 a[124:127], v[224:227], v[208:211], a[124:127]
    v_perm_b32 v231, v86, v82, s35
    s_add_u32 s61, s61, 20480
    buffer_load_dwordx4 v240, s[4:7], s61 offen lds
    v_mfma_f32_16x16x32_bf16 a[128:131], v[224:227], v[212:215], a[128:131]
    s_add_u32 m0, s38, 3072
    v_mfma_f32_16x16x32_bf16 a[132:135], v[224:227], v[216:219], a[132:135]
    buffer_load_dwordx4 v241, s[4:7], s61 offen lds
    v_mfma_f32_16x16x32_bf16 a[136:139], v[224:227], v[220:223], a[136:139]
    v_mfma_f32_16x16x32_bf16 a[140:143], v[228:231], v[196:199], a[140:143]
    v_perm_b32 v224, v63, v59, s34
    buffer_load_dwordx4 v[40:43], v236, s[8:11], s60 offen
    v_mfma_f32_16x16x32_bf16 a[144:147], v[228:231], v[200:203], a[144:147]
    v_perm_b32 v225, v71, v67, s34
    v_mfma_f32_16x16x32_bf16 a[148:151], v[228:231], v[204:207], a[148:151]
    v_perm_b32 v226, v79, v75, s34
    buffer_load_dwordx4 v[44:47], v237, s[8:11], s60 offen
    v_mfma_f32_16x16x32_bf16 a[152:155], v[228:231], v[208:211], a[152:155]
    v_perm_b32 v227, v87, v83, s34
    v_mfma_f32_16x16x32_bf16 a[156:159], v[228:231], v[212:215], a[156:159]
    v_mfma_f32_16x16x32_bf16 a[160:163], v[228:231], v[216:219], a[160:163]
    buffer_load_dwordx4 v[48:51], v238, s[8:11], s60 offen
    v_mfma_f32_16x16x32_bf16 a[164:167], v[228:231], v[220:223], a[164:167]
    v_mfma_f32_16x16x32_bf16 a[168:171], v[224:227], v[196:199], a[168:171]
    v_perm_b32 v228, v63, v59, s35
    buffer_load_dwordx4 v[52:55], v239, s[8:11], s60 offen
    v_mfma_f32_16x16x32_bf16 a[172:175], v[224:227], v[200:203], a[172:175]
    v_perm_b32 v229, v71, v67, s35
    s_add_u32 s36, s36, 1048576
    s_cmp_ge_u32 s36, 5242880
    v_mfma_f32_16x16x32_bf16 a[176:179], v[224:227], v[204:207], a[176:179]
    v_perm_b32 v230, v79, v75, s35
    s_cselect_b32 s36, 0, s36
    s_add_u32 s60, s36, s52
    v_mfma_f32_16x16x32_bf16 a[180:183], v[224:227], v[208:211], a[180:183]
    v_perm_b32 v231, v87, v83, s35
    s_mov_b32 m0, s24
    v_mfma_f32_16x16x32_bf16 a[184:187], v[224:227], v[212:215], a[184:187]
    buffer_load_dwordx4 v5, s[12:15], s42 offen offset:3072 nt lds
    v_mfma_f32_16x16x32_bf16 a[188:191], v[224:227], v[216:219], a[188:191]
    s_mov_b32 m0, s25
    v_mfma_f32_16x16x32_bf16 a[192:195], v[224:227], v[220:223], a[192:195]
    s_movk_i32 s42, 4096
    buffer_load_dwordx4 v2, s[12:15], s42 offen offset:0 nt lds
    v_mfma_f32_16x16x32_bf16 a[196:199], v[228:231], v[196:199], a[196:199]
    s_waitcnt vmcnt(17)
    v_mfma_f32_16x16x32_bf16 a[200:203], v[228:231], v[200:203], a[200:203]
    v_perm_b32 v224, v92, v88, s34
    s_mov_b32 m0, s25
    v_mfma_f32_16x16x32_bf16 a[204:207], v[228:231], v[204:207], a[204:207]
    v_perm_b32 v225, v100, v96, s34
    buffer_load_dwordx4 v3, s[12:15], s42 offen offset:1024 nt lds
    v_mfma_f32_16x16x32_bf16 a[208:211], v[228:231], v[208:211], a[208:211]
    v_perm_b32 v226, v108, v104, s34
    v_mfma_f32_16x16x32_bf16 a[212:215], v[228:231], v[212:215], a[212:215]
    v_perm_b32 v227, v116, v112, s34
    v_mfma_f32_16x16x32_bf16 a[216:219], v[228:231], v[216:219], a[216:219]
    v_mfma_f32_16x16x32_bf16 a[220:223], v[228:231], v[220:223], a[220:223]
    s_waitcnt lgkmcnt(0)
    v_mfma_f32_16x16x32_bf16 a[0:3], v[224:227], v[168:171], a[0:3]
    v_perm_b32 v228, v92, v88, s35
    v_mfma_f32_16x16x32_bf16 a[4:7], v[224:227], v[172:175], a[4:7]
    v_perm_b32 v229, v100, v96, s35
    v_mfma_f32_16x16x32_bf16 a[8:11], v[224:227], v[176:179], a[8:11]
    v_perm_b32 v230, v108, v104, s35
    buffer_load_dwordx4 v[56:59], v232, s[8:11], s60 offen
    v_mfma_f32_16x16x32_bf16 a[12:15], v[224:227], v[180:183], a[12:15]
    v_perm_b32 v231, v116, v112, s35
    v_mfma_f32_16x16x32_bf16 a[16:19], v[224:227], v[184:187], a[16:19]
    v_mfma_f32_16x16x32_bf16 a[20:23], v[224:227], v[188:191], a[20:23]
    v_mfma_f32_16x16x32_bf16 a[24:27], v[224:227], v[192:195], a[24:27]
    buffer_load_dwordx4 v[60:63], v233, s[8:11], s60 offen
    v_mfma_f32_16x16x32_bf16 a[28:31], v[228:231], v[168:171], a[28:31]
    v_perm_b32 v224, v93, v89, s34
    v_mfma_f32_16x16x32_bf16 a[32:35], v[228:231], v[172:175], a[32:35]
    v_perm_b32 v225, v101, v97, s34
    v_mfma_f32_16x16x32_bf16 a[36:39], v[228:231], v[176:179], a[36:39]
    v_perm_b32 v226, v109, v105, s34
    v_mfma_f32_16x16x32_bf16 a[40:43], v[228:231], v[180:183], a[40:43]
    v_perm_b32 v227, v117, v113, s34
    v_mfma_f32_16x16x32_bf16 a[44:47], v[228:231], v[184:187], a[44:47]
    buffer_load_dwordx4 v[64:67], v234, s[8:11], s60 offen
    v_mfma_f32_16x16x32_bf16 a[48:51], v[228:231], v[188:191], a[48:51]
    v_mfma_f32_16x16x32_bf16 a[52:55], v[228:231], v[192:195], a[52:55]
    v_mfma_f32_16x16x32_bf16 a[56:59], v[224:227], v[168:171], a[56:59]
    v_perm_b32 v228, v93, v89, s35
    v_mfma_f32_16x16x32_bf16 a[60:63], v[224:227], v[172:175], a[60:63]
    v_perm_b32 v229, v101, v97, s35
    v_mfma_f32_16x16x32_bf16 a[64:67], v[224:227], v[176:179], a[64:67]
    v_perm_b32 v230, v109, v105, s35
    buffer_load_dwordx4 v[68:71], v235, s[8:11], s60 offen
    v_mfma_f32_16x16x32_bf16 a[68:71], v[224:227], v[180:183], a[68:71]
    v_perm_b32 v231, v117, v113, s35
    v_mfma_f32_16x16x32_bf16 a[72:75], v[224:227], v[184:187], a[72:75]
    v_mfma_f32_16x16x32_bf16 a[76:79], v[224:227], v[188:191], a[76:79]
    v_mfma_f32_16x16x32_bf16 a[80:83], v[224:227], v[192:195], a[80:83]
    v_mfma_f32_16x16x32_bf16 a[84:87], v[228:231], v[168:171], a[84:87]
    v_perm_b32 v224, v94, v90, s34
    ds_read_b128 v[196:199], v243 offset:16384
    v_mfma_f32_16x16x32_bf16 a[88:91], v[228:231], v[172:175], a[88:91]
    v_perm_b32 v225, v102, v98, s34
    v_mfma_f32_16x16x32_bf16 a[92:95], v[228:231], v[176:179], a[92:95]
    v_perm_b32 v226, v110, v106, s34
    ds_read_b128 v[200:203], v243 offset:18432
    v_mfma_f32_16x16x32_bf16 a[96:99], v[228:231], v[180:183], a[96:99]
    v_perm_b32 v227, v118, v114, s34
    ds_read_b128 v[204:207], v243 offset:20480
    v_mfma_f32_16x16x32_bf16 a[100:103], v[228:231], v[184:187], a[100:103]
    ds_read_b128 v[208:211], v243 offset:22528
    buffer_load_dwordx4 v[72:75], v236, s[8:11], s60 offen
    v_mfma_f32_16x16x32_bf16 a[104:107], v[228:231], v[188:191], a[104:107]
    ds_read_b128 v[212:215], v243 offset:24576
    v_mfma_f32_16x16x32_bf16 a[108:111], v[228:231], v[192:195], a[108:111]
    v_mfma_f32_16x16x32_bf16 a[112:115], v[224:227], v[168:171], a[112:115]
    v_perm_b32 v228, v94, v90, s35
    ds_read_b128 v[216:219], v243 offset:26624
    v_mfma_f32_16x16x32_bf16 a[116:119], v[224:227], v[172:175], a[116:119]
    v_perm_b32 v229, v102, v98, s35
    ds_read_b128 v[220:223], v243 offset:28672
    buffer_load_dwordx4 v[76:79], v237, s[8:11], s60 offen
    v_mfma_f32_16x16x32_bf16 a[120:123], v[224:227], v[176:179], a[120:123]
    v_perm_b32 v230, v110, v106, s35
    v_mfma_f32_16x16x32_bf16 a[124:127], v[224:227], v[180:183], a[124:127]
    v_perm_b32 v231, v118, v114, s35
    v_mfma_f32_16x16x32_bf16 a[128:131], v[224:227], v[184:187], a[128:131]
    v_mfma_f32_16x16x32_bf16 a[132:135], v[224:227], v[188:191], a[132:135]
    v_mfma_f32_16x16x32_bf16 a[136:139], v[224:227], v[192:195], a[136:139]
    buffer_load_dwordx4 v[80:83], v238, s[8:11], s60 offen
    v_mfma_f32_16x16x32_bf16 a[140:143], v[228:231], v[168:171], a[140:143]
    v_perm_b32 v224, v95, v91, s34
    v_mfma_f32_16x16x32_bf16 a[144:147], v[228:231], v[172:175], a[144:147]
    v_perm_b32 v225, v103, v99, s34
    v_mfma_f32_16x16x32_bf16 a[148:151], v[228:231], v[176:179], a[148:151]
    v_perm_b32 v226, v111, v107, s34
    v_mfma_f32_16x16x32_bf16 a[152:155], v[228:231], v[180:183], a[152:155]
    v_perm_b32 v227, v119, v115, s34
    v_mfma_f32_16x16x32_bf16 a[156:159], v[228:231], v[184:187], a[156:159]
    buffer_load_dwordx4 v[84:87], v239, s[8:11], s60 offen
    v_mfma_f32_16x16x32_bf16 a[160:163], v[228:231], v[188:191], a[160:163]
    s_add_u32 s60, s36, s53
    v_mfma_f32_16x16x32_bf16 a[164:167], v[228:231], v[192:195], a[164:167]
    v_mfma_f32_16x16x32_bf16 a[168:171], v[224:227], v[168:171], a[168:171]
    v_perm_b32 v228, v95, v91, s35
    v_mfma_f32_16x16x32_bf16 a[172:175], v[224:227], v[172:175], a[172:175]
    v_perm_b32 v229, v103, v99, s35
    s_mov_b32 m0, s25
    v_mfma_f32_16x16x32_bf16 a[176:179], v[224:227], v[176:179], a[176:179]
    v_perm_b32 v230, v111, v107, s35
    buffer_load_dwordx4 v4, s[12:15], s42 offen offset:2048 nt lds
    v_mfma_f32_16x16x32_bf16 a[180:183], v[224:227], v[180:183], a[180:183]
    v_perm_b32 v231, v119, v115, s35
    v_mfma_f32_16x16x32_bf16 a[184:187], v[224:227], v[184:187], a[184:187]
    v_mfma_f32_16x16x32_bf16 a[188:191], v[224:227], v[188:191], a[188:191]
    v_mfma_f32_16x16x32_bf16 a[192:195], v[224:227], v[192:195], a[192:195]
    s_mov_b32 m0, s25
    v_mfma_f32_16x16x32_bf16 a[196:199], v[228:231], v[168:171], a[196:199]
    s_waitcnt vmcnt(12)
    buffer_load_dwordx4 v5, s[12:15], s42 offen offset:3072 nt lds
    v_mfma_f32_16x16x32_bf16 a[200:203], v[228:231], v[172:175], a[200:203]
    v_perm_b32 v224, v28, v24, s34
    v_mfma_f32_16x16x32_bf16 a[204:207], v[228:231], v[176:179], a[204:207]
    v_perm_b32 v225, v36, v32, s34
    v_mfma_f32_16x16x32_bf16 a[208:211], v[228:231], v[180:183], a[208:211]
    v_perm_b32 v226, v44, v40, s34
    v_mfma_f32_16x16x32_bf16 a[212:215], v[228:231], v[184:187], a[212:215]
    v_perm_b32 v227, v52, v48, s34
    v_mfma_f32_16x16x32_bf16 a[216:219], v[228:231], v[188:191], a[216:219]
    v_mfma_f32_16x16x32_bf16 a[220:223], v[228:231], v[192:195], a[220:223]
    s_waitcnt lgkmcnt(0)
    v_mfma_f32_16x16x32_bf16 a[0:3], v[224:227], v[196:199], a[0:3]
    v_perm_b32 v228, v28, v24, s35
    v_mfma_f32_16x16x32_bf16 a[4:7], v[224:227], v[200:203], a[4:7]
    v_perm_b32 v229, v36, v32, s35
    v_mfma_f32_16x16x32_bf16 a[8:11], v[224:227], v[204:207], a[8:11]
    v_perm_b32 v230, v44, v40, s35
    buffer_load_dwordx4 v[88:91], v232, s[8:11], s60 offen
    v_mfma_f32_16x16x32_bf16 a[12:15], v[224:227], v[208:211], a[12:15]
    v_perm_b32 v231, v52, v48, s35
    v_mfma_f32_16x16x32_bf16 a[16:19], v[224:227], v[212:215], a[16:19]
    v_mfma_f32_16x16x32_bf16 a[20:23], v[224:227], v[216:219], a[20:23]
    v_mfma_f32_16x16x32_bf16 a[24:27], v[224:227], v[220:223], a[24:27]
    buffer_load_dwordx4 v[92:95], v233, s[8:11], s60 offen
    v_mfma_f32_16x16x32_bf16 a[28:31], v[228:231], v[196:199], a[28:31]
    v_perm_b32 v224, v29, v25, s34
    v_mfma_f32_16x16x32_bf16 a[32:35], v[228:231], v[200:203], a[32:35]
    v_perm_b32 v225, v37, v33, s34
    v_mfma_f32_16x16x32_bf16 a[36:39], v[228:231], v[204:207], a[36:39]
    v_perm_b32 v226, v45, v41, s34
    v_mfma_f32_16x16x32_bf16 a[40:43], v[228:231], v[208:211], a[40:43]
    v_perm_b32 v227, v53, v49, s34
    v_mfma_f32_16x16x32_bf16 a[44:47], v[228:231], v[212:215], a[44:47]
    buffer_load_dwordx4 v[96:99], v234, s[8:11], s60 offen
    v_mfma_f32_16x16x32_bf16 a[48:51], v[228:231], v[216:219], a[48:51]
    v_mfma_f32_16x16x32_bf16 a[52:55], v[228:231], v[220:223], a[52:55]
    v_mfma_f32_16x16x32_bf16 a[56:59], v[224:227], v[196:199], a[56:59]
    v_perm_b32 v228, v29, v25, s35
    v_mfma_f32_16x16x32_bf16 a[60:63], v[224:227], v[200:203], a[60:63]
    v_perm_b32 v229, v37, v33, s35
    v_mfma_f32_16x16x32_bf16 a[64:67], v[224:227], v[204:207], a[64:67]
    v_perm_b32 v230, v45, v41, s35
    buffer_load_dwordx4 v[100:103], v235, s[8:11], s60 offen
    v_mfma_f32_16x16x32_bf16 a[68:71], v[224:227], v[208:211], a[68:71]
    v_perm_b32 v231, v53, v49, s35
    v_mfma_f32_16x16x32_bf16 a[72:75], v[224:227], v[212:215], a[72:75]
    v_mfma_f32_16x16x32_bf16 a[76:79], v[224:227], v[216:219], a[76:79]
    v_mfma_f32_16x16x32_bf16 a[80:83], v[224:227], v[220:223], a[80:83]
    s_waitcnt vmcnt(21)
    s_barrier
    v_mfma_f32_16x16x32_bf16 a[84:87], v[228:231], v[196:199], a[84:87]
    v_perm_b32 v224, v30, v26, s34
    ds_read_b128 v[168:171], v242 offset:0
    v_mfma_f32_16x16x32_bf16 a[88:91], v[228:231], v[200:203], a[88:91]
    v_perm_b32 v225, v38, v34, s34
    v_mfma_f32_16x16x32_bf16 a[92:95], v[228:231], v[204:207], a[92:95]
    v_perm_b32 v226, v46, v42, s34
    ds_read_b128 v[172:175], v242 offset:2048
    v_mfma_f32_16x16x32_bf16 a[96:99], v[228:231], v[208:211], a[96:99]
    v_perm_b32 v227, v54, v50, s34
    ds_read_b128 v[176:179], v242 offset:4096
    v_mfma_f32_16x16x32_bf16 a[100:103], v[228:231], v[212:215], a[100:103]
    ds_read_b128 v[180:183], v242 offset:6144
    s_add_u32 s61, s37, s57
    v_mfma_f32_16x16x32_bf16 a[104:107], v[228:231], v[216:219], a[104:107]
    ds_read_b128 v[184:187], v242 offset:8192
    s_add_u32 m0, s38, 16384
    s_nop 0
    buffer_load_dwordx4 v240, s[4:7], s61 offen lds
    v_mfma_f32_16x16x32_bf16 a[108:111], v[228:231], v[220:223], a[108:111]
    s_add_u32 m0, s38, 17408
    v_mfma_f32_16x16x32_bf16 a[112:115], v[224:227], v[196:199], a[112:115]
    v_perm_b32 v228, v30, v26, s35
    ds_read_b128 v[188:191], v242 offset:10240
    buffer_load_dwordx4 v241, s[4:7], s61 offen lds
    v_mfma_f32_16x16x32_bf16 a[116:119], v[224:227], v[200:203], a[116:119]
    v_perm_b32 v229, v38, v34, s35
    ds_read_b128 v[192:195], v242 offset:12288
    v_mfma_f32_16x16x32_bf16 a[120:123], v[224:227], v[204:207], a[120:123]
    v_perm_b32 v230, v46, v42, s35
    s_add_u32 m0, s38, 18432
    v_mfma_f32_16x16x32_bf16 a[124:127], v[224:227], v[208:211], a[124:127]
    v_perm_b32 v231, v54, v50, s35
    s_add_u32 s61, s61, 20480
    buffer_load_dwordx4 v240, s[4:7], s61 offen lds
    v_mfma_f32_16x16x32_bf16 a[128:131], v[224:227], v[212:215], a[128:131]
    s_add_u32 m0, s38, 19456
    v_mfma_f32_16x16x32_bf16 a[132:135], v[224:227], v[216:219], a[132:135]
    buffer_load_dwordx4 v241, s[4:7], s61 offen lds
    s_add_u32 s37, s37, 256
    v_mfma_f32_16x16x32_bf16 a[136:139], v[224:227], v[220:223], a[136:139]
    s_cmp_ge_u32 s37, 1280
    s_cselect_b32 s37, 0, s37
    v_mfma_f32_16x16x32_bf16 a[140:143], v[228:231], v[196:199], a[140:143]
    v_perm_b32 v224, v31, v27, s34
    buffer_load_dwordx4 v[104:107], v236, s[8:11], s60 offen
    v_mfma_f32_16x16x32_bf16 a[144:147], v[228:231], v[200:203], a[144:147]
    v_perm_b32 v225, v39, v35, s34
    v_mfma_f32_16x16x32_bf16 a[148:151], v[228:231], v[204:207], a[148:151]
    v_perm_b32 v226, v47, v43, s34
    buffer_load_dwordx4 v[108:111], v237, s[8:11], s60 offen
    v_mfma_f32_16x16x32_bf16 a[152:155], v[228:231], v[208:211], a[152:155]
    v_perm_b32 v227, v55, v51, s34
    v_mfma_f32_16x16x32_bf16 a[156:159], v[228:231], v[212:215], a[156:159]
    v_mfma_f32_16x16x32_bf16 a[160:163], v[228:231], v[216:219], a[160:163]
    buffer_load_dwordx4 v[112:115], v238, s[8:11], s60 offen
    v_mfma_f32_16x16x32_bf16 a[164:167], v[228:231], v[220:223], a[164:167]
    v_mfma_f32_16x16x32_bf16 a[168:171], v[224:227], v[196:199], a[168:171]
    v_perm_b32 v228, v31, v27, s35
    buffer_load_dwordx4 v[116:119], v239, s[8:11], s60 offen
    v_mfma_f32_16x16x32_bf16 a[172:175], v[224:227], v[200:203], a[172:175]
    v_perm_b32 v229, v39, v35, s35
    s_add_u32 s60, s36, s54
    v_mfma_f32_16x16x32_bf16 a[176:179], v[224:227], v[204:207], a[176:179]
    v_perm_b32 v230, v47, v43, s35
    v_mfma_f32_16x16x32_bf16 a[180:183], v[224:227], v[208:211], a[180:183]
    v_perm_b32 v231, v55, v51, s35
    s_mov_b32 m0, s26
    v_mfma_f32_16x16x32_bf16 a[184:187], v[224:227], v[212:215], a[184:187]
    s_movk_i32 s42, 0
    buffer_load_dwordx4 v2, s[16:19], s42 offen offset:0 nt lds
    v_mfma_f32_16x16x32_bf16 a[188:191], v[224:227], v[216:219], a[188:191]
    s_mov_b32 m0, s26
    v_mfma_f32_16x16x32_bf16 a[192:195], v[224:227], v[220:223], a[192:195]
    buffer_load_dwordx4 v3, s[16:19], s42 offen offset:1024 nt lds
    v_mfma_f32_16x16x32_bf16 a[196:199], v[228:231], v[196:199], a[196:199]
    s_waitcnt vmcnt(16)
    v_mfma_f32_16x16x32_bf16 a[200:203], v[228:231], v[200:203], a[200:203]
    v_perm_b32 v224, v60, v56, s34
    s_mov_b32 m0, s26
    v_mfma_f32_16x16x32_bf16 a[204:207], v[228:231], v[204:207], a[204:207]
    v_perm_b32 v225, v68, v64, s34
    buffer_load_dwordx4 v4, s[16:19], s42 offen offset:2048 nt lds
    v_mfma_f32_16x16x32_bf16 a[208:211], v[228:231], v[208:211], a[208:211]
    v_perm_b32 v226, v76, v72, s34
    v_mfma_f32_16x16x32_bf16 a[212:215], v[228:231], v[212:215], a[212:215]
    v_perm_b32 v227, v84, v80, s34
    v_mfma_f32_16x16x32_bf16 a[216:219], v[228:231], v[216:219], a[216:219]
    v_mfma_f32_16x16x32_bf16 a[220:223], v[228:231], v[220:223], a[220:223]
    s_waitcnt lgkmcnt(0)
    v_mfma_f32_16x16x32_bf16 a[0:3], v[224:227], v[168:171], a[0:3]
    v_perm_b32 v228, v60, v56, s35
    v_mfma_f32_16x16x32_bf16 a[4:7], v[224:227], v[172:175], a[4:7]
    v_perm_b32 v229, v68, v64, s35
    v_mfma_f32_16x16x32_bf16 a[8:11], v[224:227], v[176:179], a[8:11]
    v_perm_b32 v230, v76, v72, s35
    buffer_load_dwordx4 v[24:27], v232, s[8:11], s60 offen
    v_mfma_f32_16x16x32_bf16 a[12:15], v[224:227], v[180:183], a[12:15]
    v_perm_b32 v231, v84, v80, s35
    v_mfma_f32_16x16x32_bf16 a[16:19], v[224:227], v[184:187], a[16:19]
    v_mfma_f32_16x16x32_bf16 a[20:23], v[224:227], v[188:191], a[20:23]
    v_mfma_f32_16x16x32_bf16 a[24:27], v[224:227], v[192:195], a[24:27]
    buffer_load_dwordx4 v[28:31], v233, s[8:11], s60 offen
    v_mfma_f32_16x16x32_bf16 a[28:31], v[228:231], v[168:171], a[28:31]
    v_perm_b32 v224, v61, v57, s34
    v_mfma_f32_16x16x32_bf16 a[32:35], v[228:231], v[172:175], a[32:35]
    v_perm_b32 v225, v69, v65, s34
    v_mfma_f32_16x16x32_bf16 a[36:39], v[228:231], v[176:179], a[36:39]
    v_perm_b32 v226, v77, v73, s34
    v_mfma_f32_16x16x32_bf16 a[40:43], v[228:231], v[180:183], a[40:43]
    v_perm_b32 v227, v85, v81, s34
    v_mfma_f32_16x16x32_bf16 a[44:47], v[228:231], v[184:187], a[44:47]
    buffer_load_dwordx4 v[32:35], v234, s[8:11], s60 offen
    v_mfma_f32_16x16x32_bf16 a[48:51], v[228:231], v[188:191], a[48:51]
    v_mfma_f32_16x16x32_bf16 a[52:55], v[228:231], v[192:195], a[52:55]
    v_mfma_f32_16x16x32_bf16 a[56:59], v[224:227], v[168:171], a[56:59]
    v_perm_b32 v228, v61, v57, s35
    v_mfma_f32_16x16x32_bf16 a[60:63], v[224:227], v[172:175], a[60:63]
    v_perm_b32 v229, v69, v65, s35
    v_mfma_f32_16x16x32_bf16 a[64:67], v[224:227], v[176:179], a[64:67]
    v_perm_b32 v230, v77, v73, s35
    buffer_load_dwordx4 v[36:39], v235, s[8:11], s60 offen
    v_mfma_f32_16x16x32_bf16 a[68:71], v[224:227], v[180:183], a[68:71]
    v_perm_b32 v231, v85, v81, s35
    v_mfma_f32_16x16x32_bf16 a[72:75], v[224:227], v[184:187], a[72:75]
    v_mfma_f32_16x16x32_bf16 a[76:79], v[224:227], v[188:191], a[76:79]
    v_mfma_f32_16x16x32_bf16 a[80:83], v[224:227], v[192:195], a[80:83]
    v_mfma_f32_16x16x32_bf16 a[84:87], v[228:231], v[168:171], a[84:87]
    v_perm_b32 v224, v62, v58, s34
    ds_read_b128 v[196:199], v243 offset:0
    v_mfma_f32_16x16x32_bf16 a[88:91], v[228:231], v[172:175], a[88:91]
    v_perm_b32 v225, v70, v66, s34
    v_mfma_f32_16x16x32_bf16 a[92:95], v[228:231], v[176:179], a[92:95]
    v_perm_b32 v226, v78, v74, s34
    ds_read_b128 v[200:203], v243 offset:2048
    v_mfma_f32_16x16x32_bf16 a[96:99], v[228:231], v[180:183], a[96:99]
    v_perm_b32 v227, v86, v82, s34
    ds_read_b128 v[204:207], v243 offset:4096
    v_mfma_f32_16x16x32_bf16 a[100:103], v[228:231], v[184:187], a[100:103]
    ds_read_b128 v[208:211], v243 offset:6144
    buffer_load_dwordx4 v[40:43], v236, s[8:11], s60 offen
    v_mfma_f32_16x16x32_bf16 a[104:107], v[228:231], v[188:191], a[104:107]
    ds_read_b128 v[212:215], v243 offset:8192
    v_mfma_f32_16x16x32_bf16 a[108:111], v[228:231], v[192:195], a[108:111]
    v_mfma_f32_16x16x32_bf16 a[112:115], v[224:227], v[168:171], a[112:115]
    v_perm_b32 v228, v62, v58, s35
    ds_read_b128 v[216:219], v243 offset:10240
    v_mfma_f32_16x16x32_bf16 a[116:119], v[224:227], v[172:175], a[116:119]
    v_perm_b32 v229, v70, v66, s35
    ds_read_b128 v[220:223], v243 offset:12288
    buffer_load_dwordx4 v[44:47], v237, s[8:11], s60 offen
    v_mfma_f32_16x16x32_bf16 a[120:123], v[224:227], v[176:179], a[120:123]
    v_perm_b32 v230, v78, v74, s35
    v_mfma_f32_16x16x32_bf16 a[124:127], v[224:227], v[180:183], a[124:127]
    v_perm_b32 v231, v86, v82, s35
    v_mfma_f32_16x16x32_bf16 a[128:131], v[224:227], v[184:187], a[128:131]
    v_mfma_f32_16x16x32_bf16 a[132:135], v[224:227], v[188:191], a[132:135]
    v_mfma_f32_16x16x32_bf16 a[136:139], v[224:227], v[192:195], a[136:139]
    buffer_load_dwordx4 v[48:51], v238, s[8:11], s60 offen
    v_mfma_f32_16x16x32_bf16 a[140:143], v[228:231], v[168:171], a[140:143]
    v_perm_b32 v224, v63, v59, s34
    v_mfma_f32_16x16x32_bf16 a[144:147], v[228:231], v[172:175], a[144:147]
    v_perm_b32 v225, v71, v67, s34
    v_mfma_f32_16x16x32_bf16 a[148:151], v[228:231], v[176:179], a[148:151]
    v_perm_b32 v226, v79, v75, s34
    v_mfma_f32_16x16x32_bf16 a[152:155], v[228:231], v[180:183], a[152:155]
    v_perm_b32 v227, v87, v83, s34
    v_mfma_f32_16x16x32_bf16 a[156:159], v[228:231], v[184:187], a[156:159]
    buffer_load_dwordx4 v[52:55], v239, s[8:11], s60 offen
    v_mfma_f32_16x16x32_bf16 a[160:163], v[228:231], v[188:191], a[160:163]
    s_add_u32 s60, s36, s55
    v_mfma_f32_16x16x32_bf16 a[164:167], v[228:231], v[192:195], a[164:167]
    v_mfma_f32_16x16x32_bf16 a[168:171], v[224:227], v[168:171], a[168:171]
    v_perm_b32 v228, v63, v59, s35
    v_mfma_f32_16x16x32_bf16 a[172:175], v[224:227], v[172:175], a[172:175]
    v_perm_b32 v229, v71, v67, s35
    s_mov_b32 m0, s26
    v_mfma_f32_16x16x32_bf16 a[176:179], v[224:227], v[176:179], a[176:179]
    v_perm_b32 v230, v79, v75, s35
    buffer_load_dwordx4 v5, s[16:19], s42 offen offset:3072 nt lds
    v_mfma_f32_16x16x32_bf16 a[180:183], v[224:227], v[180:183], a[180:183]
    v_perm_b32 v231, v87, v83, s35
    v_mfma_f32_16x16x32_bf16 a[184:187], v[224:227], v[184:187], a[184:187]
    v_mfma_f32_16x16x32_bf16 a[188:191], v[224:227], v[188:191], a[188:191]
    v_mfma_f32_16x16x32_bf16 a[192:195], v[224:227], v[192:195], a[192:195]
    s_mov_b32 m0, s27
    v_mfma_f32_16x16x32_bf16 a[196:199], v[228:231], v[168:171], a[196:199]
    s_waitcnt vmcnt(12)
    s_movk_i32 s42, 4096
    buffer_load_dwordx4 v2, s[16:19], s42 offen offset:0 nt lds
    v_mfma_f32_16x16x32_bf16 a[200:203], v[228:231], v[172:175], a[200:203]
    v_perm_b32 v224, v92, v88, s34
    v_mfma_f32_16x16x32_bf16 a[204:207], v[228:231], v[176:179], a[204:207]
    v_perm_b32 v225, v100, v96, s34
    v_mfma_f32_16x16x32_bf16 a[208:211], v[228:231], v[180:183], a[208:211]
    v_perm_b32 v226, v108, v104, s34
    v_mfma_f32_16x16x32_bf16 a[212:215], v[228:231], v[184:187], a[212:215]
    v_perm_b32 v227, v116, v112, s34
    v_mfma_f32_16x16x32_bf16 a[216:219], v[228:231], v[188:191], a[216:219]
    v_mfma_f32_16x16x32_bf16 a[220:223], v[228:231], v[192:195], a[220:223]
    s_waitcnt lgkmcnt(0)
    v_mfma_f32_16x16x32_bf16 a[0:3], v[224:227], v[196:199], a[0:3]
    v_perm_b32 v228, v92, v88, s35
    v_mfma_f32_16x16x32_bf16 a[4:7], v[224:227], v[200:203], a[4:7]
    v_perm_b32 v229, v100, v96, s35
    v_mfma_f32_16x16x32_bf16 a[8:11], v[224:227], v[204:207], a[8:11]
    v_perm_b32 v230, v108, v104, s35
    buffer_load_dwordx4 v[56:59], v232, s[8:11], s60 offen
    v_mfma_f32_16x16x32_bf16 a[12:15], v[224:227], v[208:211], a[12:15]
    v_perm_b32 v231, v116, v112, s35
    v_mfma_f32_16x16x32_bf16 a[16:19], v[224:227], v[212:215], a[16:19]
    v_mfma_f32_16x16x32_bf16 a[20:23], v[224:227], v[216:219], a[20:23]
    v_mfma_f32_16x16x32_bf16 a[24:27], v[224:227], v[220:223], a[24:27]
    buffer_load_dwordx4 v[60:63], v233, s[8:11], s60 offen
    v_mfma_f32_16x16x32_bf16 a[28:31], v[228:231], v[196:199], a[28:31]
    v_perm_b32 v224, v93, v89, s34
    v_mfma_f32_16x16x32_bf16 a[32:35], v[228:231], v[200:203], a[32:35]
    v_perm_b32 v225, v101, v97, s34
    v_mfma_f32_16x16x32_bf16 a[36:39], v[228:231], v[204:207], a[36:39]
    v_perm_b32 v226, v109, v105, s34
    v_mfma_f32_16x16x32_bf16 a[40:43], v[228:231], v[208:211], a[40:43]
    v_perm_b32 v227, v117, v113, s34
    v_mfma_f32_16x16x32_bf16 a[44:47], v[228:231], v[212:215], a[44:47]
    buffer_load_dwordx4 v[64:67], v234, s[8:11], s60 offen
    v_mfma_f32_16x16x32_bf16 a[48:51], v[228:231], v[216:219], a[48:51]
    v_mfma_f32_16x16x32_bf16 a[52:55], v[228:231], v[220:223], a[52:55]
    v_mfma_f32_16x16x32_bf16 a[56:59], v[224:227], v[196:199], a[56:59]
    v_perm_b32 v228, v93, v89, s35
    v_mfma_f32_16x16x32_bf16 a[60:63], v[224:227], v[200:203], a[60:63]
    v_perm_b32 v229, v101, v97, s35
    v_mfma_f32_16x16x32_bf16 a[64:67], v[224:227], v[204:207], a[64:67]
    v_perm_b32 v230, v109, v105, s35
    buffer_load_dwordx4 v[68:71], v235, s[8:11], s60 offen
    v_mfma_f32_16x16x32_bf16 a[68:71], v[224:227], v[208:211], a[68:71]
    v_perm_b32 v231, v117, v113, s35
    v_mfma_f32_16x16x32_bf16 a[72:75], v[224:227], v[212:215], a[72:75]
    v_mfma_f32_16x16x32_bf16 a[76:79], v[224:227], v[216:219], a[76:79]
    v_mfma_f32_16x16x32_bf16 a[80:83], v[224:227], v[220:223], a[80:83]
    s_waitcnt vmcnt(21)
    s_barrier
    v_mfma_f32_16x16x32_bf16 a[84:87], v[228:231], v[196:199], a[84:87]
    v_perm_b32 v224, v94, v90, s34
    ds_read_b128 v[168:171], v242 offset:16384
    v_mfma_f32_16x16x32_bf16 a[88:91], v[228:231], v[200:203], a[88:91]
    v_perm_b32 v225, v102, v98, s34
    v_mfma_f32_16x16x32_bf16 a[92:95], v[228:231], v[204:207], a[92:95]
    v_perm_b32 v226, v110, v106, s34
    ds_read_b128 v[172:175], v242 offset:18432
    v_mfma_f32_16x16x32_bf16 a[96:99], v[228:231], v[208:211], a[96:99]
    v_perm_b32 v227, v118, v114, s34
    ds_read_b128 v[176:179], v242 offset:20480
    v_mfma_f32_16x16x32_bf16 a[100:103], v[228:231], v[212:215], a[100:103]
    ds_read_b128 v[180:183], v242 offset:22528
    s_add_u32 s61, s37, s56
    v_mfma_f32_16x16x32_bf16 a[104:107], v[228:231], v[216:219], a[104:107]
    ds_read_b128 v[184:187], v242 offset:24576
    s_add_u32 m0, s38, 0
    s_nop 0
    buffer_load_dwordx4 v240, s[4:7], s61 offen lds
    v_mfma_f32_16x16x32_bf16 a[108:111], v[228:231], v[220:223], a[108:111]
    s_add_u32 m0, s38, 1024
    v_mfma_f32_16x16x32_bf16 a[112:115], v[224:227], v[196:199], a[112:115]
    v_perm_b32 v228, v94, v90, s35
    ds_read_b128 v[188:191], v242 offset:26624
    buffer_load_dwordx4 v241, s[4:7], s61 offen lds
    v_mfma_f32_16x16x32_bf16 a[116:119], v[224:227], v[200:203], a[116:119]
    v_perm_b32 v229, v102, v98, s35
    ds_read_b128 v[192:195], v242 offset:28672
    v_mfma_f32_16x16x32_bf16 a[120:123], v[224:227], v[204:207], a[120:123]
    v_perm_b32 v230, v110, v106, s35
    s_add_u32 m0, s38, 2048
    v_mfma_f32_16x16x32_bf16 a[124:127], v[224:227], v[208:211], a[124:127]
    v_perm_b32 v231, v118, v114, s35
    s_add_u32 s61, s61, 20480
    buffer_load_dwordx4 v240, s[4:7], s61 offen lds
    v_mfma_f32_16x16x32_bf16 a[128:131], v[224:227], v[212:215], a[128:131]
    s_add_u32 m0, s38, 3072
    v_mfma_f32_16x16x32_bf16 a[132:135], v[224:227], v[216:219], a[132:135]
    buffer_load_dwordx4 v241, s[4:7], s61 offen lds
    v_mfma_f32_16x16x32_bf16 a[136:139], v[224:227], v[220:223], a[136:139]
    v_mfma_f32_16x16x32_bf16 a[140:143], v[228:231], v[196:199], a[140:143]
    v_perm_b32 v224, v95, v91, s34
    buffer_load_dwordx4 v[72:75], v236, s[8:11], s60 offen
    v_mfma_f32_16x16x32_bf16 a[144:147], v[228:231], v[200:203], a[144:147]
    v_perm_b32 v225, v103, v99, s34
    v_mfma_f32_16x16x32_bf16 a[148:151], v[228:231], v[204:207], a[148:151]
    v_perm_b32 v226, v111, v107, s34
    buffer_load_dwordx4 v[76:79], v237, s[8:11], s60 offen
    v_mfma_f32_16x16x32_bf16 a[152:155], v[228:231], v[208:211], a[152:155]
    v_perm_b32 v227, v119, v115, s34
    v_mfma_f32_16x16x32_bf16 a[156:159], v[228:231], v[212:215], a[156:159]
    v_mfma_f32_16x16x32_bf16 a[160:163], v[228:231], v[216:219], a[160:163]
    buffer_load_dwordx4 v[80:83], v238, s[8:11], s60 offen
    v_mfma_f32_16x16x32_bf16 a[164:167], v[228:231], v[220:223], a[164:167]
    v_mfma_f32_16x16x32_bf16 a[168:171], v[224:227], v[196:199], a[168:171]
    v_perm_b32 v228, v95, v91, s35
    buffer_load_dwordx4 v[84:87], v239, s[8:11], s60 offen
    v_mfma_f32_16x16x32_bf16 a[172:175], v[224:227], v[200:203], a[172:175]
    v_perm_b32 v229, v103, v99, s35
    s_add_u32 s36, s36, 1048576
    s_cmp_ge_u32 s36, 5242880
    v_mfma_f32_16x16x32_bf16 a[176:179], v[224:227], v[204:207], a[176:179]
    v_perm_b32 v230, v111, v107, s35
    s_cselect_b32 s36, 0, s36
    s_add_u32 s60, s36, s52
    v_mfma_f32_16x16x32_bf16 a[180:183], v[224:227], v[208:211], a[180:183]
    v_perm_b32 v231, v119, v115, s35
    s_mov_b32 m0, s27
    v_mfma_f32_16x16x32_bf16 a[184:187], v[224:227], v[212:215], a[184:187]
    buffer_load_dwordx4 v3, s[16:19], s42 offen offset:1024 nt lds
    v_mfma_f32_16x16x32_bf16 a[188:191], v[224:227], v[216:219], a[188:191]
    s_mov_b32 m0, s27
    v_mfma_f32_16x16x32_bf16 a[192:195], v[224:227], v[220:223], a[192:195]
    buffer_load_dwordx4 v4, s[16:19], s42 offen offset:2048 nt lds
    v_mfma_f32_16x16x32_bf16 a[196:199], v[228:231], v[196:199], a[196:199]
    s_waitcnt vmcnt(16)
    v_mfma_f32_16x16x32_bf16 a[200:203], v[228:231], v[200:203], a[200:203]
    v_perm_b32 v224, v28, v24, s34
    s_mov_b32 m0, s27
    v_mfma_f32_16x16x32_bf16 a[204:207], v[228:231], v[204:207], a[204:207]
    v_perm_b32 v225, v36, v32, s34
    buffer_load_dwordx4 v5, s[16:19], s42 offen offset:3072 nt lds
    v_mfma_f32_16x16x32_bf16 a[208:211], v[228:231], v[208:211], a[208:211]
    v_perm_b32 v226, v44, v40, s34
    v_mfma_f32_16x16x32_bf16 a[212:215], v[228:231], v[212:215], a[212:215]
    v_perm_b32 v227, v52, v48, s34
    v_mfma_f32_16x16x32_bf16 a[216:219], v[228:231], v[216:219], a[216:219]
    v_mfma_f32_16x16x32_bf16 a[220:223], v[228:231], v[220:223], a[220:223]
    s_waitcnt lgkmcnt(0)
    v_mfma_f32_16x16x32_bf16 a[0:3], v[224:227], v[168:171], a[0:3]
    v_perm_b32 v228, v28, v24, s35
    v_mfma_f32_16x16x32_bf16 a[4:7], v[224:227], v[172:175], a[4:7]
    v_perm_b32 v229, v36, v32, s35
    v_mfma_f32_16x16x32_bf16 a[8:11], v[224:227], v[176:179], a[8:11]
    v_perm_b32 v230, v44, v40, s35
    buffer_load_dwordx4 v[88:91], v232, s[8:11], s60 offen
    v_mfma_f32_16x16x32_bf16 a[12:15], v[224:227], v[180:183], a[12:15]
    v_perm_b32 v231, v52, v48, s35
    v_mfma_f32_16x16x32_bf16 a[16:19], v[224:227], v[184:187], a[16:19]
    v_mfma_f32_16x16x32_bf16 a[20:23], v[224:227], v[188:191], a[20:23]
    v_mfma_f32_16x16x32_bf16 a[24:27], v[224:227], v[192:195], a[24:27]
    buffer_load_dwordx4 v[92:95], v233, s[8:11], s60 offen
    v_mfma_f32_16x16x32_bf16 a[28:31], v[228:231], v[168:171], a[28:31]
    v_perm_b32 v224, v29, v25, s34
    v_mfma_f32_16x16x32_bf16 a[32:35], v[228:231], v[172:175], a[32:35]
    v_perm_b32 v225, v37, v33, s34
    v_mfma_f32_16x16x32_bf16 a[36:39], v[228:231], v[176:179], a[36:39]
    v_perm_b32 v226, v45, v41, s34
    v_mfma_f32_16x16x32_bf16 a[40:43], v[228:231], v[180:183], a[40:43]
    v_perm_b32 v227, v53, v49, s34
    v_mfma_f32_16x16x32_bf16 a[44:47], v[228:231], v[184:187], a[44:47]
    buffer_load_dwordx4 v[96:99], v234, s[8:11], s60 offen
    v_mfma_f32_16x16x32_bf16 a[48:51], v[228:231], v[188:191], a[48:51]
    v_mfma_f32_16x16x32_bf16 a[52:55], v[228:231], v[192:195], a[52:55]
    v_mfma_f32_16x16x32_bf16 a[56:59], v[224:227], v[168:171], a[56:59]
    v_perm_b32 v228, v29, v25, s35
    v_mfma_f32_16x16x32_bf16 a[60:63], v[224:227], v[172:175], a[60:63]
    v_perm_b32 v229, v37, v33, s35
    v_mfma_f32_16x16x32_bf16 a[64:67], v[224:227], v[176:179], a[64:67]
    v_perm_b32 v230, v45, v41, s35
    buffer_load_dwordx4 v[100:103], v235, s[8:11], s60 offen
    v_mfma_f32_16x16x32_bf16 a[68:71], v[224:227], v[180:183], a[68:71]
    v_perm_b32 v231, v53, v49, s35
    v_mfma_f32_16x16x32_bf16 a[72:75], v[224:227], v[184:187], a[72:75]
    v_mfma_f32_16x16x32_bf16 a[76:79], v[224:227], v[188:191], a[76:79]
    v_mfma_f32_16x16x32_bf16 a[80:83], v[224:227], v[192:195], a[80:83]
    v_mfma_f32_16x16x32_bf16 a[84:87], v[228:231], v[168:171], a[84:87]
    v_perm_b32 v224, v30, v26, s34
    ds_read_b128 v[196:199], v243 offset:16384
    v_mfma_f32_16x16x32_bf16 a[88:91], v[228:231], v[172:175], a[88:91]
    v_perm_b32 v225, v38, v34, s34
    v_mfma_f32_16x16x32_bf16 a[92:95], v[228:231], v[176:179], a[92:95]
    v_perm_b32 v226, v46, v42, s34
    ds_read_b128 v[200:203], v243 offset:18432
    v_mfma_f32_16x16x32_bf16 a[96:99], v[228:231], v[180:183], a[96:99]
    v_perm_b32 v227, v54, v50, s34
    ds_read_b128 v[204:207], v243 offset:20480
    v_mfma_f32_16x16x32_bf16 a[100:103], v[228:231], v[184:187], a[100:103]
    ds_read_b128 v[208:211], v243 offset:22528
    buffer_load_dwordx4 v[104:107], v236, s[8:11], s60 offen
    v_mfma_f32_16x16x32_bf16 a[104:107], v[228:231], v[188:191], a[104:107]
    ds_read_b128 v[212:215], v243 offset:24576
    v_mfma_f32_16x16x32_bf16 a[108:111], v[228:231], v[192:195], a[108:111]
    v_mfma_f32_16x16x32_bf16 a[112:115], v[224:227], v[168:171], a[112:115]
    v_perm_b32 v228, v30, v26, s35
    ds_read_b128 v[216:219], v243 offset:26624
    v_mfma_f32_16x16x32_bf16 a[116:119], v[224:227], v[172:175], a[116:119]
    v_perm_b32 v229, v38, v34, s35
    ds_read_b128 v[220:223], v243 offset:28672
    buffer_load_dwordx4 v[108:111], v237, s[8:11], s60 offen
    v_mfma_f32_16x16x32_bf16 a[120:123], v[224:227], v[176:179], a[120:123]
    v_perm_b32 v230, v46, v42, s35
    v_mfma_f32_16x16x32_bf16 a[124:127], v[224:227], v[180:183], a[124:127]
    v_perm_b32 v231, v54, v50, s35
    v_mfma_f32_16x16x32_bf16 a[128:131], v[224:227], v[184:187], a[128:131]
    v_mfma_f32_16x16x32_bf16 a[132:135], v[224:227], v[188:191], a[132:135]
    v_mfma_f32_16x16x32_bf16 a[136:139], v[224:227], v[192:195], a[136:139]
    buffer_load_dwordx4 v[112:115], v238, s[8:11], s60 offen
    v_mfma_f32_16x16x32_bf16 a[140:143], v[228:231], v[168:171], a[140:143]
    v_perm_b32 v224, v31, v27, s34
    v_mfma_f32_16x16x32_bf16 a[144:147], v[228:231], v[172:175], a[144:147]
    v_perm_b32 v225, v39, v35, s34
    v_mfma_f32_16x16x32_bf16 a[148:151], v[228:231], v[176:179], a[148:151]
    v_perm_b32 v226, v47, v43, s34
    v_mfma_f32_16x16x32_bf16 a[152:155], v[228:231], v[180:183], a[152:155]
    v_perm_b32 v227, v55, v51, s34
    v_mfma_f32_16x16x32_bf16 a[156:159], v[228:231], v[184:187], a[156:159]
    buffer_load_dwordx4 v[116:119], v239, s[8:11], s60 offen
    v_mfma_f32_16x16x32_bf16 a[160:163], v[228:231], v[188:191], a[160:163]
    s_add_u32 s60, s36, s53
    v_mfma_f32_16x16x32_bf16 a[164:167], v[228:231], v[192:195], a[164:167]
    v_mfma_f32_16x16x32_bf16 a[168:171], v[224:227], v[168:171], a[168:171]
    v_perm_b32 v228, v31, v27, s35
    v_mfma_f32_16x16x32_bf16 a[172:175], v[224:227], v[172:175], a[172:175]
    v_perm_b32 v229, v39, v35, s35
    s_mov_b32 m0, s28
    v_mfma_f32_16x16x32_bf16 a[176:179], v[224:227], v[176:179], a[176:179]
    v_perm_b32 v230, v47, v43, s35
    s_movk_i32 s42, 8192
    buffer_load_dwordx4 v2, s[12:15], s42 offen offset:0 nt lds
    v_mfma_f32_16x16x32_bf16 a[180:183], v[224:227], v[180:183], a[180:183]
    v_perm_b32 v231, v55, v51, s35
    v_mfma_f32_16x16x32_bf16 a[184:187], v[224:227], v[184:187], a[184:187]
    v_mfma_f32_16x16x32_bf16 a[188:191], v[224:227], v[188:191], a[188:191]
    v_mfma_f32_16x16x32_bf16 a[192:195], v[224:227], v[192:195], a[192:195]
    s_mov_b32 m0, s28
    v_mfma_f32_16x16x32_bf16 a[196:199], v[228:231], v[168:171], a[196:199]
    s_waitcnt vmcnt(12)
    buffer_load_dwordx4 v3, s[12:15], s42 offen offset:1024 nt lds
    v_mfma_f32_16x16x32_bf16 a[200:203], v[228:231], v[172:175], a[200:203]
    v_perm_b32 v224, v60, v56, s34
    v_mfma_f32_16x16x32_bf16 a[204:207], v[228:231], v[176:179], a[204:207]
    v_perm_b32 v225, v68, v64, s34
    v_mfma_f32_16x16x32_bf16 a[208:211], v[228:231], v[180:183], a[208:211]
    v_perm_b32 v226, v76, v72, s34
    v_mfma_f32_16x16x32_bf16 a[212:215], v[228:231], v[184:187], a[212:215]
    v_perm_b32 v227, v84, v80, s34
    v_mfma_f32_16x16x32_bf16 a[216:219], v[228:231], v[188:191], a[216:219]
    v_mfma_f32_16x16x32_bf16 a[220:223], v[228:231], v[192:195], a[220:223]
    s_waitcnt lgkmcnt(0)
    v_mfma_f32_16x16x32_bf16 a[0:3], v[224:227], v[196:199], a[0:3]
    v_perm_b32 v228, v60, v56, s35
    v_mfma_f32_16x16x32_bf16 a[4:7], v[224:227], v[200:203], a[4:7]
    v_perm_b32 v229, v68, v64, s35
    v_mfma_f32_16x16x32_bf16 a[8:11], v[224:227], v[204:207], a[8:11]
    v_perm_b32 v230, v76, v72, s35
    buffer_load_dwordx4 v[24:27], v232, s[8:11], s60 offen
    v_mfma_f32_16x16x32_bf16 a[12:15], v[224:227], v[208:211], a[12:15]
    v_perm_b32 v231, v84, v80, s35
    v_mfma_f32_16x16x32_bf16 a[16:19], v[224:227], v[212:215], a[16:19]
    v_mfma_f32_16x16x32_bf16 a[20:23], v[224:227], v[216:219], a[20:23]
    v_mfma_f32_16x16x32_bf16 a[24:27], v[224:227], v[220:223], a[24:27]
    buffer_load_dwordx4 v[28:31], v233, s[8:11], s60 offen
    v_mfma_f32_16x16x32_bf16 a[28:31], v[228:231], v[196:199], a[28:31]
    v_perm_b32 v224, v61, v57, s34
    v_mfma_f32_16x16x32_bf16 a[32:35], v[228:231], v[200:203], a[32:35]
    v_perm_b32 v225, v69, v65, s34
    v_mfma_f32_16x16x32_bf16 a[36:39], v[228:231], v[204:207], a[36:39]
    v_perm_b32 v226, v77, v73, s34
    v_mfma_f32_16x16x32_bf16 a[40:43], v[228:231], v[208:211], a[40:43]
    v_perm_b32 v227, v85, v81, s34
    v_mfma_f32_16x16x32_bf16 a[44:47], v[228:231], v[212:215], a[44:47]
    buffer_load_dwordx4 v[32:35], v234, s[8:11], s60 offen
    v_mfma_f32_16x16x32_bf16 a[48:51], v[228:231], v[216:219], a[48:51]
    v_mfma_f32_16x16x32_bf16 a[52:55], v[228:231], v[220:223], a[52:55]
    v_mfma_f32_16x16x32_bf16 a[56:59], v[224:227], v[196:199], a[56:59]
    v_perm_b32 v228, v61, v57, s35
    v_mfma_f32_16x16x32_bf16 a[60:63], v[224:227], v[200:203], a[60:63]
    v_perm_b32 v229, v69, v65, s35
    v_mfma_f32_16x16x32_bf16 a[64:67], v[224:227], v[204:207], a[64:67]
    v_perm_b32 v230, v77, v73, s35
    buffer_load_dwordx4 v[36:39], v235, s[8:11], s60 offen
    v_mfma_f32_16x16x32_bf16 a[68:71], v[224:227], v[208:211], a[68:71]
    v_perm_b32 v231, v85, v81, s35
    v_mfma_f32_16x16x32_bf16 a[72:75], v[224:227], v[212:215], a[72:75]
    v_mfma_f32_16x16x32_bf16 a[76:79], v[224:227], v[216:219], a[76:79]
    v_mfma_f32_16x16x32_bf16 a[80:83], v[224:227], v[220:223], a[80:83]
    s_waitcnt vmcnt(21)
    s_barrier
    v_mfma_f32_16x16x32_bf16 a[84:87], v[228:231], v[196:199], a[84:87]
    v_perm_b32 v224, v62, v58, s34
    ds_read_b128 v[168:171], v242 offset:0
    v_mfma_f32_16x16x32_bf16 a[88:91], v[228:231], v[200:203], a[88:91]
    v_perm_b32 v225, v70, v66, s34
    v_mfma_f32_16x16x32_bf16 a[92:95], v[228:231], v[204:207], a[92:95]
    v_perm_b32 v226, v78, v74, s34
    ds_read_b128 v[172:175], v242 offset:2048
    v_mfma_f32_16x16x32_bf16 a[96:99], v[228:231], v[208:211], a[96:99]
    v_perm_b32 v227, v86, v82, s34
    ds_read_b128 v[176:179], v242 offset:4096
    v_mfma_f32_16x16x32_bf16 a[100:103], v[228:231], v[212:215], a[100:103]
    ds_read_b128 v[180:183], v242 offset:6144
    s_add_u32 s61, s37, s57
    v_mfma_f32_16x16x32_bf16 a[104:107], v[228:231], v[216:219], a[104:107]
    ds_read_b128 v[184:187], v242 offset:8192
    s_add_u32 m0, s38, 16384
    s_nop 0
    buffer_load_dwordx4 v240, s[4:7], s61 offen lds
    v_mfma_f32_16x16x32_bf16 a[108:111], v[228:231], v[220:223], a[108:111]
    s_add_u32 m0, s38, 17408
    v_mfma_f32_16x16x32_bf16 a[112:115], v[224:227], v[196:199], a[112:115]
    v_perm_b32 v228, v62, v58, s35
    ds_read_b128 v[188:191], v242 offset:10240
    buffer_load_dwordx4 v241, s[4:7], s61 offen lds
    v_mfma_f32_16x16x32_bf16 a[116:119], v[224:227], v[200:203], a[116:119]
    v_perm_b32 v229, v70, v66, s35
    ds_read_b128 v[192:195], v242 offset:12288
    v_mfma_f32_16x16x32_bf16 a[120:123], v[224:227], v[204:207], a[120:123]
    v_perm_b32 v230, v78, v74, s35
    s_add_u32 m0, s38, 18432
    v_mfma_f32_16x16x32_bf16 a[124:127], v[224:227], v[208:211], a[124:127]
    v_perm_b32 v231, v86, v82, s35
    s_add_u32 s61, s61, 20480
    buffer_load_dwordx4 v240, s[4:7], s61 offen lds
    v_mfma_f32_16x16x32_bf16 a[128:131], v[224:227], v[212:215], a[128:131]
    s_add_u32 m0, s38, 19456
    v_mfma_f32_16x16x32_bf16 a[132:135], v[224:227], v[216:219], a[132:135]
    buffer_load_dwordx4 v241, s[4:7], s61 offen lds
    s_add_u32 s37, s37, 256
    v_mfma_f32_16x16x32_bf16 a[136:139], v[224:227], v[220:223], a[136:139]
    s_cmp_ge_u32 s37, 1280
    s_cselect_b32 s37, 0, s37
    v_mfma_f32_16x16x32_bf16 a[140:143], v[228:231], v[196:199], a[140:143]
    v_perm_b32 v224, v63, v59, s34
    buffer_load_dwordx4 v[40:43], v236, s[8:11], s60 offen
    v_mfma_f32_16x16x32_bf16 a[144:147], v[228:231], v[200:203], a[144:147]
    v_perm_b32 v225, v71, v67, s34
    v_mfma_f32_16x16x32_bf16 a[148:151], v[228:231], v[204:207], a[148:151]
    v_perm_b32 v226, v79, v75, s34
    buffer_load_dwordx4 v[44:47], v237, s[8:11], s60 offen
    v_mfma_f32_16x16x32_bf16 a[152:155], v[228:231], v[208:211], a[152:155]
    v_perm_b32 v227, v87, v83, s34
    v_mfma_f32_16x16x32_bf16 a[156:159], v[228:231], v[212:215], a[156:159]
    v_mfma_f32_16x16x32_bf16 a[160:163], v[228:231], v[216:219], a[160:163]
    buffer_load_dwordx4 v[48:51], v238, s[8:11], s60 offen
    v_mfma_f32_16x16x32_bf16 a[164:167], v[228:231], v[220:223], a[164:167]
    v_mfma_f32_16x16x32_bf16 a[168:171], v[224:227], v[196:199], a[168:171]
    v_perm_b32 v228, v63, v59, s35
    buffer_load_dwordx4 v[52:55], v239, s[8:11], s60 offen
    v_mfma_f32_16x16x32_bf16 a[172:175], v[224:227], v[200:203], a[172:175]
    v_perm_b32 v229, v71, v67, s35
    s_add_u32 s60, s36, s54
    v_mfma_f32_16x16x32_bf16 a[176:179], v[224:227], v[204:207], a[176:179]
    v_perm_b32 v230, v79, v75, s35
    v_mfma_f32_16x16x32_bf16 a[180:183], v[224:227], v[208:211], a[180:183]
    v_perm_b32 v231, v87, v83, s35
    s_mov_b32 m0, s28
    v_mfma_f32_16x16x32_bf16 a[184:187], v[224:227], v[212:215], a[184:187]
    buffer_load_dwordx4 v4, s[12:15], s42 offen offset:2048 nt lds
    v_mfma_f32_16x16x32_bf16 a[188:191], v[224:227], v[216:219], a[188:191]
    s_mov_b32 m0, s28
    v_mfma_f32_16x16x32_bf16 a[192:195], v[224:227], v[220:223], a[192:195]
    buffer_load_dwordx4 v5, s[12:15], s42 offen offset:3072 nt lds
    v_mfma_f32_16x16x32_bf16 a[196:199], v[228:231], v[196:199], a[196:199]
    s_waitcnt vmcnt(16)
    v_mfma_f32_16x16x32_bf16 a[200:203], v[228:231], v[200:203], a[200:203]
    v_perm_b32 v224, v92, v88, s34
    s_mov_b32 m0, s29
    v_mfma_f32_16x16x32_bf16 a[204:207], v[228:231], v[204:207], a[204:207]
    v_perm_b32 v225, v100, v96, s34
    s_movk_i32 s42, 12288
    buffer_load_dwordx4 v2, s[12:15], s42 offen offset:0 nt lds
    v_mfma_f32_16x16x32_bf16 a[208:211], v[228:231], v[208:211], a[208:211]
    v_perm_b32 v226, v108, v104, s34
    v_mfma_f32_16x16x32_bf16 a[212:215], v[228:231], v[212:215], a[212:215]
    v_perm_b32 v227, v116, v112, s34
    v_mfma_f32_16x16x32_bf16 a[216:219], v[228:231], v[216:219], a[216:219]
    v_mfma_f32_16x16x32_bf16 a[220:223], v[228:231], v[220:223], a[220:223]
    s_waitcnt lgkmcnt(0)
    v_mfma_f32_16x16x32_bf16 a[0:3], v[224:227], v[168:171], a[0:3]
    v_perm_b32 v228, v92, v88, s35
    v_mfma_f32_16x16x32_bf16 a[4:7], v[224:227], v[172:175], a[4:7]
    v_perm_b32 v229, v100, v96, s35
    v_mfma_f32_16x16x32_bf16 a[8:11], v[224:227], v[176:179], a[8:11]
    v_perm_b32 v230, v108, v104, s35
    buffer_load_dwordx4 v[56:59], v232, s[8:11], s60 offen
    v_mfma_f32_16x16x32_bf16 a[12:15], v[224:227], v[180:183], a[12:15]
    v_perm_b32 v231, v116, v112, s35
    v_mfma_f32_16x16x32_bf16 a[16:19], v[224:227], v[184:187], a[16:19]
    v_mfma_f32_16x16x32_bf16 a[20:23], v[224:227], v[188:191], a[20:23]
    v_mfma_f32_16x16x32_bf16 a[24:27], v[224:227], v[192:195], a[24:27]
    buffer_load_dwordx4 v[60:63], v233, s[8:11], s60 offen
    v_mfma_f32_16x16x32_bf16 a[28:31], v[228:231], v[168:171], a[28:31]
    v_perm_b32 v224, v93, v89, s34
    v_mfma_f32_16x16x32_bf16 a[32:35], v[228:231], v[172:175], a[32:35]
    v_perm_b32 v225, v101, v97, s34
    v_mfma_f32_16x16x32_bf16 a[36:39], v[228:231], v[176:179], a[36:39]
    v_perm_b32 v226, v109, v105, s34
    v_mfma_f32_16x16x32_bf16 a[40:43], v[228:231], v[180:183], a[40:43]
    v_perm_b32 v227, v117, v113, s34
    v_mfma_f32_16x16x32_bf16 a[44:47], v[228:231], v[184:187], a[44:47]
    buffer_load_dwordx4 v[64:67], v234, s[8:11], s60 offen
    v_mfma_f32_16x16x32_bf16 a[48:51], v[228:231], v[188:191], a[48:51]
    v_mfma_f32_16x16x32_bf16 a[52:55], v[228:231], v[192:195], a[52:55]
    v_mfma_f32_16x16x32_bf16 a[56:59], v[224:227], v[168:171], a[56:59]
    v_perm_b32 v228, v93, v89, s35
    v_mfma_f32_16x16x32_bf16 a[60:63], v[224:227], v[172:175], a[60:63]
    v_perm_b32 v229, v101, v97, s35
    v_mfma_f32_16x16x32_bf16 a[64:67], v[224:227], v[176:179], a[64:67]
    v_perm_b32 v230, v109, v105, s35
    buffer_load_dwordx4 v[68:71], v235, s[8:11], s60 offen
    v_mfma_f32_16x16x32_bf16 a[68:71], v[224:227], v[180:183], a[68:71]
    v_perm_b32 v231, v117, v113, s35
    v_mfma_f32_16x16x32_bf16 a[72:75], v[224:227], v[184:187], a[72:75]
    v_mfma_f32_16x16x32_bf16 a[76:79], v[224:227], v[188:191], a[76:79]
    v_mfma_f32_16x16x32_bf16 a[80:83], v[224:227], v[192:195], a[80:83]
    v_mfma_f32_16x16x32_bf16 a[84:87], v[228:231], v[168:171], a[84:87]
    v_perm_b32 v224, v94, v90, s34
    ds_read_b128 v[196:199], v243 offset:0
    v_mfma_f32_16x16x32_bf16 a[88:91], v[228:231], v[172:175], a[88:91]
    v_perm_b32 v225, v102, v98, s34
    v_mfma_f32_16x16x32_bf16 a[92:95], v[228:231], v[176:179], a[92:95]
    v_perm_b32 v226, v110, v106, s34
    ds_read_b128 v[200:203], v243 offset:2048
    v_mfma_f32_16x16x32_bf16 a[96:99], v[228:231], v[180:183], a[96:99]
    v_perm_b32 v227, v118, v114, s34
    ds_read_b128 v[204:207], v243 offset:4096
    v_mfma_f32_16x16x32_bf16 a[100:103], v[228:231], v[184:187], a[100:103]
    ds_read_b128 v[208:211], v243 offset:6144
    buffer_load_dwordx4 v[72:75], v236, s[8:11], s60 offen
    v_mfma_f32_16x16x32_bf16 a[104:107], v[228:231], v[188:191], a[104:107]
    ds_read_b128 v[212:215], v243 offset:8192
    v_mfma_f32_16x16x32_bf16 a[108:111], v[228:231], v[192:195], a[108:111]
    v_mfma_f32_16x16x32_bf16 a[112:115], v[224:227], v[168:171], a[112:115]
    v_perm_b32 v228, v94, v90, s35
    ds_read_b128 v[216:219], v243 offset:10240
    v_mfma_f32_16x16x32_bf16 a[116:119], v[224:227], v[172:175], a[116:119]
    v_perm_b32 v229, v102, v98, s35
    ds_read_b128 v[220:223], v243 offset:12288
    buffer_load_dwordx4 v[76:79], v237, s[8:11], s60 offen
    v_mfma_f32_16x16x32_bf16 a[120:123], v[224:227], v[176:179], a[120:123]
    v_perm_b32 v230, v110, v106, s35
    v_mfma_f32_16x16x32_bf16 a[124:127], v[224:227], v[180:183], a[124:127]
    v_perm_b32 v231, v118, v114, s35
    v_mfma_f32_16x16x32_bf16 a[128:131], v[224:227], v[184:187], a[128:131]
    v_mfma_f32_16x16x32_bf16 a[132:135], v[224:227], v[188:191], a[132:135]
    v_mfma_f32_16x16x32_bf16 a[136:139], v[224:227], v[192:195], a[136:139]
    buffer_load_dwordx4 v[80:83], v238, s[8:11], s60 offen
    v_mfma_f32_16x16x32_bf16 a[140:143], v[228:231], v[168:171], a[140:143]
    v_perm_b32 v224, v95, v91, s34
    v_mfma_f32_16x16x32_bf16 a[144:147], v[228:231], v[172:175], a[144:147]
    v_perm_b32 v225, v103, v99, s34
    v_mfma_f32_16x16x32_bf16 a[148:151], v[228:231], v[176:179], a[148:151]
    v_perm_b32 v226, v111, v107, s34
    v_mfma_f32_16x16x32_bf16 a[152:155], v[228:231], v[180:183], a[152:155]
    v_perm_b32 v227, v119, v115, s34
    v_mfma_f32_16x16x32_bf16 a[156:159], v[228:231], v[184:187], a[156:159]
    buffer_load_dwordx4 v[84:87], v239, s[8:11], s60 offen
    v_mfma_f32_16x16x32_bf16 a[160:163], v[228:231], v[188:191], a[160:163]
    s_add_u32 s60, s36, s55
    v_mfma_f32_16x16x32_bf16 a[164:167], v[228:231], v[192:195], a[164:167]
    v_mfma_f32_16x16x32_bf16 a[168:171], v[224:227], v[168:171], a[168:171]
    v_perm_b32 v228, v95, v91, s35
    v_mfma_f32_16x16x32_bf16 a[172:175], v[224:227], v[172:175], a[172:175]
    v_perm_b32 v229, v103, v99, s35
    s_mov_b32 m0, s29
    v_mfma_f32_16x16x32_bf16 a[176:179], v[224:227], v[176:179], a[176:179]
    v_perm_b32 v230, v111, v107, s35
    buffer_load_dwordx4 v3, s[12:15], s42 offen offset:1024 nt lds
    v_mfma_f32_16x16x32_bf16 a[180:183], v[224:227], v[180:183], a[180:183]
    v_perm_b32 v231, v119, v115, s35
    v_mfma_f32_16x16x32_bf16 a[184:187], v[224:227], v[184:187], a[184:187]
    v_mfma_f32_16x16x32_bf16 a[188:191], v[224:227], v[188:191], a[188:191]
    v_mfma_f32_16x16x32_bf16 a[192:195], v[224:227], v[192:195], a[192:195]
    s_mov_b32 m0, s29
    v_mfma_f32_16x16x32_bf16 a[196:199], v[228:231], v[168:171], a[196:199]
    s_waitcnt vmcnt(12)
    buffer_load_dwordx4 v4, s[12:15], s42 offen offset:2048 nt lds
    v_mfma_f32_16x16x32_bf16 a[200:203], v[228:231], v[172:175], a[200:203]
    v_perm_b32 v224, v28, v24, s34
    v_mfma_f32_16x16x32_bf16 a[204:207], v[228:231], v[176:179], a[204:207]
    v_perm_b32 v225, v36, v32, s34
    v_mfma_f32_16x16x32_bf16 a[208:211], v[228:231], v[180:183], a[208:211]
    v_perm_b32 v226, v44, v40, s34
    v_mfma_f32_16x16x32_bf16 a[212:215], v[228:231], v[184:187], a[212:215]
    v_perm_b32 v227, v52, v48, s34
    v_mfma_f32_16x16x32_bf16 a[216:219], v[228:231], v[188:191], a[216:219]
    v_mfma_f32_16x16x32_bf16 a[220:223], v[228:231], v[192:195], a[220:223]
    s_waitcnt lgkmcnt(0)
    v_mfma_f32_16x16x32_bf16 a[0:3], v[224:227], v[196:199], a[0:3]
    v_perm_b32 v228, v28, v24, s35
    v_mfma_f32_16x16x32_bf16 a[4:7], v[224:227], v[200:203], a[4:7]
    v_perm_b32 v229, v36, v32, s35
    v_mfma_f32_16x16x32_bf16 a[8:11], v[224:227], v[204:207], a[8:11]
    v_perm_b32 v230, v44, v40, s35
    buffer_load_dwordx4 v[88:91], v232, s[8:11], s60 offen
    v_mfma_f32_16x16x32_bf16 a[12:15], v[224:227], v[208:211], a[12:15]
    v_perm_b32 v231, v52, v48, s35
    v_mfma_f32_16x16x32_bf16 a[16:19], v[224:227], v[212:215], a[16:19]
    v_mfma_f32_16x16x32_bf16 a[20:23], v[224:227], v[216:219], a[20:23]
    v_mfma_f32_16x16x32_bf16 a[24:27], v[224:227], v[220:223], a[24:27]
    buffer_load_dwordx4 v[92:95], v233, s[8:11], s60 offen
    v_mfma_f32_16x16x32_bf16 a[28:31], v[228:231], v[196:199], a[28:31]
    v_perm_b32 v224, v29, v25, s34
    v_mfma_f32_16x16x32_bf16 a[32:35], v[228:231], v[200:203], a[32:35]
    v_perm_b32 v225, v37, v33, s34
    v_mfma_f32_16x16x32_bf16 a[36:39], v[228:231], v[204:207], a[36:39]
    v_perm_b32 v226, v45, v41, s34
    v_mfma_f32_16x16x32_bf16 a[40:43], v[228:231], v[208:211], a[40:43]
    v_perm_b32 v227, v53, v49, s34
    v_mfma_f32_16x16x32_bf16 a[44:47], v[228:231], v[212:215], a[44:47]
    buffer_load_dwordx4 v[96:99], v234, s[8:11], s60 offen
    v_mfma_f32_16x16x32_bf16 a[48:51], v[228:231], v[216:219], a[48:51]
    v_mfma_f32_16x16x32_bf16 a[52:55], v[228:231], v[220:223], a[52:55]
    v_mfma_f32_16x16x32_bf16 a[56:59], v[224:227], v[196:199], a[56:59]
    v_perm_b32 v228, v29, v25, s35
    v_mfma_f32_16x16x32_bf16 a[60:63], v[224:227], v[200:203], a[60:63]
    v_perm_b32 v229, v37, v33, s35
    v_mfma_f32_16x16x32_bf16 a[64:67], v[224:227], v[204:207], a[64:67]
    v_perm_b32 v230, v45, v41, s35
    buffer_load_dwordx4 v[100:103], v235, s[8:11], s60 offen
    v_mfma_f32_16x16x32_bf16 a[68:71], v[224:227], v[208:211], a[68:71]
    v_perm_b32 v231, v53, v49, s35
    v_mfma_f32_16x16x32_bf16 a[72:75], v[224:227], v[212:215], a[72:75]
    v_mfma_f32_16x16x32_bf16 a[76:79], v[224:227], v[216:219], a[76:79]
    v_mfma_f32_16x16x32_bf16 a[80:83], v[224:227], v[220:223], a[80:83]
    s_waitcnt vmcnt(21)
    s_barrier
    v_mfma_f32_16x16x32_bf16 a[84:87], v[228:231], v[196:199], a[84:87]
    v_perm_b32 v224, v30, v26, s34
    ds_read_b128 v[168:171], v242 offset:16384
    v_mfma_f32_16x16x32_bf16 a[88:91], v[228:231], v[200:203], a[88:91]
    v_perm_b32 v225, v38, v34, s34
    v_mfma_f32_16x16x32_bf16 a[92:95], v[228:231], v[204:207], a[92:95]
    v_perm_b32 v226, v46, v42, s34
    ds_read_b128 v[172:175], v242 offset:18432
    v_mfma_f32_16x16x32_bf16 a[96:99], v[228:231], v[208:211], a[96:99]
    v_perm_b32 v227, v54, v50, s34
    ds_read_b128 v[176:179], v242 offset:20480
    v_mfma_f32_16x16x32_bf16 a[100:103], v[228:231], v[212:215], a[100:103]
    ds_read_b128 v[180:183], v242 offset:22528
    s_add_u32 s61, s37, s56
    v_mfma_f32_16x16x32_bf16 a[104:107], v[228:231], v[216:219], a[104:107]
    ds_read_b128 v[184:187], v242 offset:24576
    s_add_u32 m0, s38, 0
    s_nop 0
    buffer_load_dwordx4 v240, s[4:7], s61 offen lds
    v_mfma_f32_16x16x32_bf16 a[108:111], v[228:231], v[220:223], a[108:111]
    s_add_u32 m0, s38, 1024
    v_mfma_f32_16x16x32_bf16 a[112:115], v[224:227], v[196:199], a[112:115]
    v_perm_b32 v228, v30, v26, s35
    ds_read_b128 v[188:191], v242 offset:26624
    buffer_load_dwordx4 v241, s[4:7], s61 offen lds
    v_mfma_f32_16x16x32_bf16 a[116:119], v[224:227], v[200:203], a[116:119]
    v_perm_b32 v229, v38, v34, s35
    ds_read_b128 v[192:195], v242 offset:28672
    v_mfma_f32_16x16x32_bf16 a[120:123], v[224:227], v[204:207], a[120:123]
    v_perm_b32 v230, v46, v42, s35
    s_add_u32 m0, s38, 2048
    v_mfma_f32_16x16x32_bf16 a[124:127], v[224:227], v[208:211], a[124:127]
    v_perm_b32 v231, v54, v50, s35
    s_add_u32 s61, s61, 20480
    buffer_load_dwordx4 v240, s[4:7], s61 offen lds
    v_mfma_f32_16x16x32_bf16 a[128:131], v[224:227], v[212:215], a[128:131]
    s_add_u32 m0, s38, 3072
    v_mfma_f32_16x16x32_bf16 a[132:135], v[224:227], v[216:219], a[132:135]
    buffer_load_dwordx4 v241, s[4:7], s61 offen lds
    v_mfma_f32_16x16x32_bf16 a[136:139], v[224:227], v[220:223], a[136:139]
    v_mfma_f32_16x16x32_bf16 a[140:143], v[228:231], v[196:199], a[140:143]
    v_perm_b32 v224, v31, v27, s34
    buffer_load_dwordx4 v[104:107], v236, s[8:11], s60 offen
    v_mfma_f32_16x16x32_bf16 a[144:147], v[228:231], v[200:203], a[144:147]
    v_perm_b32 v225, v39, v35, s34
    v_mfma_f32_16x16x32_bf16 a[148:151], v[228:231], v[204:207], a[148:151]
    v_perm_b32 v226, v47, v43, s34
    buffer_load_dwordx4 v[108:111], v237, s[8:11], s60 offen
    v_mfma_f32_16x16x32_bf16 a[152:155], v[228:231], v[208:211], a[152:155]
    v_perm_b32 v227, v55, v51, s34
    v_mfma_f32_16x16x32_bf16 a[156:159], v[228:231], v[212:215], a[156:159]
    v_mfma_f32_16x16x32_bf16 a[160:163], v[228:231], v[216:219], a[160:163]
    buffer_load_dwordx4 v[112:115], v238, s[8:11], s60 offen
    v_mfma_f32_16x16x32_bf16 a[164:167], v[228:231], v[220:223], a[164:167]
    v_mfma_f32_16x16x32_bf16 a[168:171], v[224:227], v[196:199], a[168:171]
    v_perm_b32 v228, v31, v27, s35
    buffer_load_dwordx4 v[116:119], v239, s[8:11], s60 offen
    v_mfma_f32_16x16x32_bf16 a[172:175], v[224:227], v[200:203], a[172:175]
    v_perm_b32 v229, v39, v35, s35
    s_add_u32 s36, s36, 1048576
    s_cmp_ge_u32 s36, 5242880
    v_mfma_f32_16x16x32_bf16 a[176:179], v[224:227], v[204:207], a[176:179]
    v_perm_b32 v230, v47, v43, s35
    s_cselect_b32 s36, 0, s36
    s_add_u32 s60, s36, s52
    v_mfma_f32_16x16x32_bf16 a[180:183], v[224:227], v[208:211], a[180:183]
    v_perm_b32 v231, v55, v51, s35
    s_mov_b32 m0, s29
    v_mfma_f32_16x16x32_bf16 a[184:187], v[224:227], v[212:215], a[184:187]
    buffer_load_dwordx4 v5, s[12:15], s42 offen offset:3072 nt lds
    v_mfma_f32_16x16x32_bf16 a[188:191], v[224:227], v[216:219], a[188:191]
    s_mov_b32 m0, s30
    v_mfma_f32_16x16x32_bf16 a[192:195], v[224:227], v[220:223], a[192:195]
    s_movk_i32 s42, 8192
    buffer_load_dwordx4 v2, s[16:19], s42 offen offset:0 nt lds
    v_mfma_f32_16x16x32_bf16 a[196:199], v[228:231], v[196:199], a[196:199]
    s_waitcnt vmcnt(16)
    v_mfma_f32_16x16x32_bf16 a[200:203], v[228:231], v[200:203], a[200:203]
    v_perm_b32 v224, v60, v56, s34
    s_mov_b32 m0, s30
    v_mfma_f32_16x16x32_bf16 a[204:207], v[228:231], v[204:207], a[204:207]
    v_perm_b32 v225, v68, v64, s34
    buffer_load_dwordx4 v3, s[16:19], s42 offen offset:1024 nt lds
    v_mfma_f32_16x16x32_bf16 a[208:211], v[228:231], v[208:211], a[208:211]
    v_perm_b32 v226, v76, v72, s34
    v_mfma_f32_16x16x32_bf16 a[212:215], v[228:231], v[212:215], a[212:215]
    v_perm_b32 v227, v84, v80, s34
    v_mfma_f32_16x16x32_bf16 a[216:219], v[228:231], v[216:219], a[216:219]
    v_mfma_f32_16x16x32_bf16 a[220:223], v[228:231], v[220:223], a[220:223]
    s_waitcnt lgkmcnt(0)
    v_mfma_f32_16x16x32_bf16 a[0:3], v[224:227], v[168:171], a[0:3]
    v_perm_b32 v228, v60, v56, s35
    v_mfma_f32_16x16x32_bf16 a[4:7], v[224:227], v[172:175], a[4:7]
    v_perm_b32 v229, v68, v64, s35
    s_waitcnt vmcnt(50)
    v_mfma_f32_16x16x32_bf16 a[8:11], v[224:227], v[176:179], a[8:11]
    v_perm_b32 v230, v76, v72, s35
    ds_read_b128 a[224:227], v6 offset:0
    buffer_load_dwordx4 v[24:27], v232, s[8:11], s60 offen
    v_mfma_f32_16x16x32_bf16 a[12:15], v[224:227], v[180:183], a[12:15]
    v_perm_b32 v231, v84, v80, s35
    ds_read_b128 a[228:231], v7 offset:0
    v_mfma_f32_16x16x32_bf16 a[16:19], v[224:227], v[184:187], a[16:19]
    v_mfma_f32_16x16x32_bf16 a[20:23], v[224:227], v[188:191], a[20:23]
    ds_read_b128 a[232:235], v8 offset:0
    v_mfma_f32_16x16x32_bf16 a[24:27], v[224:227], v[192:195], a[24:27]
    ds_read_b128 a[236:239], v9 offset:0
    buffer_load_dwordx4 v[28:31], v233, s[8:11], s60 offen
    v_mfma_f32_16x16x32_bf16 a[28:31], v[228:231], v[168:171], a[28:31]
    v_perm_b32 v224, v61, v57, s34
    v_mfma_f32_16x16x32_bf16 a[32:35], v[228:231], v[172:175], a[32:35]
    v_perm_b32 v225, v69, v65, s34
    ds_read_b128 a[240:243], v6 offset:4096
    v_mfma_f32_16x16x32_bf16 a[36:39], v[228:231], v[176:179], a[36:39]
    v_perm_b32 v226, v77, v73, s34
    ds_read_b128 a[244:247], v7 offset:4096
    v_mfma_f32_16x16x32_bf16 a[40:43], v[228:231], v[180:183], a[40:43]
    v_perm_b32 v227, v85, v81, s34
    v_mfma_f32_16x16x32_bf16 a[44:47], v[228:231], v[184:187], a[44:47]
    ds_read_b128 a[248:251], v8 offset:4096
    buffer_load_dwordx4 v[32:35], v234, s[8:11], s60 offen
    v_mfma_f32_16x16x32_bf16 a[48:51], v[228:231], v[188:191], a[48:51]
    ds_read_b128 a[252:255], v9 offset:4096
    v_mfma_f32_16x16x32_bf16 a[52:55], v[228:231], v[192:195], a[52:55]
    v_mfma_f32_16x16x32_bf16 a[56:59], v[224:227], v[168:171], a[56:59]
    v_perm_b32 v228, v61, v57, s35
    ds_read_b64_tr_b16 v[136:137], v10 offset:8192
    v_mfma_f32_16x16x32_bf16 a[60:63], v[224:227], v[172:175], a[60:63]
    v_perm_b32 v229, v69, v65, s35
    ds_read_b64_tr_b16 v[138:139], v10 offset:12288
    v_mfma_f32_16x16x32_bf16 a[64:67], v[224:227], v[176:179], a[64:67]
    v_perm_b32 v230, v77, v73, s35
    buffer_load_dwordx4 v[36:39], v235, s[8:11], s60 offen
    v_mfma_f32_16x16x32_bf16 a[68:71], v[224:227], v[180:183], a[68:71]
    v_perm_b32 v231, v85, v81, s35
    ds_read_b64_tr_b16 v[140:141], v11 offset:8192
    v_mfma_f32_16x16x32_bf16 a[72:75], v[224:227], v[184:187], a[72:75]
    ds_read_b64_tr_b16 v[142:143], v11 offset:12288
    v_mfma_f32_16x16x32_bf16 a[76:79], v[224:227], v[188:191], a[76:79]
    v_mfma_f32_16x16x32_bf16 a[80:83], v[224:227], v[192:195], a[80:83]
    v_mfma_f32_16x16x32_bf16 a[84:87], v[228:231], v[168:171], a[84:87]
    v_perm_b32 v224, v62, v58, s34
    ds_read_b128 v[196:199], v243 offset:16384
    v_mfma_f32_16x16x32_bf16 a[88:91], v[228:231], v[172:175], a[88:91]
    v_perm_b32 v225, v70, v66, s34
    v_mfma_f32_16x16x32_bf16 a[92:95], v[228:231], v[176:179], a[92:95]
    v_perm_b32 v226, v78, v74, s34
    ds_read_b128 v[200:203], v243 offset:18432
    v_mfma_f32_16x16x32_bf16 a[96:99], v[228:231], v[180:183], a[96:99]
    v_perm_b32 v227, v86, v82, s34
    ds_read_b128 v[204:207], v243 offset:20480
    v_mfma_f32_16x16x32_bf16 a[100:103], v[228:231], v[184:187], a[100:103]
    ds_read_b128 v[208:211], v243 offset:22528
    buffer_load_dwordx4 v[40:43], v236, s[8:11], s60 offen
    v_mfma_f32_16x16x32_bf16 a[104:107], v[228:231], v[188:191], a[104:107]
    ds_read_b128 v[212:215], v243 offset:24576
    v_mfma_f32_16x16x32_bf16 a[108:111], v[228:231], v[192:195], a[108:111]
    v_mfma_f32_16x16x32_bf16 a[112:115], v[224:227], v[168:171], a[112:115]
    v_perm_b32 v228, v62, v58, s35
    ds_read_b128 v[216:219], v243 offset:26624
    v_mfma_f32_16x16x32_bf16 a[116:119], v[224:227], v[172:175], a[116:119]
    v_perm_b32 v229, v70, v66, s35
    ds_read_b128 v[220:223], v243 offset:28672
    buffer_load_dwordx4 v[44:47], v237, s[8:11], s60 offen
    v_mfma_f32_16x16x32_bf16 a[120:123], v[224:227], v[176:179], a[120:123]
    v_perm_b32 v230, v78, v74, s35
    v_mfma_f32_16x16x32_bf16 a[124:127], v[224:227], v[180:183], a[124:127]
    v_perm_b32 v231, v86, v82, s35
    v_mfma_f32_16x16x32_bf16 a[128:131], v[224:227], v[184:187], a[128:131]
    ds_read_b64_tr_b16 v[144:145], v12 offset:8192
    v_mfma_f32_16x16x32_bf16 a[132:135], v[224:227], v[188:191], a[132:135]
    ds_read_b64_tr_b16 v[146:147], v12 offset:12288
    v_mfma_f32_16x16x32_bf16 a[136:139], v[224:227], v[192:195], a[136:139]
    buffer_load_dwordx4 v[48:51], v238, s[8:11], s60 offen
    v_mfma_f32_16x16x32_bf16 a[140:143], v[228:231], v[168:171], a[140:143]
    v_perm_b32 v224, v63, v59, s34
    ds_read_b64_tr_b16 v[148:149], v13 offset:8192
    v_mfma_f32_16x16x32_bf16 a[144:147], v[228:231], v[172:175], a[144:147]
    v_perm_b32 v225, v71, v67, s34
    v_mfma_f32_16x16x32_bf16 a[148:151], v[228:231], v[176:179], a[148:151]
    v_perm_b32 v226, v79, v75, s34
    ds_read_b64_tr_b16 v[150:151], v13 offset:12288
    v_mfma_f32_16x16x32_bf16 a[152:155], v[228:231], v[180:183], a[152:155]
    v_perm_b32 v227, v87, v83, s34
    v_mfma_f32_16x16x32_bf16 a[156:159], v[228:231], v[184:187], a[156:159]
    ds_read_b64_tr_b16 v[152:153], v14 offset:8192
    buffer_load_dwordx4 v[52:55], v239, s[8:11], s60 offen
    v_mfma_f32_16x16x32_bf16 a[160:163], v[228:231], v[188:191], a[160:163]
    s_add_u32 s60, s36, s53
    v_mfma_f32_16x16x32_bf16 a[164:167], v[228:231], v[192:195], a[164:167]
    ds_read_b64_tr_b16 v[154:155], v14 offset:12288
    v_mfma_f32_16x16x32_bf16 a[168:171], v[224:227], v[168:171], a[168:171]
    v_perm_b32 v228, v63, v59, s35
    v_mfma_f32_16x16x32_bf16 a[172:175], v[224:227], v[172:175], a[172:175]
    v_perm_b32 v229, v71, v67, s35
    ds_read_b64_tr_b16 v[156:157], v15 offset:8192
    s_mov_b32 m0, s30
    v_mfma_f32_16x16x32_bf16 a[176:179], v[224:227], v[176:179], a[176:179]
    v_perm_b32 v230, v79, v75, s35
    ds_read_b64_tr_b16 v[158:159], v15 offset:12288
    buffer_load_dwordx4 v4, s[16:19], s42 offen offset:2048 nt lds
    v_mfma_f32_16x16x32_bf16 a[180:183], v[224:227], v[180:183], a[180:183]
    v_perm_b32 v231, v87, v83, s35
    v_mfma_f32_16x16x32_bf16 a[184:187], v[224:227], v[184:187], a[184:187]
    ds_read_b64_tr_b16 v[160:161], v16 offset:8192
    v_mfma_f32_16x16x32_bf16 a[188:191], v[224:227], v[188:191], a[188:191]
    v_mfma_f32_16x16x32_bf16 a[192:195], v[224:227], v[192:195], a[192:195]
    ds_read_b64_tr_b16 v[162:163], v16 offset:12288
    s_mov_b32 m0, s30
    v_mfma_f32_16x16x32_bf16 a[196:199], v[228:231], v[168:171], a[196:199]
    s_waitcnt vmcnt(12)
    buffer_load_dwordx4 v5, s[16:19], s42 offen offset:3072 nt lds
    v_mfma_f32_16x16x32_bf16 a[200:203], v[228:231], v[172:175], a[200:203]
    v_perm_b32 v224, v92, v88, s34
    ds_read_b64_tr_b16 v[164:165], v17 offset:8192
    v_mfma_f32_16x16x32_bf16 a[204:207], v[228:231], v[176:179], a[204:207]
    v_perm_b32 v225, v100, v96, s34
    v_mfma_f32_16x16x32_bf16 a[208:211], v[228:231], v[180:183], a[208:211]
    v_perm_b32 v226, v108, v104, s34
    ds_read_b64_tr_b16 v[166:167], v17 offset:12288
    v_mfma_f32_16x16x32_bf16 a[212:215], v[228:231], v[184:187], a[212:215]
    v_perm_b32 v227, v116, v112, s34
    v_mfma_f32_16x16x32_bf16 a[216:219], v[228:231], v[188:191], a[216:219]
    v_mfma_f32_16x16x32_bf16 a[220:223], v[228:231], v[192:195], a[220:223]
    s_waitcnt lgkmcnt(0)
    v_mfma_f32_16x16x32_bf16 a[0:3], v[224:227], v[196:199], a[0:3]
    v_perm_b32 v228, v92, v88, s35
    v_mfma_f32_16x16x32_bf16 a[4:7], v[224:227], v[200:203], a[4:7]
    v_perm_b32 v229, v100, v96, s35
    v_mfma_f32_16x16x32_bf16 a[8:11], v[224:227], v[204:207], a[8:11]
    v_perm_b32 v230, v108, v104, s35
    buffer_load_dwordx4 v[56:59], v232, s[8:11], s60 offen
    v_mfma_f32_16x16x32_bf16 a[12:15], v[224:227], v[208:211], a[12:15]
    v_perm_b32 v231, v116, v112, s35
    v_mfma_f32_16x16x32_bf16 a[16:19], v[224:227], v[212:215], a[16:19]
    v_mfma_f32_16x16x32_bf16 a[20:23], v[224:227], v[216:219], a[20:23]
    v_mfma_f32_16x16x32_bf16 a[24:27], v[224:227], v[220:223], a[24:27]
    buffer_load_dwordx4 v[60:63], v233, s[8:11], s60 offen
    v_mfma_f32_16x16x32_bf16 a[28:31], v[228:231], v[196:199], a[28:31]
    v_perm_b32 v224, v93, v89, s34
    v_mfma_f32_16x16x32_bf16 a[32:35], v[228:231], v[200:203], a[32:35]
    v_perm_b32 v225, v101, v97, s34
    v_mfma_f32_16x16x32_bf16 a[36:39], v[228:231], v[204:207], a[36:39]
    v_perm_b32 v226, v109, v105, s34
    v_mfma_f32_16x16x32_bf16 a[40:43], v[228:231], v[208:211], a[40:43]
    v_perm_b32 v227, v117, v113, s34
    v_mfma_f32_16x16x32_bf16 a[44:47], v[228:231], v[212:215], a[44:47]
    buffer_load_dwordx4 v[64:67], v234, s[8:11], s60 offen
    v_mfma_f32_16x16x32_bf16 a[48:51], v[228:231], v[216:219], a[48:51]
    v_mfma_f32_16x16x32_bf16 a[52:55], v[228:231], v[220:223], a[52:55]
    v_mfma_f32_16x16x32_bf16 a[56:59], v[224:227], v[196:199], a[56:59]
    v_perm_b32 v228, v93, v89, s35
    v_mfma_f32_16x16x32_bf16 a[60:63], v[224:227], v[200:203], a[60:63]
    v_perm_b32 v229, v101, v97, s35
    v_mfma_f32_16x16x32_bf16 a[64:67], v[224:227], v[204:207], a[64:67]
    v_perm_b32 v230, v109, v105, s35
    buffer_load_dwordx4 v[68:71], v235, s[8:11], s60 offen
    v_mfma_f32_16x16x32_bf16 a[68:71], v[224:227], v[208:211], a[68:71]
    v_perm_b32 v231, v117, v113, s35
    v_mfma_f32_16x16x32_bf16 a[72:75], v[224:227], v[212:215], a[72:75]
    v_mfma_f32_16x16x32_bf16 a[76:79], v[224:227], v[216:219], a[76:79]
    v_mfma_f32_16x16x32_bf16 a[80:83], v[224:227], v[220:223], a[80:83]
    s_waitcnt vmcnt(21)
    s_barrier
    v_mfma_f32_16x16x32_bf16 a[84:87], v[228:231], v[196:199], a[84:87]
    v_perm_b32 v224, v94, v90, s34
    ds_read_b128 v[168:171], v242 offset:0
    v_mfma_f32_16x16x32_bf16 a[88:91], v[228:231], v[200:203], a[88:91]
    v_perm_b32 v225, v102, v98, s34
    v_mfma_f32_16x16x32_bf16 a[92:95], v[228:231], v[204:207], a[92:95]
    v_perm_b32 v226, v110, v106, s34
    ds_read_b128 v[172:175], v242 offset:2048
    v_mfma_f32_16x16x32_bf16 a[96:99], v[228:231], v[208:211], a[96:99]
    v_perm_b32 v227, v118, v114, s34
    ds_read_b128 v[176:179], v242 offset:4096
    v_mfma_f32_16x16x32_bf16 a[100:103], v[228:231], v[212:215], a[100:103]
    ds_read_b128 v[180:183], v242 offset:6144
    s_add_u32 s61, s37, s57
    v_mfma_f32_16x16x32_bf16 a[104:107], v[228:231], v[216:219], a[104:107]
    ds_read_b128 v[184:187], v242 offset:8192
    s_add_u32 m0, s38, 16384
    s_nop 0
    buffer_load_dwordx4 v240, s[4:7], s61 offen lds
    v_mfma_f32_16x16x32_bf16 a[108:111], v[228:231], v[220:223], a[108:111]
    s_add_u32 m0, s38, 17408
    v_mfma_f32_16x16x32_bf16 a[112:115], v[224:227], v[196:199], a[112:115]
    v_perm_b32 v228, v94, v90, s35
    ds_read_b128 v[188:191], v242 offset:10240
    buffer_load_dwordx4 v241, s[4:7], s61 offen lds
    v_mfma_f32_16x16x32_bf16 a[116:119], v[224:227], v[200:203], a[116:119]
    v_perm_b32 v229, v102, v98, s35
    ds_read_b128 v[192:195], v242 offset:12288
    v_mfma_f32_16x16x32_bf16 a[120:123], v[224:227], v[204:207], a[120:123]
    v_perm_b32 v230, v110, v106, s35
    s_add_u32 m0, s38, 18432
    v_mfma_f32_16x16x32_bf16 a[124:127], v[224:227], v[208:211], a[124:127]
    v_perm_b32 v231, v118, v114, s35
    s_add_u32 s61, s61, 20480
    buffer_load_dwordx4 v240, s[4:7], s61 offen lds
    v_mfma_f32_16x16x32_bf16 a[128:131], v[224:227], v[212:215], a[128:131]
    s_add_u32 m0, s38, 19456
    v_mfma_f32_16x16x32_bf16 a[132:135], v[224:227], v[216:219], a[132:135]
    buffer_load_dwordx4 v241, s[4:7], s61 offen lds
    s_add_u32 s37, s37, 256
    v_mfma_f32_16x16x32_bf16 a[136:139], v[224:227], v[220:223], a[136:139]
    s_cmp_ge_u32 s37, 1280
    s_cselect_b32 s37, 0, s37
    v_mfma_f32_16x16x32_bf16 a[140:143], v[228:231], v[196:199], a[140:143]
    v_perm_b32 v224, v95, v91, s34
    buffer_load_dwordx4 v[72:75], v236, s[8:11], s60 offen
    v_mfma_f32_16x16x32_bf16 a[144:147], v[228:231], v[200:203], a[144:147]
    v_perm_b32 v225, v103, v99, s34
    v_mfma_f32_16x16x32_bf16 a[148:151], v[228:231], v[204:207], a[148:151]
    v_perm_b32 v226, v111, v107, s34
    buffer_load_dwordx4 v[76:79], v237, s[8:11], s60 offen
    v_mfma_f32_16x16x32_bf16 a[152:155], v[228:231], v[208:211], a[152:155]
    v_perm_b32 v227, v119, v115, s34
    v_mfma_f32_16x16x32_bf16 a[156:159], v[228:231], v[212:215], a[156:159]
    v_mfma_f32_16x16x32_bf16 a[160:163], v[228:231], v[216:219], a[160:163]
    buffer_load_dwordx4 v[80:83], v238, s[8:11], s60 offen
    v_mfma_f32_16x16x32_bf16 a[164:167], v[228:231], v[220:223], a[164:167]
    v_mfma_f32_16x16x32_bf16 a[168:171], v[224:227], v[196:199], a[168:171]
    v_perm_b32 v228, v95, v91, s35
    buffer_load_dwordx4 v[84:87], v239, s[8:11], s60 offen
    v_mfma_f32_16x16x32_bf16 a[172:175], v[224:227], v[200:203], a[172:175]
    v_perm_b32 v229, v103, v99, s35
    s_add_u32 s60, s36, s54
    v_mfma_f32_16x16x32_bf16 a[176:179], v[224:227], v[204:207], a[176:179]
    v_perm_b32 v230, v111, v107, s35
    v_mfma_f32_16x16x32_bf16 a[180:183], v[224:227], v[208:211], a[180:183]
    v_perm_b32 v231, v119, v115, s35
    s_mov_b32 m0, s31
    v_mfma_f32_16x16x32_bf16 a[184:187], v[224:227], v[212:215], a[184:187]
    s_movk_i32 s42, 12288
    buffer_load_dwordx4 v2, s[16:19], s42 offen offset:0 nt lds
    v_mfma_f32_16x16x32_bf16 a[188:191], v[224:227], v[216:219], a[188:191]
    s_mov_b32 m0, s31
    v_mfma_f32_16x16x32_bf16 a[192:195], v[224:227], v[220:223], a[192:195]
    buffer_load_dwordx4 v3, s[16:19], s42 offen offset:1024 nt lds
    v_mfma_f32_16x16x32_bf16 a[196:199], v[228:231], v[196:199], a[196:199]
    s_waitcnt vmcnt(16)
    v_mfma_f32_16x16x32_bf16 a[200:203], v[228:231], v[200:203], a[200:203]
    v_perm_b32 v224, v28, v24, s34
    s_mov_b32 m0, s31
    v_mfma_f32_16x16x32_bf16 a[204:207], v[228:231], v[204:207], a[204:207]
    v_perm_b32 v225, v36, v32, s34
    buffer_load_dwordx4 v4, s[16:19], s42 offen offset:2048 nt lds
    v_mfma_f32_16x16x32_bf16 a[208:211], v[228:231], v[208:211], a[208:211]
    v_perm_b32 v226, v44, v40, s34
    v_mfma_f32_16x16x32_bf16 a[212:215], v[228:231], v[212:215], a[212:215]
    v_perm_b32 v227, v52, v48, s34
    v_mfma_f32_16x16x32_bf16 a[216:219], v[228:231], v[216:219], a[216:219]
    v_mfma_f32_16x16x32_bf16 a[220:223], v[228:231], v[220:223], a[220:223]
    s_waitcnt lgkmcnt(0)
    v_mfma_f32_16x16x32_bf16 a[0:3], v[224:227], v[168:171], a[0:3]
    v_perm_b32 v228, v28, v24, s35
    v_mfma_f32_16x16x32_bf16 a[4:7], v[224:227], v[172:175], a[4:7]
    v_perm_b32 v229, v36, v32, s35
    v_mfma_f32_16x16x32_bf16 a[8:11], v[224:227], v[176:179], a[8:11]
    v_perm_b32 v230, v44, v40, s35
    buffer_load_dwordx4 v[88:91], v232, s[8:11], s60 offen
    v_mfma_f32_16x16x32_bf16 a[12:15], v[224:227], v[180:183], a[12:15]
    v_perm_b32 v231, v52, v48, s35
    v_mfma_f32_16x16x32_bf16 a[16:19], v[224:227], v[184:187], a[16:19]
    v_mfma_f32_16x16x32_bf16 a[20:23], v[224:227], v[188:191], a[20:23]
    v_mfma_f32_16x16x32_bf16 a[24:27], v[224:227], v[192:195], a[24:27]
    buffer_load_dwordx4 v[92:95], v233, s[8:11], s60 offen
    v_mfma_f32_16x16x32_bf16 a[28:31], v[228:231], v[168:171], a[28:31]
    v_perm_b32 v224, v29, v25, s34
    v_mfma_f32_16x16x32_bf16 a[32:35], v[228:231], v[172:175], a[32:35]
    v_perm_b32 v225, v37, v33, s34
    v_mfma_f32_16x16x32_bf16 a[36:39], v[228:231], v[176:179], a[36:39]
    v_perm_b32 v226, v45, v41, s34
    v_mfma_f32_16x16x32_bf16 a[40:43], v[228:231], v[180:183], a[40:43]
    v_perm_b32 v227, v53, v49, s34
    v_mfma_f32_16x16x32_bf16 a[44:47], v[228:231], v[184:187], a[44:47]
    buffer_load_dwordx4 v[96:99], v234, s[8:11], s60 offen
    v_mfma_f32_16x16x32_bf16 a[48:51], v[228:231], v[188:191], a[48:51]
    v_mfma_f32_16x16x32_bf16 a[52:55], v[228:231], v[192:195], a[52:55]
    v_mfma_f32_16x16x32_bf16 a[56:59], v[224:227], v[168:171], a[56:59]
    v_perm_b32 v228, v29, v25, s35
    v_mfma_f32_16x16x32_bf16 a[60:63], v[224:227], v[172:175], a[60:63]
    v_perm_b32 v229, v37, v33, s35
    v_mfma_f32_16x16x32_bf16 a[64:67], v[224:227], v[176:179], a[64:67]
    v_perm_b32 v230, v45, v41, s35
    buffer_load_dwordx4 v[100:103], v235, s[8:11], s60 offen
    v_mfma_f32_16x16x32_bf16 a[68:71], v[224:227], v[180:183], a[68:71]
    v_perm_b32 v231, v53, v49, s35
    v_mfma_f32_16x16x32_bf16 a[72:75], v[224:227], v[184:187], a[72:75]
    v_mfma_f32_16x16x32_bf16 a[76:79], v[224:227], v[188:191], a[76:79]
    v_mfma_f32_16x16x32_bf16 a[80:83], v[224:227], v[192:195], a[80:83]
    v_mfma_f32_16x16x32_bf16 a[84:87], v[228:231], v[168:171], a[84:87]
    v_perm_b32 v224, v30, v26, s34
    ds_read_b128 v[196:199], v243 offset:0
    v_mfma_f32_16x16x32_bf16 a[88:91], v[228:231], v[172:175], a[88:91]
    v_perm_b32 v225, v38, v34, s34
    v_mfma_f32_16x16x32_bf16 a[92:95], v[228:231], v[176:179], a[92:95]
    v_perm_b32 v226, v46, v42, s34
    ds_read_b128 v[200:203], v243 offset:2048
    v_mfma_f32_16x16x32_bf16 a[96:99], v[228:231], v[180:183], a[96:99]
    v_perm_b32 v227, v54, v50, s34
    ds_read_b128 v[204:207], v243 offset:4096
    v_mfma_f32_16x16x32_bf16 a[100:103], v[228:231], v[184:187], a[100:103]
    ds_read_b128 v[208:211], v243 offset:6144
    buffer_load_dwordx4 v[104:107], v236, s[8:11], s60 offen
    v_mfma_f32_16x16x32_bf16 a[104:107], v[228:231], v[188:191], a[104:107]
    ds_read_b128 v[212:215], v243 offset:8192
    v_mfma_f32_16x16x32_bf16 a[108:111], v[228:231], v[192:195], a[108:111]
    v_mfma_f32_16x16x32_bf16 a[112:115], v[224:227], v[168:171], a[112:115]
    v_perm_b32 v228, v30, v26, s35
    ds_read_b128 v[216:219], v243 offset:10240
    v_mfma_f32_16x16x32_bf16 a[116:119], v[224:227], v[172:175], a[116:119]
    v_perm_b32 v229, v38, v34, s35
    ds_read_b128 v[220:223], v243 offset:12288
    buffer_load_dwordx4 v[108:111], v237, s[8:11], s60 offen
    v_mfma_f32_16x16x32_bf16 a[120:123], v[224:227], v[176:179], a[120:123]
    v_perm_b32 v230, v46, v42, s35
    v_mfma_f32_16x16x32_bf16 a[124:127], v[224:227], v[180:183], a[124:127]
    v_perm_b32 v231, v54, v50, s35
    v_mfma_f32_16x16x32_bf16 a[128:131], v[224:227], v[184:187], a[128:131]
    v_mfma_f32_16x16x32_bf16 a[132:135], v[224:227], v[188:191], a[132:135]
    v_mfma_f32_16x16x32_bf16 a[136:139], v[224:227], v[192:195], a[136:139]
    buffer_load_dwordx4 v[112:115], v238, s[8:11], s60 offen
    v_mfma_f32_16x16x32_bf16 a[140:143], v[228:231], v[168:171], a[140:143]
    v_perm_b32 v224, v31, v27, s34
    v_mfma_f32_16x16x32_bf16 a[144:147], v[228:231], v[172:175], a[144:147]
    v_perm_b32 v225, v39, v35, s34
    v_mfma_f32_16x16x32_bf16 a[148:151], v[228:231], v[176:179], a[148:151]
    v_perm_b32 v226, v47, v43, s34
    v_mfma_f32_16x16x32_bf16 a[152:155], v[228:231], v[180:183], a[152:155]
    v_perm_b32 v227, v55, v51, s34
    v_mfma_f32_16x16x32_bf16 a[156:159], v[228:231], v[184:187], a[156:159]
    buffer_load_dwordx4 v[116:119], v239, s[8:11], s60 offen
    v_mfma_f32_16x16x32_bf16 a[160:163], v[228:231], v[188:191], a[160:163]
    s_add_u32 s60, s36, s55
    v_mfma_f32_16x16x32_bf16 a[164:167], v[228:231], v[192:195], a[164:167]
    v_mfma_f32_16x16x32_bf16 a[168:171], v[224:227], v[168:171], a[168:171]
    v_perm_b32 v228, v31, v27, s35
    v_mfma_f32_16x16x32_bf16 a[172:175], v[224:227], v[172:175], a[172:175]
    v_perm_b32 v229, v39, v35, s35
    s_mov_b32 m0, s31
    v_mfma_f32_16x16x32_bf16 a[176:179], v[224:227], v[176:179], a[176:179]
    v_perm_b32 v230, v47, v43, s35
    buffer_load_dwordx4 v5, s[16:19], s42 offen offset:3072 nt lds
    v_mfma_f32_16x16x32_bf16 a[180:183], v[224:227], v[180:183], a[180:183]
    v_perm_b32 v231, v55, v51, s35
    v_mfma_f32_16x16x32_bf16 a[184:187], v[224:227], v[184:187], a[184:187]
    v_mfma_f32_16x16x32_bf16 a[188:191], v[224:227], v[188:191], a[188:191]
    v_mfma_f32_16x16x32_bf16 a[192:195], v[224:227], v[192:195], a[192:195]
    s_mov_b32 m0, s24
    v_mfma_f32_16x16x32_bf16 a[196:199], v[228:231], v[168:171], a[196:199]
    s_waitcnt vmcnt(12)
    s_movk_i32 s42, 16384
    buffer_load_dwordx4 v2, s[12:15], s42 offen offset:0 nt lds
    v_mfma_f32_16x16x32_bf16 a[200:203], v[228:231], v[172:175], a[200:203]
    v_perm_b32 v224, v60, v56, s34
    v_mfma_f32_16x16x32_bf16 a[204:207], v[228:231], v[176:179], a[204:207]
    v_perm_b32 v225, v68, v64, s34
    v_mfma_f32_16x16x32_bf16 a[208:211], v[228:231], v[180:183], a[208:211]
    v_perm_b32 v226, v76, v72, s34
    v_mfma_f32_16x16x32_bf16 a[212:215], v[228:231], v[184:187], a[212:215]
    v_perm_b32 v227, v84, v80, s34
    v_mfma_f32_16x16x32_bf16 a[216:219], v[228:231], v[188:191], a[216:219]
    v_mfma_f32_16x16x32_bf16 a[220:223], v[228:231], v[192:195], a[220:223]
    s_waitcnt lgkmcnt(0)
    v_mfma_f32_16x16x32_bf16 a[0:3], v[224:227], v[196:199], a[0:3]
    v_perm_b32 v228, v60, v56, s35
    v_mfma_f32_16x16x32_bf16 a[4:7], v[224:227], v[200:203], a[4:7]
    v_perm_b32 v229, v68, v64, s35
    v_mfma_f32_16x16x32_bf16 a[8:11], v[224:227], v[204:207], a[8:11]
    v_perm_b32 v230, v76, v72, s35
    buffer_load_dwordx4 v[24:27], v232, s[8:11], s60 offen
    v_mfma_f32_16x16x32_bf16 a[12:15], v[224:227], v[208:211], a[12:15]
    v_perm_b32 v231, v84, v80, s35
    v_mfma_f32_16x16x32_bf16 a[16:19], v[224:227], v[212:215], a[16:19]
    v_mfma_f32_16x16x32_bf16 a[20:23], v[224:227], v[216:219], a[20:23]
    v_mfma_f32_16x16x32_bf16 a[24:27], v[224:227], v[220:223], a[24:27]
    buffer_load_dwordx4 v[28:31], v233, s[8:11], s60 offen
    v_mfma_f32_16x16x32_bf16 a[28:31], v[228:231], v[196:199], a[28:31]
    v_perm_b32 v224, v61, v57, s34
    v_mfma_f32_16x16x32_bf16 a[32:35], v[228:231], v[200:203], a[32:35]
    v_perm_b32 v225, v69, v65, s34
    v_mfma_f32_16x16x32_bf16 a[36:39], v[228:231], v[204:207], a[36:39]
    v_perm_b32 v226, v77, v73, s34
    v_mfma_f32_16x16x32_bf16 a[40:43], v[228:231], v[208:211], a[40:43]
    v_perm_b32 v227, v85, v81, s34
    v_mfma_f32_16x16x32_bf16 a[44:47], v[228:231], v[212:215], a[44:47]
    buffer_load_dwordx4 v[32:35], v234, s[8:11], s60 offen
    v_mfma_f32_16x16x32_bf16 a[48:51], v[228:231], v[216:219], a[48:51]
    v_mfma_f32_16x16x32_bf16 a[52:55], v[228:231], v[220:223], a[52:55]
    v_mfma_f32_16x16x32_bf16 a[56:59], v[224:227], v[196:199], a[56:59]
    v_perm_b32 v228, v61, v57, s35
    v_mfma_f32_16x16x32_bf16 a[60:63], v[224:227], v[200:203], a[60:63]
    v_perm_b32 v229, v69, v65, s35
    v_mfma_f32_16x16x32_bf16 a[64:67], v[224:227], v[204:207], a[64:67]
    v_perm_b32 v230, v77, v73, s35
    buffer_load_dwordx4 v[36:39], v235, s[8:11], s60 offen
    v_mfma_f32_16x16x32_bf16 a[68:71], v[224:227], v[208:211], a[68:71]
    v_perm_b32 v231, v85, v81, s35
    v_mfma_f32_16x16x32_bf16 a[72:75], v[224:227], v[212:215], a[72:75]
    v_mfma_f32_16x16x32_bf16 a[76:79], v[224:227], v[216:219], a[76:79]
    v_mfma_f32_16x16x32_bf16 a[80:83], v[224:227], v[220:223], a[80:83]
    s_waitcnt vmcnt(21)
    s_barrier
    v_mfma_f32_16x16x32_bf16 a[84:87], v[228:231], v[196:199], a[84:87]
    v_perm_b32 v224, v62, v58, s34
    ds_read_b128 v[168:171], v242 offset:16384
    v_mfma_f32_16x16x32_bf16 a[88:91], v[228:231], v[200:203], a[88:91]
    v_perm_b32 v225, v70, v66, s34
    v_mfma_f32_16x16x32_bf16 a[92:95], v[228:231], v[204:207], a[92:95]
    v_perm_b32 v226, v78, v74, s34
    ds_read_b128 v[172:175], v242 offset:18432
    v_mfma_f32_16x16x32_bf16 a[96:99], v[228:231], v[208:211], a[96:99]
    v_perm_b32 v227, v86, v82, s34
    ds_read_b128 v[176:179], v242 offset:20480
    v_mfma_f32_16x16x32_bf16 a[100:103], v[228:231], v[212:215], a[100:103]
    ds_read_b128 v[180:183], v242 offset:22528
    s_add_u32 s61, s37, s56
    v_mfma_f32_16x16x32_bf16 a[104:107], v[228:231], v[216:219], a[104:107]
    ds_read_b128 v[184:187], v242 offset:24576
    s_add_u32 m0, s38, 0
    s_nop 0
    buffer_load_dwordx4 v240, s[4:7], s61 offen lds
    v_mfma_f32_16x16x32_bf16 a[108:111], v[228:231], v[220:223], a[108:111]
    s_add_u32 m0, s38, 1024
    v_mfma_f32_16x16x32_bf16 a[112:115], v[224:227], v[196:199], a[112:115]
    v_perm_b32 v228, v62, v58, s35
    ds_read_b128 v[188:191], v242 offset:26624
    buffer_load_dwordx4 v241, s[4:7], s61 offen lds
    v_mfma_f32_16x16x32_bf16 a[116:119], v[224:227], v[200:203], a[116:119]
    v_perm_b32 v229, v70, v66, s35
    ds_read_b128 v[192:195], v242 offset:28672
    v_mfma_f32_16x16x32_bf16 a[120:123], v[224:227], v[204:207], a[120:123]
    v_perm_b32 v230, v78, v74, s35
    s_add_u32 m0, s38, 2048
    v_mfma_f32_16x16x32_bf16 a[124:127], v[224:227], v[208:211], a[124:127]
    v_perm_b32 v231, v86, v82, s35
    s_add_u32 s61, s61, 20480
    buffer_load_dwordx4 v240, s[4:7], s61 offen lds
    v_mfma_f32_16x16x32_bf16 a[128:131], v[224:227], v[212:215], a[128:131]
    s_add_u32 m0, s38, 3072
    v_mfma_f32_16x16x32_bf16 a[132:135], v[224:227], v[216:219], a[132:135]
    buffer_load_dwordx4 v241, s[4:7], s61 offen lds
    v_mfma_f32_16x16x32_bf16 a[136:139], v[224:227], v[220:223], a[136:139]
    v_mfma_f32_16x16x32_bf16 a[140:143], v[228:231], v[196:199], a[140:143]
    v_perm_b32 v224, v63, v59, s34
    buffer_load_dwordx4 v[40:43], v236, s[8:11], s60 offen
    v_mfma_f32_16x16x32_bf16 a[144:147], v[228:231], v[200:203], a[144:147]
    v_perm_b32 v225, v71, v67, s34
    v_mfma_f32_16x16x32_bf16 a[148:151], v[228:231], v[204:207], a[148:151]
    v_perm_b32 v226, v79, v75, s34
    buffer_load_dwordx4 v[44:47], v237, s[8:11], s60 offen
    v_mfma_f32_16x16x32_bf16 a[152:155], v[228:231], v[208:211], a[152:155]
    v_perm_b32 v227, v87, v83, s34
    v_mfma_f32_16x16x32_bf16 a[156:159], v[228:231], v[212:215], a[156:159]
    v_mfma_f32_16x16x32_bf16 a[160:163], v[228:231], v[216:219], a[160:163]
    buffer_load_dwordx4 v[48:51], v238, s[8:11], s60 offen
    v_mfma_f32_16x16x32_bf16 a[164:167], v[228:231], v[220:223], a[164:167]
    v_mfma_f32_16x16x32_bf16 a[168:171], v[224:227], v[196:199], a[168:171]
    v_perm_b32 v228, v63, v59, s35
    buffer_load_dwordx4 v[52:55], v239, s[8:11], s60 offen
    v_mfma_f32_16x16x32_bf16 a[172:175], v[224:227], v[200:203], a[172:175]
    v_perm_b32 v229, v71, v67, s35
    s_add_u32 s36, s36, 1048576
    s_cmp_ge_u32 s36, 5242880
    v_mfma_f32_16x16x32_bf16 a[176:179], v[224:227], v[204:207], a[176:179]
    v_perm_b32 v230, v79, v75, s35
    s_cselect_b32 s36, 0, s36
    s_add_u32 s60, s36, s52
    v_mfma_f32_16x16x32_bf16 a[180:183], v[224:227], v[208:211], a[180:183]
    v_perm_b32 v231, v87, v83, s35
    s_mov_b32 m0, s24
    v_mfma_f32_16x16x32_bf16 a[184:187], v[224:227], v[212:215], a[184:187]
    buffer_load_dwordx4 v3, s[12:15], s42 offen offset:1024 nt lds
    v_mfma_f32_16x16x32_bf16 a[188:191], v[224:227], v[216:219], a[188:191]
    s_mov_b32 m0, s24
    v_mfma_f32_16x16x32_bf16 a[192:195], v[224:227], v[220:223], a[192:195]
    buffer_load_dwordx4 v4, s[12:15], s42 offen offset:2048 nt lds
    v_mfma_f32_16x16x32_bf16 a[196:199], v[228:231], v[196:199], a[196:199]
    s_waitcnt vmcnt(16)
    v_mfma_f32_16x16x32_bf16 a[200:203], v[228:231], v[200:203], a[200:203]
    v_perm_b32 v224, v92, v88, s34
    s_mov_b32 m0, s24
    v_mfma_f32_16x16x32_bf16 a[204:207], v[228:231], v[204:207], a[204:207]
    v_perm_b32 v225, v100, v96, s34
    buffer_load_dwordx4 v5, s[12:15], s42 offen offset:3072 nt lds
    v_mfma_f32_16x16x32_bf16 a[208:211], v[228:231], v[208:211], a[208:211]
    v_perm_b32 v226, v108, v104, s34
    v_mfma_f32_16x16x32_bf16 a[212:215], v[228:231], v[212:215], a[212:215]
    v_perm_b32 v227, v116, v112, s34
    v_mfma_f32_16x16x32_bf16 a[216:219], v[228:231], v[216:219], a[216:219]
    v_mfma_f32_16x16x32_bf16 a[220:223], v[228:231], v[220:223], a[220:223]
    s_waitcnt lgkmcnt(0)
    v_mfma_f32_16x16x32_bf16 a[0:3], v[224:227], v[168:171], a[0:3]
    v_perm_b32 v228, v92, v88, s35
    v_mfma_f32_16x16x32_bf16 a[4:7], v[224:227], v[172:175], a[4:7]
    v_perm_b32 v229, v100, v96, s35
    v_mfma_f32_16x16x32_bf16 a[8:11], v[224:227], v[176:179], a[8:11]
    v_perm_b32 v230, v108, v104, s35
    buffer_load_dwordx4 v[56:59], v232, s[8:11], s60 offen
    v_mfma_f32_16x16x32_bf16 a[12:15], v[224:227], v[180:183], a[12:15]
    v_perm_b32 v231, v116, v112, s35
    v_mfma_f32_16x16x32_bf16 a[16:19], v[224:227], v[184:187], a[16:19]
    v_mfma_f32_16x16x32_bf16 a[20:23], v[224:227], v[188:191], a[20:23]
    v_mfma_f32_16x16x32_bf16 a[24:27], v[224:227], v[192:195], a[24:27]
    buffer_load_dwordx4 v[60:63], v233, s[8:11], s60 offen
    v_mfma_f32_16x16x32_bf16 a[28:31], v[228:231], v[168:171], a[28:31]
    v_perm_b32 v224, v93, v89, s34
    v_mfma_f32_16x16x32_bf16 a[32:35], v[228:231], v[172:175], a[32:35]
    v_perm_b32 v225, v101, v97, s34
    v_mfma_f32_16x16x32_bf16 a[36:39], v[228:231], v[176:179], a[36:39]
    v_perm_b32 v226, v109, v105, s34
    v_mfma_f32_16x16x32_bf16 a[40:43], v[228:231], v[180:183], a[40:43]
    v_perm_b32 v227, v117, v113, s34
    v_mfma_f32_16x16x32_bf16 a[44:47], v[228:231], v[184:187], a[44:47]
    buffer_load_dwordx4 v[64:67], v234, s[8:11], s60 offen
    v_mfma_f32_16x16x32_bf16 a[48:51], v[228:231], v[188:191], a[48:51]
    v_mfma_f32_16x16x32_bf16 a[52:55], v[228:231], v[192:195], a[52:55]
    v_mfma_f32_16x16x32_bf16 a[56:59], v[224:227], v[168:171], a[56:59]
    v_perm_b32 v228, v93, v89, s35
    v_mfma_f32_16x16x32_bf16 a[60:63], v[224:227], v[172:175], a[60:63]
    v_perm_b32 v229, v101, v97, s35
    v_mfma_f32_16x16x32_bf16 a[64:67], v[224:227], v[176:179], a[64:67]
    v_perm_b32 v230, v109, v105, s35
    buffer_load_dwordx4 v[68:71], v235, s[8:11], s60 offen
    v_mfma_f32_16x16x32_bf16 a[68:71], v[224:227], v[180:183], a[68:71]
    v_perm_b32 v231, v117, v113, s35
    v_mfma_f32_16x16x32_bf16 a[72:75], v[224:227], v[184:187], a[72:75]
    v_mfma_f32_16x16x32_bf16 a[76:79], v[224:227], v[188:191], a[76:79]
    v_mfma_f32_16x16x32_bf16 a[80:83], v[224:227], v[192:195], a[80:83]
    v_mfma_f32_16x16x32_bf16 a[84:87], v[228:231], v[168:171], a[84:87]
    v_perm_b32 v224, v94, v90, s34
    ds_read_b128 v[196:199], v243 offset:16384
    v_mfma_f32_16x16x32_bf16 a[88:91], v[228:231], v[172:175], a[88:91]
    v_perm_b32 v225, v102, v98, s34
    v_mfma_f32_16x16x32_bf16 a[92:95], v[228:231], v[176:179], a[92:95]
    v_perm_b32 v226, v110, v106, s34
    ds_read_b128 v[200:203], v243 offset:18432
    v_mfma_f32_16x16x32_bf16 a[96:99], v[228:231], v[180:183], a[96:99]
    v_perm_b32 v227, v118, v114, s34
    ds_read_b128 v[204:207], v243 offset:20480
    v_mfma_f32_16x16x32_bf16 a[100:103], v[228:231], v[184:187], a[100:103]
    ds_read_b128 v[208:211], v243 offset:22528
    buffer_load_dwordx4 v[72:75], v236, s[8:11], s60 offen
    v_mfma_f32_16x16x32_bf16 a[104:107], v[228:231], v[188:191], a[104:107]
    ds_read_b128 v[212:215], v243 offset:24576
    v_mfma_f32_16x16x32_bf16 a[108:111], v[228:231], v[192:195], a[108:111]
    v_mfma_f32_16x16x32_bf16 a[112:115], v[224:227], v[168:171], a[112:115]
    v_perm_b32 v228, v94, v90, s35
    ds_read_b128 v[216:219], v243 offset:26624
    v_mfma_f32_16x16x32_bf16 a[116:119], v[224:227], v[172:175], a[116:119]
    v_perm_b32 v229, v102, v98, s35
    ds_read_b128 v[220:223], v243 offset:28672
    buffer_load_dwordx4 v[76:79], v237, s[8:11], s60 offen
    v_mfma_f32_16x16x32_bf16 a[120:123], v[224:227], v[176:179], a[120:123]
    v_perm_b32 v230, v110, v106, s35
    v_mfma_f32_16x16x32_bf16 a[124:127], v[224:227], v[180:183], a[124:127]
    v_perm_b32 v231, v118, v114, s35
    v_mfma_f32_16x16x32_bf16 a[128:131], v[224:227], v[184:187], a[128:131]
    v_mfma_f32_16x16x32_bf16 a[132:135], v[224:227], v[188:191], a[132:135]
    v_mfma_f32_16x16x32_bf16 a[136:139], v[224:227], v[192:195], a[136:139]
    buffer_load_dwordx4 v[80:83], v238, s[8:11], s60 offen
    v_mfma_f32_16x16x32_bf16 a[140:143], v[228:231], v[168:171], a[140:143]
    v_perm_b32 v224, v95, v91, s34
    v_mfma_f32_16x16x32_bf16 a[144:147], v[228:231], v[172:175], a[144:147]
    v_perm_b32 v225, v103, v99, s34
    v_mfma_f32_16x16x32_bf16 a[148:151], v[228:231], v[176:179], a[148:151]
    v_perm_b32 v226, v111, v107, s34
    v_mfma_f32_16x16x32_bf16 a[152:155], v[228:231], v[180:183], a[152:155]
    v_perm_b32 v227, v119, v115, s34
    v_mfma_f32_16x16x32_bf16 a[156:159], v[228:231], v[184:187], a[156:159]
    buffer_load_dwordx4 v[84:87], v239, s[8:11], s60 offen
    v_mfma_f32_16x16x32_bf16 a[160:163], v[228:231], v[188:191], a[160:163]
    s_add_u32 s60, s36, s53
    v_mfma_f32_16x16x32_bf16 a[164:167], v[228:231], v[192:195], a[164:167]
    v_mfma_f32_16x16x32_bf16 a[168:171], v[224:227], v[168:171], a[168:171]
    v_perm_b32 v228, v95, v91, s35
    v_mfma_f32_16x16x32_bf16 a[172:175], v[224:227], v[172:175], a[172:175]
    v_perm_b32 v229, v103, v99, s35
    s_mov_b32 m0, s25
    v_mfma_f32_16x16x32_bf16 a[176:179], v[224:227], v[176:179], a[176:179]
    v_perm_b32 v230, v111, v107, s35
    s_movk_i32 s42, 20480
    buffer_load_dwordx4 v2, s[12:15], s42 offen offset:0 nt lds
    v_mfma_f32_16x16x32_bf16 a[180:183], v[224:227], v[180:183], a[180:183]
    v_perm_b32 v231, v119, v115, s35
    v_mfma_f32_16x16x32_bf16 a[184:187], v[224:227], v[184:187], a[184:187]
    v_mfma_f32_16x16x32_bf16 a[188:191], v[224:227], v[188:191], a[188:191]
    v_mfma_f32_16x16x32_bf16 a[192:195], v[224:227], v[192:195], a[192:195]
    s_mov_b32 m0, s25
    v_mfma_f32_16x16x32_bf16 a[196:199], v[228:231], v[168:171], a[196:199]
    s_waitcnt vmcnt(12)
    buffer_load_dwordx4 v3, s[12:15], s42 offen offset:1024 nt lds
    v_mfma_f32_16x16x32_bf16 a[200:203], v[228:231], v[172:175], a[200:203]
    v_perm_b32 v224, v28, v24, s34
    v_mfma_f32_16x16x32_bf16 a[204:207], v[228:231], v[176:179], a[204:207]
    v_perm_b32 v225, v36, v32, s34
    v_mfma_f32_16x16x32_bf16 a[208:211], v[228:231], v[180:183], a[208:211]
    v_perm_b32 v226, v44, v40, s34
    v_mfma_f32_16x16x32_bf16 a[212:215], v[228:231], v[184:187], a[212:215]
    v_perm_b32 v227, v52, v48, s34
    v_mfma_f32_16x16x32_bf16 a[216:219], v[228:231], v[188:191], a[216:219]
    v_mfma_f32_16x16x32_bf16 a[220:223], v[228:231], v[192:195], a[220:223]
    s_waitcnt lgkmcnt(0)
    v_mfma_f32_16x16x32_bf16 a[0:3], v[224:227], v[196:199], a[0:3]
    v_perm_b32 v228, v28, v24, s35
    v_mfma_f32_16x16x32_bf16 a[4:7], v[224:227], v[200:203], a[4:7]
    v_perm_b32 v229, v36, v32, s35
    v_mfma_f32_16x16x32_bf16 a[8:11], v[224:227], v[204:207], a[8:11]
    v_perm_b32 v230, v44, v40, s35
    buffer_load_dwordx4 v[88:91], v232, s[8:11], s60 offen
    v_mfma_f32_16x16x32_bf16 a[12:15], v[224:227], v[208:211], a[12:15]
    v_perm_b32 v231, v52, v48, s35
    v_mfma_f32_16x16x32_bf16 a[16:19], v[224:227], v[212:215], a[16:19]
    v_mfma_f32_16x16x32_bf16 a[20:23], v[224:227], v[216:219], a[20:23]
    v_mfma_f32_16x16x32_bf16 a[24:27], v[224:227], v[220:223], a[24:27]
    buffer_load_dwordx4 v[92:95], v233, s[8:11], s60 offen
    v_mfma_f32_16x16x32_bf16 a[28:31], v[228:231], v[196:199], a[28:31]
    v_perm_b32 v224, v29, v25, s34
    v_mfma_f32_16x16x32_bf16 a[32:35], v[228:231], v[200:203], a[32:35]
    v_perm_b32 v225, v37, v33, s34
    v_mfma_f32_16x16x32_bf16 a[36:39], v[228:231], v[204:207], a[36:39]
    v_perm_b32 v226, v45, v41, s34
    v_mfma_f32_16x16x32_bf16 a[40:43], v[228:231], v[208:211], a[40:43]
    v_perm_b32 v227, v53, v49, s34
    v_mfma_f32_16x16x32_bf16 a[44:47], v[228:231], v[212:215], a[44:47]
    buffer_load_dwordx4 v[96:99], v234, s[8:11], s60 offen
    v_mfma_f32_16x16x32_bf16 a[48:51], v[228:231], v[216:219], a[48:51]
    v_mfma_f32_16x16x32_bf16 a[52:55], v[228:231], v[220:223], a[52:55]
    v_mfma_f32_16x16x32_bf16 a[56:59], v[224:227], v[196:199], a[56:59]
    v_perm_b32 v228, v29, v25, s35
    v_mfma_f32_16x16x32_bf16 a[60:63], v[224:227], v[200:203], a[60:63]
    v_perm_b32 v229, v37, v33, s35
    v_mfma_f32_16x16x32_bf16 a[64:67], v[224:227], v[204:207], a[64:67]
    v_perm_b32 v230, v45, v41, s35
    buffer_load_dwordx4 v[100:103], v235, s[8:11], s60 offen
    v_mfma_f32_16x16x32_bf16 a[68:71], v[224:227], v[208:211], a[68:71]
    v_perm_b32 v231, v53, v49, s35
    v_mfma_f32_16x16x32_bf16 a[72:75], v[224:227], v[212:215], a[72:75]
    v_mfma_f32_16x16x32_bf16 a[76:79], v[224:227], v[216:219], a[76:79]
    v_mfma_f32_16x16x32_bf16 a[80:83], v[224:227], v[220:223], a[80:83]
    s_waitcnt vmcnt(21)
    s_barrier
    v_mfma_f32_16x16x32_bf16 a[84:87], v[228:231], v[196:199], a[84:87]
    v_perm_b32 v224, v30, v26, s34
    ds_read_b128 v[168:171], v242 offset:0
    v_mfma_f32_16x16x32_bf16 a[88:91], v[228:231], v[200:203], a[88:91]
    v_perm_b32 v225, v38, v34, s34
    v_mfma_f32_16x16x32_bf16 a[92:95], v[228:231], v[204:207], a[92:95]
    v_perm_b32 v226, v46, v42, s34
    ds_read_b128 v[172:175], v242 offset:2048
    v_mfma_f32_16x16x32_bf16 a[96:99], v[228:231], v[208:211], a[96:99]
    v_perm_b32 v227, v54, v50, s34
    ds_read_b128 v[176:179], v242 offset:4096
    v_mfma_f32_16x16x32_bf16 a[100:103], v[228:231], v[212:215], a[100:103]
    ds_read_b128 v[180:183], v242 offset:6144
    s_add_u32 s61, s37, s57
    v_mfma_f32_16x16x32_bf16 a[104:107], v[228:231], v[216:219], a[104:107]
    ds_read_b128 v[184:187], v242 offset:8192
    s_add_u32 m0, s38, 16384
    s_nop 0
    buffer_load_dwordx4 v240, s[4:7], s61 offen lds
    v_mfma_f32_16x16x32_bf16 a[108:111], v[228:231], v[220:223], a[108:111]
    s_add_u32 m0, s38, 17408
    v_mfma_f32_16x16x32_bf16 a[112:115], v[224:227], v[196:199], a[112:115]
    v_perm_b32 v228, v30, v26, s35
    ds_read_b128 v[188:191], v242 offset:10240
    buffer_load_dwordx4 v241, s[4:7], s61 offen lds
    v_mfma_f32_16x16x32_bf16 a[116:119], v[224:227], v[200:203], a[116:119]
    v_perm_b32 v229, v38, v34, s35
    ds_read_b128 v[192:195], v242 offset:12288
    v_mfma_f32_16x16x32_bf16 a[120:123], v[224:227], v[204:207], a[120:123]
    v_perm_b32 v230, v46, v42, s35
    s_add_u32 m0, s38, 18432
    v_mfma_f32_16x16x32_bf16 a[124:127], v[224:227], v[208:211], a[124:127]
    v_perm_b32 v231, v54, v50, s35
    s_add_u32 s61, s61, 20480
    buffer_load_dwordx4 v240, s[4:7], s61 offen lds
    v_mfma_f32_16x16x32_bf16 a[128:131], v[224:227], v[212:215], a[128:131]
    s_add_u32 m0, s38, 19456
    v_mfma_f32_16x16x32_bf16 a[132:135], v[224:227], v[216:219], a[132:135]
    buffer_load_dwordx4 v241, s[4:7], s61 offen lds
    s_add_u32 s37, s37, 256
    v_mfma_f32_16x16x32_bf16 a[136:139], v[224:227], v[220:223], a[136:139]
    s_cmp_ge_u32 s37, 1280
    s_cselect_b32 s37, 0, s37
    v_mfma_f32_16x16x32_bf16 a[140:143], v[228:231], v[196:199], a[140:143]
    v_perm_b32 v224, v31, v27, s34
    buffer_load_dwordx4 v[104:107], v236, s[8:11], s60 offen
    v_mfma_f32_16x16x32_bf16 a[144:147], v[228:231], v[200:203], a[144:147]
    v_perm_b32 v225, v39, v35, s34
    v_mfma_f32_16x16x32_bf16 a[148:151], v[228:231], v[204:207], a[148:151]
    v_perm_b32 v226, v47, v43, s34
    buffer_load_dwordx4 v[108:111], v237, s[8:11], s60 offen
    v_mfma_f32_16x16x32_bf16 a[152:155], v[228:231], v[208:211], a[152:155]
    v_perm_b32 v227, v55, v51, s34
    v_mfma_f32_16x16x32_bf16 a[156:159], v[228:231], v[212:215], a[156:159]
    v_mfma_f32_16x16x32_bf16 a[160:163], v[228:231], v[216:219], a[160:163]
    buffer_load_dwordx4 v[112:115], v238, s[8:11], s60 offen
    v_mfma_f32_16x16x32_bf16 a[164:167], v[228:231], v[220:223], a[164:167]
    v_mfma_f32_16x16x32_bf16 a[168:171], v[224:227], v[196:199], a[168:171]
    v_perm_b32 v228, v31, v27, s35
    buffer_load_dwordx4 v[116:119], v239, s[8:11], s60 offen
    v_mfma_f32_16x16x32_bf16 a[172:175], v[224:227], v[200:203], a[172:175]
    v_perm_b32 v229, v39, v35, s35
    s_add_u32 s60, s36, s54
    v_mfma_f32_16x16x32_bf16 a[176:179], v[224:227], v[204:207], a[176:179]
    v_perm_b32 v230, v47, v43, s35
    v_mfma_f32_16x16x32_bf16 a[180:183], v[224:227], v[208:211], a[180:183]
    v_perm_b32 v231, v55, v51, s35
    s_mov_b32 m0, s25
    v_mfma_f32_16x16x32_bf16 a[184:187], v[224:227], v[212:215], a[184:187]
    buffer_load_dwordx4 v4, s[12:15], s42 offen offset:2048 nt lds
    v_mfma_f32_16x16x32_bf16 a[188:191], v[224:227], v[216:219], a[188:191]
    s_mov_b32 m0, s25
    v_mfma_f32_16x16x32_bf16 a[192:195], v[224:227], v[220:223], a[192:195]
    buffer_load_dwordx4 v5, s[12:15], s42 offen offset:3072 nt lds
    v_mfma_f32_16x16x32_bf16 a[196:199], v[228:231], v[196:199], a[196:199]
    s_waitcnt vmcnt(16)
    v_mfma_f32_16x16x32_bf16 a[200:203], v[228:231], v[200:203], a[200:203]
    v_perm_b32 v224, v60, v56, s34
    s_mov_b32 m0, s26
    v_mfma_f32_16x16x32_bf16 a[204:207], v[228:231], v[204:207], a[204:207]
    v_perm_b32 v225, v68, v64, s34
    s_movk_i32 s42, 16384
    buffer_load_dwordx4 v2, s[16:19], s42 offen offset:0 nt lds
    v_mfma_f32_16x16x32_bf16 a[208:211], v[228:231], v[208:211], a[208:211]
    v_perm_b32 v226, v76, v72, s34
    v_mfma_f32_16x16x32_bf16 a[212:215], v[228:231], v[212:215], a[212:215]
    v_perm_b32 v227, v84, v80, s34
    v_mfma_f32_16x16x32_bf16 a[216:219], v[228:231], v[216:219], a[216:219]
    v_mfma_f32_16x16x32_bf16 a[220:223], v[228:231], v[220:223], a[220:223]
    s_waitcnt lgkmcnt(0)
    v_mfma_f32_16x16x32_bf16 a[0:3], v[224:227], v[168:171], a[0:3]
    v_perm_b32 v228, v60, v56, s35
    v_mfma_f32_16x16x32_bf16 a[4:7], v[224:227], v[172:175], a[4:7]
    v_perm_b32 v229, v68, v64, s35
    v_mfma_f32_16x16x32_bf16 a[8:11], v[224:227], v[176:179], a[8:11]
    v_perm_b32 v230, v76, v72, s35
    buffer_load_dwordx4 v[24:27], v232, s[8:11], s60 offen
    v_mfma_f32_16x16x32_bf16 a[12:15], v[224:227], v[180:183], a[12:15]
    v_perm_b32 v231, v84, v80, s35
    v_mfma_f32_16x16x32_bf16 a[16:19], v[224:227], v[184:187], a[16:19]
    v_mfma_f32_16x16x32_bf16 a[20:23], v[224:227], v[188:191], a[20:23]
    v_mfma_f32_16x16x32_bf16 a[24:27], v[224:227], v[192:195], a[24:27]
    buffer_load_dwordx4 v[28:31], v233, s[8:11], s60 offen
    v_mfma_f32_16x16x32_bf16 a[28:31], v[228:231], v[168:171], a[28:31]
    v_perm_b32 v224, v61, v57, s34
    v_mfma_f32_16x16x32_bf16 a[32:35], v[228:231], v[172:175], a[32:35]
    v_perm_b32 v225, v69, v65, s34
    v_mfma_f32_16x16x32_bf16 a[36:39], v[228:231], v[176:179], a[36:39]
    v_perm_b32 v226, v77, v73, s34
    v_mfma_f32_16x16x32_bf16 a[40:43], v[228:231], v[180:183], a[40:43]
    v_perm_b32 v227, v85, v81, s34
    v_mfma_f32_16x16x32_bf16 a[44:47], v[228:231], v[184:187], a[44:47]
    buffer_load_dwordx4 v[32:35], v234, s[8:11], s60 offen
    v_mfma_f32_16x16x32_bf16 a[48:51], v[228:231], v[188:191], a[48:51]
    v_mfma_f32_16x16x32_bf16 a[52:55], v[228:231], v[192:195], a[52:55]
    v_mfma_f32_16x16x32_bf16 a[56:59], v[224:227], v[168:171], a[56:59]
    v_perm_b32 v228, v61, v57, s35
    v_mfma_f32_16x16x32_bf16 a[60:63], v[224:227], v[172:175], a[60:63]
    v_perm_b32 v229, v69, v65, s35
    v_mfma_f32_16x16x32_bf16 a[64:67], v[224:227], v[176:179], a[64:67]
    v_perm_b32 v230, v77, v73, s35
    buffer_load_dwordx4 v[36:39], v235, s[8:11], s60 offen
    v_mfma_f32_16x16x32_bf16 a[68:71], v[224:227], v[180:183], a[68:71]
    v_perm_b32 v231, v85, v81, s35
    v_mfma_f32_16x16x32_bf16 a[72:75], v[224:227], v[184:187], a[72:75]
    v_mfma_f32_16x16x32_bf16 a[76:79], v[224:227], v[188:191], a[76:79]
    v_mfma_f32_16x16x32_bf16 a[80:83], v[224:227], v[192:195], a[80:83]
    v_mfma_f32_16x16x32_bf16 a[84:87], v[228:231], v[168:171], a[84:87]
    v_perm_b32 v224, v62, v58, s34
    ds_read_b128 v[196:199], v243 offset:0
    v_mfma_f32_16x16x32_bf16 a[88:91], v[228:231], v[172:175], a[88:91]
    v_perm_b32 v225, v70, v66, s34
    v_mfma_f32_16x16x32_bf16 a[92:95], v[228:231], v[176:179], a[92:95]
    v_perm_b32 v226, v78, v74, s34
    ds_read_b128 v[200:203], v243 offset:2048
    v_mfma_f32_16x16x32_bf16 a[96:99], v[228:231], v[180:183], a[96:99]
    v_perm_b32 v227, v86, v82, s34
    ds_read_b128 v[204:207], v243 offset:4096
    v_mfma_f32_16x16x32_bf16 a[100:103], v[228:231], v[184:187], a[100:103]
    ds_read_b128 v[208:211], v243 offset:6144
    buffer_load_dwordx4 v[40:43], v236, s[8:11], s60 offen
    v_mfma_f32_16x16x32_bf16 a[104:107], v[228:231], v[188:191], a[104:107]
    ds_read_b128 v[212:215], v243 offset:8192
    v_mfma_f32_16x16x32_bf16 a[108:111], v[228:231], v[192:195], a[108:111]
    v_mfma_f32_16x16x32_bf16 a[112:115], v[224:227], v[168:171], a[112:115]
    v_perm_b32 v228, v62, v58, s35
    ds_read_b128 v[216:219], v243 offset:10240
    v_mfma_f32_16x16x32_bf16 a[116:119], v[224:227], v[172:175], a[116:119]
    v_perm_b32 v229, v70, v66, s35
    ds_read_b128 v[220:223], v243 offset:12288
    buffer_load_dwordx4 v[44:47], v237, s[8:11], s60 offen
    v_mfma_f32_16x16x32_bf16 a[120:123], v[224:227], v[176:179], a[120:123]
    v_perm_b32 v230, v78, v74, s35
    v_mfma_f32_16x16x32_bf16 a[124:127], v[224:227], v[180:183], a[124:127]
    v_perm_b32 v231, v86, v82, s35
    v_mfma_f32_16x16x32_bf16 a[128:131], v[224:227], v[184:187], a[128:131]
    v_mfma_f32_16x16x32_bf16 a[132:135], v[224:227], v[188:191], a[132:135]
    v_mfma_f32_16x16x32_bf16 a[136:139], v[224:227], v[192:195], a[136:139]
    buffer_load_dwordx4 v[48:51], v238, s[8:11], s60 offen
    v_mfma_f32_16x16x32_bf16 a[140:143], v[228:231], v[168:171], a[140:143]
    v_perm_b32 v224, v63, v59, s34
    v_mfma_f32_16x16x32_bf16 a[144:147], v[228:231], v[172:175], a[144:147]
    v_perm_b32 v225, v71, v67, s34
    v_mfma_f32_16x16x32_bf16 a[148:151], v[228:231], v[176:179], a[148:151]
    v_perm_b32 v226, v79, v75, s34
    v_mfma_f32_16x16x32_bf16 a[152:155], v[228:231], v[180:183], a[152:155]
    v_perm_b32 v227, v87, v83, s34
    v_mfma_f32_16x16x32_bf16 a[156:159], v[228:231], v[184:187], a[156:159]
    buffer_load_dwordx4 v[52:55], v239, s[8:11], s60 offen
    v_mfma_f32_16x16x32_bf16 a[160:163], v[228:231], v[188:191], a[160:163]
    s_add_u32 s60, s36, s55
    v_mfma_f32_16x16x32_bf16 a[164:167], v[228:231], v[192:195], a[164:167]
    v_mfma_f32_16x16x32_bf16 a[168:171], v[224:227], v[168:171], a[168:171]
    v_perm_b32 v228, v63, v59, s35
    v_mfma_f32_16x16x32_bf16 a[172:175], v[224:227], v[172:175], a[172:175]
    v_perm_b32 v229, v71, v67, s35
    s_mov_b32 m0, s26
    v_mfma_f32_16x16x32_bf16 a[176:179], v[224:227], v[176:179], a[176:179]
    v_perm_b32 v230, v79, v75, s35
    buffer_load_dwordx4 v3, s[16:19], s42 offen offset:1024 nt lds
    v_mfma_f32_16x16x32_bf16 a[180:183], v[224:227], v[180:183], a[180:183]
    v_perm_b32 v231, v87, v83, s35
    v_mfma_f32_16x16x32_bf16 a[184:187], v[224:227], v[184:187], a[184:187]
    v_mfma_f32_16x16x32_bf16 a[188:191], v[224:227], v[188:191], a[188:191]
    v_mfma_f32_16x16x32_bf16 a[192:195], v[224:227], v[192:195], a[192:195]
    s_mov_b32 m0, s26
    v_mfma_f32_16x16x32_bf16 a[196:199], v[228:231], v[168:171], a[196:199]
    s_waitcnt vmcnt(12)
    buffer_load_dwordx4 v4, s[16:19], s42 offen offset:2048 nt lds
    v_mfma_f32_16x16x32_bf16 a[200:203], v[228:231], v[172:175], a[200:203]
    v_perm_b32 v224, v92, v88, s34
    v_mfma_f32_16x16x32_bf16 a[204:207], v[228:231], v[176:179], a[204:207]
    v_perm_b32 v225, v100, v96, s34
    v_mfma_f32_16x16x32_bf16 a[208:211], v[228:231], v[180:183], a[208:211]
    v_perm_b32 v226, v108, v104, s34
    v_mfma_f32_16x16x32_bf16 a[212:215], v[228:231], v[184:187], a[212:215]
    v_perm_b32 v227, v116, v112, s34
    v_mfma_f32_16x16x32_bf16 a[216:219], v[228:231], v[188:191], a[216:219]
    v_mfma_f32_16x16x32_bf16 a[220:223], v[228:231], v[192:195], a[220:223]
    s_waitcnt lgkmcnt(0)
    v_mfma_f32_16x16x32_bf16 a[0:3], v[224:227], v[196:199], a[0:3]
    v_perm_b32 v228, v92, v88, s35
    v_mfma_f32_16x16x32_bf16 a[4:7], v[224:227], v[200:203], a[4:7]
    v_perm_b32 v229, v100, v96, s35
    v_mfma_f32_16x16x32_bf16 a[8:11], v[224:227], v[204:207], a[8:11]
    v_perm_b32 v230, v108, v104, s35
    buffer_load_dwordx4 v[56:59], v232, s[8:11], s60 offen
    v_mfma_f32_16x16x32_bf16 a[12:15], v[224:227], v[208:211], a[12:15]
    v_perm_b32 v231, v116, v112, s35
    v_mfma_f32_16x16x32_bf16 a[16:19], v[224:227], v[212:215], a[16:19]
    v_mfma_f32_16x16x32_bf16 a[20:23], v[224:227], v[216:219], a[20:23]
    v_mfma_f32_16x16x32_bf16 a[24:27], v[224:227], v[220:223], a[24:27]
    buffer_load_dwordx4 v[60:63], v233, s[8:11], s60 offen
    v_mfma_f32_16x16x32_bf16 a[28:31], v[228:231], v[196:199], a[28:31]
    v_perm_b32 v224, v93, v89, s34
    v_mfma_f32_16x16x32_bf16 a[32:35], v[228:231], v[200:203], a[32:35]
    v_perm_b32 v225, v101, v97, s34
    v_mfma_f32_16x16x32_bf16 a[36:39], v[228:231], v[204:207], a[36:39]
    v_perm_b32 v226, v109, v105, s34
    v_mfma_f32_16x16x32_bf16 a[40:43], v[228:231], v[208:211], a[40:43]
    v_perm_b32 v227, v117, v113, s34
    v_mfma_f32_16x16x32_bf16 a[44:47], v[228:231], v[212:215], a[44:47]
    buffer_load_dwordx4 v[64:67], v234, s[8:11], s60 offen
    v_mfma_f32_16x16x32_bf16 a[48:51], v[228:231], v[216:219], a[48:51]
    v_mfma_f32_16x16x32_bf16 a[52:55], v[228:231], v[220:223], a[52:55]
    v_mfma_f32_16x16x32_bf16 a[56:59], v[224:227], v[196:199], a[56:59]
    v_perm_b32 v228, v93, v89, s35
    v_mfma_f32_16x16x32_bf16 a[60:63], v[224:227], v[200:203], a[60:63]
    v_perm_b32 v229, v101, v97, s35
    v_mfma_f32_16x16x32_bf16 a[64:67], v[224:227], v[204:207], a[64:67]
    v_perm_b32 v230, v109, v105, s35
    buffer_load_dwordx4 v[68:71], v235, s[8:11], s60 offen
    v_mfma_f32_16x16x32_bf16 a[68:71], v[224:227], v[208:211], a[68:71]
    v_perm_b32 v231, v117, v113, s35
    v_mfma_f32_16x16x32_bf16 a[72:75], v[224:227], v[212:215], a[72:75]
    v_mfma_f32_16x16x32_bf16 a[76:79], v[224:227], v[216:219], a[76:79]
    v_mfma_f32_16x16x32_bf16 a[80:83], v[224:227], v[220:223], a[80:83]
    s_waitcnt vmcnt(21)
    s_barrier
    v_mfma_f32_16x16x32_bf16 a[84:87], v[228:231], v[196:199], a[84:87]
    v_perm_b32 v224, v94, v90, s34
    ds_read_b128 v[168:171], v242 offset:16384
    v_mfma_f32_16x16x32_bf16 a[88:91], v[228:231], v[200:203], a[88:91]
    v_perm_b32 v225, v102, v98, s34
    v_mfma_f32_16x16x32_bf16 a[92:95], v[228:231], v[204:207], a[92:95]
    v_perm_b32 v226, v110, v106, s34
    ds_read_b128 v[172:175], v242 offset:18432
    v_mfma_f32_16x16x32_bf16 a[96:99], v[228:231], v[208:211], a[96:99]
    v_perm_b32 v227, v118, v114, s34
    ds_read_b128 v[176:179], v242 offset:20480
    v_mfma_f32_16x16x32_bf16 a[100:103], v[228:231], v[212:215], a[100:103]
    ds_read_b128 v[180:183], v242 offset:22528
    buffer_load_dwordx4 v[72:75], v236, s[8:11], s60 offen
    v_mfma_f32_16x16x32_bf16 a[104:107], v[228:231], v[216:219], a[104:107]
    ds_read_b128 v[184:187], v242 offset:24576
    v_mfma_f32_16x16x32_bf16 a[108:111], v[228:231], v[220:223], a[108:111]
    v_mfma_f32_16x16x32_bf16 a[112:115], v[224:227], v[196:199], a[112:115]
    v_perm_b32 v228, v94, v90, s35
    ds_read_b128 v[188:191], v242 offset:26624
    v_mfma_f32_16x16x32_bf16 a[116:119], v[224:227], v[200:203], a[116:119]
    v_perm_b32 v229, v102, v98, s35
    ds_read_b128 v[192:195], v242 offset:28672
    buffer_load_dwordx4 v[76:79], v237, s[8:11], s60 offen
    v_mfma_f32_16x16x32_bf16 a[120:123], v[224:227], v[204:207], a[120:123]
    v_perm_b32 v230, v110, v106, s35
    v_mfma_f32_16x16x32_bf16 a[124:127], v[224:227], v[208:211], a[124:127]
    v_perm_b32 v231, v118, v114, s35
    v_mfma_f32_16x16x32_bf16 a[128:131], v[224:227], v[212:215], a[128:131]
    v_mfma_f32_16x16x32_bf16 a[132:135], v[224:227], v[216:219], a[132:135]
    buffer_load_dwordx4 v[80:83], v238, s[8:11], s60 offen
    v_mfma_f32_16x16x32_bf16 a[136:139], v[224:227], v[220:223], a[136:139]
    v_mfma_f32_16x16x32_bf16 a[140:143], v[228:231], v[196:199], a[140:143]
    v_perm_b32 v224, v95, v91, s34
    v_mfma_f32_16x16x32_bf16 a[144:147], v[228:231], v[200:203], a[144:147]
    v_perm_b32 v225, v103, v99, s34
    v_mfma_f32_16x16x32_bf16 a[148:151], v[228:231], v[204:207], a[148:151]
    v_perm_b32 v226, v111, v107, s34
    buffer_load_dwordx4 v[84:87], v239, s[8:11], s60 offen
    v_mfma_f32_16x16x32_bf16 a[152:155], v[228:231], v[208:211], a[152:155]
    v_perm_b32 v227, v119, v115, s34
    s_add_u32 s36, s36, 1048576
    s_cmp_ge_u32 s36, 5242880
    v_mfma_f32_16x16x32_bf16 a[156:159], v[228:231], v[212:215], a[156:159]
    s_cselect_b32 s36, 0, s36
    s_add_u32 s60, s36, s52
    v_mfma_f32_16x16x32_bf16 a[160:163], v[228:231], v[216:219], a[160:163]
    v_mfma_f32_16x16x32_bf16 a[164:167], v[228:231], v[220:223], a[164:167]
    s_mov_b32 m0, s26
    v_mfma_f32_16x16x32_bf16 a[168:171], v[224:227], v[196:199], a[168:171]
    v_perm_b32 v228, v95, v91, s35
    buffer_load_dwordx4 v5, s[16:19], s42 offen offset:3072 nt lds
    v_mfma_f32_16x16x32_bf16 a[172:175], v[224:227], v[200:203], a[172:175]
    v_perm_b32 v229, v103, v99, s35
    v_mfma_f32_16x16x32_bf16 a[176:179], v[224:227], v[204:207], a[176:179]
    v_perm_b32 v230, v111, v107, s35
    v_mfma_f32_16x16x32_bf16 a[180:183], v[224:227], v[208:211], a[180:183]
    v_perm_b32 v231, v119, v115, s35
    s_mov_b32 m0, s27
    v_mfma_f32_16x16x32_bf16 a[184:187], v[224:227], v[212:215], a[184:187]
    s_movk_i32 s42, 20480
    buffer_load_dwordx4 v2, s[16:19], s42 offen offset:0 nt lds
    v_mfma_f32_16x16x32_bf16 a[188:191], v[224:227], v[216:219], a[188:191]
    v_mfma_f32_16x16x32_bf16 a[192:195], v[224:227], v[220:223], a[192:195]
    v_mfma_f32_16x16x32_bf16 a[196:199], v[228:231], v[196:199], a[196:199]
    s_waitcnt vmcnt(12)
    s_mov_b32 m0, s27
    v_mfma_f32_16x16x32_bf16 a[200:203], v[228:231], v[200:203], a[200:203]
    v_perm_b32 v224, v28, v24, s34
    buffer_load_dwordx4 v3, s[16:19], s42 offen offset:1024 nt lds
    v_mfma_f32_16x16x32_bf16 a[204:207], v[228:231], v[204:207], a[204:207]
    v_perm_b32 v225, v36, v32, s34
    v_mfma_f32_16x16x32_bf16 a[208:211], v[228:231], v[208:211], a[208:211]
    v_perm_b32 v226, v44, v40, s34
    v_mfma_f32_16x16x32_bf16 a[212:215], v[228:231], v[212:215], a[212:215]
    v_perm_b32 v227, v52, v48, s34
    v_mfma_f32_16x16x32_bf16 a[216:219], v[228:231], v[216:219], a[216:219]
    v_mfma_f32_16x16x32_bf16 a[220:223], v[228:231], v[220:223], a[220:223]
    s_waitcnt lgkmcnt(0)
    v_mfma_f32_16x16x32_bf16 a[0:3], v[224:227], v[168:171], a[0:3]
    v_perm_b32 v228, v28, v24, s35
    v_mfma_f32_16x16x32_bf16 a[4:7], v[224:227], v[172:175], a[4:7]
    v_perm_b32 v229, v36, v32, s35
    v_mfma_f32_16x16x32_bf16 a[8:11], v[224:227], v[176:179], a[8:11]
    v_perm_b32 v230, v44, v40, s35
    v_mfma_f32_16x16x32_bf16 a[12:15], v[224:227], v[180:183], a[12:15]
    v_perm_b32 v231, v52, v48, s35
    v_mfma_f32_16x16x32_bf16 a[16:19], v[224:227], v[184:187], a[16:19]
    v_mfma_f32_16x16x32_bf16 a[20:23], v[224:227], v[188:191], a[20:23]
    v_mfma_f32_16x16x32_bf16 a[24:27], v[224:227], v[192:195], a[24:27]
    v_mfma_f32_16x16x32_bf16 a[28:31], v[228:231], v[168:171], a[28:31]
    v_perm_b32 v224, v29, v25, s34
    v_mfma_f32_16x16x32_bf16 a[32:35], v[228:231], v[172:175], a[32:35]
    v_perm_b32 v225, v37, v33, s34
    v_mfma_f32_16x16x32_bf16 a[36:39], v[228:231], v[176:179], a[36:39]
    v_perm_b32 v226, v45, v41, s34
    v_mfma_f32_16x16x32_bf16 a[40:43], v[228:231], v[180:183], a[40:43]
    v_perm_b32 v227, v53, v49, s34
    v_mfma_f32_16x16x32_bf16 a[44:47], v[228:231], v[184:187], a[44:47]
    v_mfma_f32_16x16x32_bf16 a[48:51], v[228:231], v[188:191], a[48:51]
    v_mfma_f32_16x16x32_bf16 a[52:55], v[228:231], v[192:195], a[52:55]
    v_mfma_f32_16x16x32_bf16 a[56:59], v[224:227], v[168:171], a[56:59]
    v_perm_b32 v228, v29, v25, s35
    v_mfma_f32_16x16x32_bf16 a[60:63], v[224:227], v[172:175], a[60:63]
    v_perm_b32 v229, v37, v33, s35
    v_mfma_f32_16x16x32_bf16 a[64:67], v[224:227], v[176:179], a[64:67]
    v_perm_b32 v230, v45, v41, s35
    v_mfma_f32_16x16x32_bf16 a[68:71], v[224:227], v[180:183], a[68:71]
    v_perm_b32 v231, v53, v49, s35
    v_mfma_f32_16x16x32_bf16 a[72:75], v[224:227], v[184:187], a[72:75]
    v_mfma_f32_16x16x32_bf16 a[76:79], v[224:227], v[188:191], a[76:79]
    v_mfma_f32_16x16x32_bf16 a[80:83], v[224:227], v[192:195], a[80:83]
    v_mfma_f32_16x16x32_bf16 a[84:87], v[228:231], v[168:171], a[84:87]
    v_perm_b32 v224, v30, v26, s34
    ds_read_b128 v[196:199], v243 offset:16384
    v_mfma_f32_16x16x32_bf16 a[88:91], v[228:231], v[172:175], a[88:91]
    v_perm_b32 v225, v38, v34, s34
    v_mfma_f32_16x16x32_bf16 a[92:95], v[228:231], v[176:179], a[92:95]
    v_perm_b32 v226, v46, v42, s34
    ds_read_b128 v[200:203], v243 offset:18432
    v_mfma_f32_16x16x32_bf16 a[96:99], v[228:231], v[180:183], a[96:99]
    v_perm_b32 v227, v54, v50, s34
    ds_read_b128 v[204:207], v243 offset:20480
    v_mfma_f32_16x16x32_bf16 a[100:103], v[228:231], v[184:187], a[100:103]
    ds_read_b128 v[208:211], v243 offset:22528
    s_mov_b32 m0, s27
    v_mfma_f32_16x16x32_bf16 a[104:107], v[228:231], v[188:191], a[104:107]
    ds_read_b128 v[212:215], v243 offset:24576
    buffer_load_dwordx4 v4, s[16:19], s42 offen offset:2048 nt lds
    v_mfma_f32_16x16x32_bf16 a[108:111], v[228:231], v[192:195], a[108:111]
    v_mfma_f32_16x16x32_bf16 a[112:115], v[224:227], v[168:171], a[112:115]
    v_perm_b32 v228, v30, v26, s35
    ds_read_b128 v[216:219], v243 offset:26624
    v_mfma_f32_16x16x32_bf16 a[116:119], v[224:227], v[172:175], a[116:119]
    v_perm_b32 v229, v38, v34, s35
    ds_read_b128 v[220:223], v243 offset:28672
    v_mfma_f32_16x16x32_bf16 a[120:123], v[224:227], v[176:179], a[120:123]
    v_perm_b32 v230, v46, v42, s35
    v_mfma_f32_16x16x32_bf16 a[124:127], v[224:227], v[180:183], a[124:127]
    v_perm_b32 v231, v54, v50, s35
    v_mfma_f32_16x16x32_bf16 a[128:131], v[224:227], v[184:187], a[128:131]
    v_mfma_f32_16x16x32_bf16 a[132:135], v[224:227], v[188:191], a[132:135]
    v_mfma_f32_16x16x32_bf16 a[136:139], v[224:227], v[192:195], a[136:139]
    v_mfma_f32_16x16x32_bf16 a[140:143], v[228:231], v[168:171], a[140:143]
    v_perm_b32 v224, v31, v27, s34
    v_mfma_f32_16x16x32_bf16 a[144:147], v[228:231], v[172:175], a[144:147]
    v_perm_b32 v225, v39, v35, s34
    v_mfma_f32_16x16x32_bf16 a[148:151], v[228:231], v[176:179], a[148:151]
    v_perm_b32 v226, v47, v43, s34
    v_mfma_f32_16x16x32_bf16 a[152:155], v[228:231], v[180:183], a[152:155]
    v_perm_b32 v227, v55, v51, s34
    v_mfma_f32_16x16x32_bf16 a[156:159], v[228:231], v[184:187], a[156:159]
    s_mov_b32 m0, s27
    v_mfma_f32_16x16x32_bf16 a[160:163], v[228:231], v[188:191], a[160:163]
    buffer_load_dwordx4 v5, s[16:19], s42 offen offset:3072 nt lds
    v_mfma_f32_16x16x32_bf16 a[164:167], v[228:231], v[192:195], a[164:167]
    v_mfma_f32_16x16x32_bf16 a[168:171], v[224:227], v[168:171], a[168:171]
    v_perm_b32 v228, v31, v27, s35
    v_mfma_f32_16x16x32_bf16 a[172:175], v[224:227], v[172:175], a[172:175]
    v_perm_b32 v229, v39, v35, s35
    v_mfma_f32_16x16x32_bf16 a[176:179], v[224:227], v[176:179], a[176:179]
    v_perm_b32 v230, v47, v43, s35
    v_mfma_f32_16x16x32_bf16 a[180:183], v[224:227], v[180:183], a[180:183]
    v_perm_b32 v231, v55, v51, s35
    v_mfma_f32_16x16x32_bf16 a[184:187], v[224:227], v[184:187], a[184:187]
    v_mfma_f32_16x16x32_bf16 a[188:191], v[224:227], v[188:191], a[188:191]
    v_mfma_f32_16x16x32_bf16 a[192:195], v[224:227], v[192:195], a[192:195]
    v_mfma_f32_16x16x32_bf16 a[196:199], v[228:231], v[168:171], a[196:199]
    s_waitcnt vmcnt(5)
    v_mfma_f32_16x16x32_bf16 a[200:203], v[228:231], v[172:175], a[200:203]
    v_perm_b32 v224, v60, v56, s34
    v_mfma_f32_16x16x32_bf16 a[204:207], v[228:231], v[176:179], a[204:207]
    v_perm_b32 v225, v68, v64, s34
    v_mfma_f32_16x16x32_bf16 a[208:211], v[228:231], v[180:183], a[208:211]
    v_perm_b32 v226, v76, v72, s34
    v_mfma_f32_16x16x32_bf16 a[212:215], v[228:231], v[184:187], a[212:215]
    v_perm_b32 v227, v84, v80, s34
    v_mfma_f32_16x16x32_bf16 a[216:219], v[228:231], v[188:191], a[216:219]
    v_mfma_f32_16x16x32_bf16 a[220:223], v[228:231], v[192:195], a[220:223]
    s_waitcnt lgkmcnt(0)
    v_mfma_f32_16x16x32_bf16 a[0:3], v[224:227], v[196:199], a[0:3]
    v_perm_b32 v228, v60, v56, s35
    v_mfma_f32_16x16x32_bf16 a[4:7], v[224:227], v[200:203], a[4:7]
    v_perm_b32 v229, v68, v64, s35
    v_mfma_f32_16x16x32_bf16 a[8:11], v[224:227], v[204:207], a[8:11]
    v_perm_b32 v230, v76, v72, s35
    v_mfma_f32_16x16x32_bf16 a[12:15], v[224:227], v[208:211], a[12:15]
    v_perm_b32 v231, v84, v80, s35
    v_mfma_f32_16x16x32_bf16 a[16:19], v[224:227], v[212:215], a[16:19]
    v_mfma_f32_16x16x32_bf16 a[20:23], v[224:227], v[216:219], a[20:23]
    v_mfma_f32_16x16x32_bf16 a[24:27], v[224:227], v[220:223], a[24:27]
    v_mfma_f32_16x16x32_bf16 a[28:31], v[228:231], v[196:199], a[28:31]
    v_perm_b32 v224, v61, v57, s34
    v_mfma_f32_16x16x32_bf16 a[32:35], v[228:231], v[200:203], a[32:35]
    v_perm_b32 v225, v69, v65, s34
    v_mfma_f32_16x16x32_bf16 a[36:39], v[228:231], v[204:207], a[36:39]
    v_perm_b32 v226, v77, v73, s34
    v_mfma_f32_16x16x32_bf16 a[40:43], v[228:231], v[208:211], a[40:43]
    v_perm_b32 v227, v85, v81, s34
    v_mfma_f32_16x16x32_bf16 a[44:47], v[228:231], v[212:215], a[44:47]
    v_mfma_f32_16x16x32_bf16 a[48:51], v[228:231], v[216:219], a[48:51]
    v_mfma_f32_16x16x32_bf16 a[52:55], v[228:231], v[220:223], a[52:55]
    v_mfma_f32_16x16x32_bf16 a[56:59], v[224:227], v[196:199], a[56:59]
    v_perm_b32 v228, v61, v57, s35
    v_mfma_f32_16x16x32_bf16 a[60:63], v[224:227], v[200:203], a[60:63]
    v_perm_b32 v229, v69, v65, s35
    v_mfma_f32_16x16x32_bf16 a[64:67], v[224:227], v[204:207], a[64:67]
    v_perm_b32 v230, v77, v73, s35
    v_mfma_f32_16x16x32_bf16 a[68:71], v[224:227], v[208:211], a[68:71]
    v_perm_b32 v231, v85, v81, s35
    v_mfma_f32_16x16x32_bf16 a[72:75], v[224:227], v[212:215], a[72:75]
    v_mfma_f32_16x16x32_bf16 a[76:79], v[224:227], v[216:219], a[76:79]
    v_mfma_f32_16x16x32_bf16 a[80:83], v[224:227], v[220:223], a[80:83]
    s_barrier
    v_mfma_f32_16x16x32_bf16 a[84:87], v[228:231], v[196:199], a[84:87]
    v_perm_b32 v224, v62, v58, s34
    v_mfma_f32_16x16x32_bf16 a[88:91], v[228:231], v[200:203], a[88:91]
    v_perm_b32 v225, v70, v66, s34
    v_mfma_f32_16x16x32_bf16 a[92:95], v[228:231], v[204:207], a[92:95]
    v_perm_b32 v226, v78, v74, s34
    v_mfma_f32_16x16x32_bf16 a[96:99], v[228:231], v[208:211], a[96:99]
    v_perm_b32 v227, v86, v82, s34
    v_mfma_f32_16x16x32_bf16 a[100:103], v[228:231], v[212:215], a[100:103]
    s_add_u32 m0, s63, 0
    v_mfma_f32_16x16x32_bf16 a[104:107], v[228:231], v[216:219], a[104:107]
    buffer_load_dwordx4 v244, s[76:79], 0 offen lds
    v_mfma_f32_16x16x32_bf16 a[108:111], v[228:231], v[220:223], a[108:111]
    v_mfma_f32_16x16x32_bf16 a[112:115], v[224:227], v[196:199], a[112:115]
    v_perm_b32 v228, v62, v58, s35
    v_mfma_f32_16x16x32_bf16 a[116:119], v[224:227], v[200:203], a[116:119]
    v_perm_b32 v229, v70, v66, s35
    v_mfma_f32_16x16x32_bf16 a[120:123], v[224:227], v[204:207], a[120:123]
    v_perm_b32 v230, v78, v74, s35
    s_add_u32 m0, s63, 1024
    v_mfma_f32_16x16x32_bf16 a[124:127], v[224:227], v[208:211], a[124:127]
    v_perm_b32 v231, v86, v82, s35
    buffer_load_dwordx4 v245, s[76:79], 0 offen lds
    v_mfma_f32_16x16x32_bf16 a[128:131], v[224:227], v[212:215], a[128:131]
    v_mfma_f32_16x16x32_bf16 a[132:135], v[224:227], v[216:219], a[132:135]
    v_mfma_f32_16x16x32_bf16 a[136:139], v[224:227], v[220:223], a[136:139]
    v_mfma_f32_16x16x32_bf16 a[140:143], v[228:231], v[196:199], a[140:143]
    v_perm_b32 v224, v63, v59, s34
    v_mfma_f32_16x16x32_bf16 a[144:147], v[228:231], v[200:203], a[144:147]
    v_perm_b32 v225, v71, v67, s34
    s_add_u32 m0, s63, 2048
    v_mfma_f32_16x16x32_bf16 a[148:151], v[228:231], v[204:207], a[148:151]
    v_perm_b32 v226, v79, v75, s34
    buffer_load_dwordx4 v246, s[76:79], 0 offen lds
    v_mfma_f32_16x16x32_bf16 a[152:155], v[228:231], v[208:211], a[152:155]
    v_perm_b32 v227, v87, v83, s34
    v_mfma_f32_16x16x32_bf16 a[156:159], v[228:231], v[212:215], a[156:159]
    v_mfma_f32_16x16x32_bf16 a[160:163], v[228:231], v[216:219], a[160:163]
    v_mfma_f32_16x16x32_bf16 a[164:167], v[228:231], v[220:223], a[164:167]
    s_add_u32 m0, s63, 3072
    v_mfma_f32_16x16x32_bf16 a[168:171], v[224:227], v[196:199], a[168:171]
    v_perm_b32 v228, v63, v59, s35
    buffer_load_dwordx4 v247, s[76:79], 0 offen lds
    v_mfma_f32_16x16x32_bf16 a[172:175], v[224:227], v[200:203], a[172:175]
    v_perm_b32 v229, v71, v67, s35
    v_mfma_f32_16x16x32_bf16 a[176:179], v[224:227], v[204:207], a[176:179]
    v_perm_b32 v230, v79, v75, s35
    v_mfma_f32_16x16x32_bf16 a[180:183], v[224:227], v[208:211], a[180:183]
    v_perm_b32 v231, v87, v83, s35
    v_mfma_f32_16x16x32_bf16 a[184:187], v[224:227], v[212:215], a[184:187]
    v_mfma_f32_16x16x32_bf16 a[188:191], v[224:227], v[216:219], a[188:191]
    s_add_u32 m0, s63, 4096
    v_mfma_f32_16x16x32_bf16 a[192:195], v[224:227], v[220:223], a[192:195]
    buffer_load_dwordx4 v248, s[76:79], 0 offen lds
    v_mfma_f32_16x16x32_bf16 a[196:199], v[228:231], v[196:199], a[196:199]
    v_mfma_f32_16x16x32_bf16 a[200:203], v[228:231], v[200:203], a[200:203]
    v_mfma_f32_16x16x32_bf16 a[204:207], v[228:231], v[204:207], a[204:207]
    v_mfma_f32_16x16x32_bf16 a[208:211], v[228:231], v[208:211], a[208:211]
    v_mfma_f32_16x16x32_bf16 a[212:215], v[228:231], v[212:215], a[212:215]
    v_mfma_f32_16x16x32_bf16 a[216:219], v[228:231], v[216:219], a[216:219]
    v_mfma_f32_16x16x32_bf16 a[220:223], v[228:231], v[220:223], a[220:223]
    s_movk_i32 s42, 24576
    s_movk_i32 s43, 28672
    s_movk_i32 s44, 24576
    s_movk_i32 s45, 28672
    v_mov_b32 v252, s33
    v_mov_b32 v253, s33
    v_accvgpr_read_b32 v204, a0
    v_accvgpr_read_b32 v205, a28
    v_pk_mul_f32 v[204:205], v[204:205], v[252:253]
    v_cvt_pk_bf16_f32 v24, v204, v205
    v_accvgpr_read_b32 v206, a56
    v_accvgpr_read_b32 v207, a84
    v_pk_mul_f32 v[206:207], v[206:207], v[252:253]
    v_cvt_pk_bf16_f32 v25, v206, v207
    v_accvgpr_read_b32 v208, a112
    v_accvgpr_read_b32 v209, a140
    v_pk_mul_f32 v[208:209], v[208:209], v[252:253]
    v_cvt_pk_bf16_f32 v26, v208, v209
    v_accvgpr_read_b32 v210, a168
    v_accvgpr_read_b32 v211, a196
    v_pk_mul_f32 v[210:211], v[210:211], v[252:253]
    v_cvt_pk_bf16_f32 v27, v210, v211
    v_accvgpr_read_b32 v204, a1
    v_accvgpr_read_b32 v205, a29
    v_pk_mul_f32 v[204:205], v[204:205], v[252:253]
    v_cvt_pk_bf16_f32 v28, v204, v205
    v_accvgpr_read_b32 v206, a57
    v_accvgpr_read_b32 v207, a85
    v_pk_mul_f32 v[206:207], v[206:207], v[252:253]
    v_cvt_pk_bf16_f32 v29, v206, v207
    v_accvgpr_read_b32 v208, a113
    v_accvgpr_read_b32 v209, a141
    v_pk_mul_f32 v[208:209], v[208:209], v[252:253]
    v_cvt_pk_bf16_f32 v30, v208, v209
    v_accvgpr_read_b32 v210, a169
    v_accvgpr_read_b32 v211, a197
    v_pk_mul_f32 v[210:211], v[210:211], v[252:253]
    v_cvt_pk_bf16_f32 v31, v210, v211
    v_accvgpr_read_b32 v204, a2
    v_accvgpr_read_b32 v205, a30
    v_pk_mul_f32 v[204:205], v[204:205], v[252:253]
    v_cvt_pk_bf16_f32 v32, v204, v205
    v_accvgpr_read_b32 v206, a58
    v_accvgpr_read_b32 v207, a86
    v_pk_mul_f32 v[206:207], v[206:207], v[252:253]
    v_cvt_pk_bf16_f32 v33, v206, v207
    v_accvgpr_read_b32 v208, a114
    v_accvgpr_read_b32 v209, a142
    v_pk_mul_f32 v[208:209], v[208:209], v[252:253]
    v_cvt_pk_bf16_f32 v34, v208, v209
    v_accvgpr_read_b32 v210, a170
    v_accvgpr_read_b32 v211, a198
    v_pk_mul_f32 v[210:211], v[210:211], v[252:253]
    v_cvt_pk_bf16_f32 v35, v210, v211
    v_accvgpr_read_b32 v204, a3
    v_accvgpr_read_b32 v205, a31
    v_pk_mul_f32 v[204:205], v[204:205], v[252:253]
    v_cvt_pk_bf16_f32 v36, v204, v205
    v_accvgpr_read_b32 v206, a59
    v_accvgpr_read_b32 v207, a87
    v_pk_mul_f32 v[206:207], v[206:207], v[252:253]
    v_cvt_pk_bf16_f32 v37, v206, v207
    v_accvgpr_read_b32 v208, a115
    v_accvgpr_read_b32 v209, a143
    v_pk_mul_f32 v[208:209], v[208:209], v[252:253]
    v_cvt_pk_bf16_f32 v38, v208, v209
    v_accvgpr_read_b32 v210, a171
    v_accvgpr_read_b32 v211, a199
    v_pk_mul_f32 v[210:211], v[210:211], v[252:253]
    v_cvt_pk_bf16_f32 v39, v210, v211
    v_accvgpr_read_b32 v204, a4
    v_accvgpr_read_b32 v205, a32
    v_pk_mul_f32 v[204:205], v[204:205], v[252:253]
    v_cvt_pk_bf16_f32 v40, v204, v205
    v_mfma_f32_16x16x32_bf16 v[168:171], a[224:227], v[24:27], 0
    v_accvgpr_read_b32 v206, a60
    v_accvgpr_read_b32 v207, a88
    v_pk_mul_f32 v[206:207], v[206:207], v[252:253]
    v_cvt_pk_bf16_f32 v41, v206, v207
    v_accvgpr_read_b32 v208, a116
    v_accvgpr_read_b32 v209, a144
    v_pk_mul_f32 v[208:209], v[208:209], v[252:253]
    v_cvt_pk_bf16_f32 v42, v208, v209
    v_mfma_f32_16x16x32_bf16 v[168:171], a[228:231], v[28:31], v[168:171]
    v_accvgpr_read_b32 v210, a172
    v_accvgpr_read_b32 v211, a200
    v_pk_mul_f32 v[210:211], v[210:211], v[252:253]
    v_cvt_pk_bf16_f32 v43, v210, v211
    v_accvgpr_read_b32 v204, a5
    v_accvgpr_read_b32 v205, a33
    v_pk_mul_f32 v[204:205], v[204:205], v[252:253]
    v_cvt_pk_bf16_f32 v44, v204, v205
    v_mfma_f32_16x16x32_bf16 v[168:171], a[232:235], v[32:35], v[168:171]
    v_accvgpr_read_b32 v206, a61
    v_accvgpr_read_b32 v207, a89
    v_pk_mul_f32 v[206:207], v[206:207], v[252:253]
    v_cvt_pk_bf16_f32 v45, v206, v207
    v_accvgpr_read_b32 v208, a117
    v_accvgpr_read_b32 v209, a145
    v_pk_mul_f32 v[208:209], v[208:209], v[252:253]
    v_cvt_pk_bf16_f32 v46, v208, v209
    v_mfma_f32_16x16x32_bf16 v[168:171], a[236:239], v[36:39], v[168:171]
    v_accvgpr_read_b32 v210, a173
    v_accvgpr_read_b32 v211, a201
    v_pk_mul_f32 v[210:211], v[210:211], v[252:253]
    v_cvt_pk_bf16_f32 v47, v210, v211
    v_accvgpr_read_b32 v204, a6
    v_accvgpr_read_b32 v205, a34
    v_pk_mul_f32 v[204:205], v[204:205], v[252:253]
    v_cvt_pk_bf16_f32 v48, v204, v205
    v_mfma_f32_16x16x32_bf16 v[172:175], a[240:243], v[24:27], 0
    v_accvgpr_read_b32 v206, a62
    v_accvgpr_read_b32 v207, a90
    v_pk_mul_f32 v[206:207], v[206:207], v[252:253]
    v_cvt_pk_bf16_f32 v49, v206, v207
    v_accvgpr_read_b32 v208, a118
    v_accvgpr_read_b32 v209, a146
    v_pk_mul_f32 v[208:209], v[208:209], v[252:253]
    v_cvt_pk_bf16_f32 v50, v208, v209
    v_mfma_f32_16x16x32_bf16 v[172:175], a[244:247], v[28:31], v[172:175]
    v_accvgpr_read_b32 v210, a174
    v_accvgpr_read_b32 v211, a202
    v_pk_mul_f32 v[210:211], v[210:211], v[252:253]
    v_cvt_pk_bf16_f32 v51, v210, v211
    v_accvgpr_read_b32 v204, a7
    v_accvgpr_read_b32 v205, a35
    v_pk_mul_f32 v[204:205], v[204:205], v[252:253]
    v_cvt_pk_bf16_f32 v52, v204, v205
    v_mfma_f32_16x16x32_bf16 v[172:175], a[248:251], v[32:35], v[172:175]
    v_accvgpr_read_b32 v206, a63
    v_accvgpr_read_b32 v207, a91
    v_pk_mul_f32 v[206:207], v[206:207], v[252:253]
    v_cvt_pk_bf16_f32 v53, v206, v207
    v_accvgpr_read_b32 v208, a119
    v_accvgpr_read_b32 v209, a147
    v_pk_mul_f32 v[208:209], v[208:209], v[252:253]
    v_cvt_pk_bf16_f32 v54, v208, v209
    v_mfma_f32_16x16x32_bf16 v[172:175], a[252:255], v[36:39], v[172:175]
    v_accvgpr_read_b32 v210, a175
    v_accvgpr_read_b32 v211, a203
    v_pk_mul_f32 v[210:211], v[210:211], v[252:253]
    v_cvt_pk_bf16_f32 v55, v210, v211
    v_accvgpr_read_b32 v204, a8
    v_max3_f32 v18, v168, v169, v170
    v_accvgpr_read_b32 v205, a36
    s_nop 0
    v_max3_f32 v18, v18, v171, v172
    v_pk_mul_f32 v[204:205], v[204:205], v[252:253]
    v_cvt_pk_bf16_f32 v56, v204, v205
    v_max3_f32 v18, v18, v173, v174
    v_mfma_f32_16x16x32_bf16 v[176:179], a[224:227], v[40:43], 0
    v_accvgpr_read_b32 v206, a64
    v_max_f32 v18, v18, v175
    v_accvgpr_read_b32 v207, a92
    v_pk_mul_f32 v[206:207], v[206:207], v[252:253]
    v_mov_b32 v19, v18
    v_cvt_pk_bf16_f32 v57, v206, v207
    s_nop 0
    v_permlane16_swap_b32 v18, v19
    v_accvgpr_read_b32 v208, a120
    v_accvgpr_read_b32 v209, a148
    v_max_f32 v18, v18, v19
    v_pk_mul_f32 v[208:209], v[208:209], v[252:253]
    v_mov_b32 v19, v18
    v_cvt_pk_bf16_f32 v58, v208, v209
    v_mfma_f32_16x16x32_bf16 v[176:179], a[228:231], v[44:47], v[176:179]
    v_accvgpr_read_b32 v210, a176
    v_permlane32_swap_b32 v18, v19
    v_accvgpr_read_b32 v211, a204
    v_max_f32 v18, v18, v19
    v_pk_mul_f32 v[210:211], v[210:211], v[252:253]
    v_cvt_pk_bf16_f32 v59, v210, v211
    v_sub_f32 v212, 0, v18
    v_accvgpr_read_b32 v204, a9
    v_sub_f32 v213, 0, v18
    v_accvgpr_read_b32 v205, a37
    v_pk_mul_f32 v[204:205], v[204:205], v[252:253]
    v_sub_f32 v214, 0, v18
    v_cvt_pk_bf16_f32 v60, v204, v205
    v_mfma_f32_16x16x32_bf16 v[176:179], a[232:235], v[48:51], v[176:179]
    v_sub_f32 v215, 0, v18
    v_accvgpr_read_b32 v206, a65
    v_accvgpr_read_b32 v207, a93
    v_mov_b32 v247, 0
    v_pk_mul_f32 v[206:207], v[206:207], v[252:253]
    v_add_f32 v168, v168, v212
    v_cvt_pk_bf16_f32 v61, v206, v207
    v_accvgpr_read_b32 v208, a121
    v_add_f32 v169, v169, v212
    v_accvgpr_read_b32 v209, a149
    v_add_f32 v170, v170, v212
    v_pk_mul_f32 v[208:209], v[208:209], v[252:253]
    v_cvt_pk_bf16_f32 v62, v208, v209
    v_add_f32 v171, v171, v212
    v_mfma_f32_16x16x32_bf16 v[176:179], a[236:239], v[52:55], v[176:179]
    v_accvgpr_read_b32 v210, a177
    v_add_f32 v172, v172, v212
    v_accvgpr_read_b32 v211, a205
    v_pk_mul_f32 v[210:211], v[210:211], v[252:253]
    v_add_f32 v173, v173, v212
    v_cvt_pk_bf16_f32 v63, v210, v211
    v_add_f32 v174, v174, v212
    v_accvgpr_read_b32 v204, a10
    v_add_f32 v175, v175, v212
    v_accvgpr_read_b32 v205, a38
    v_pk_mul_f32 v[204:205], v[204:205], v[252:253]
    v_exp_f32 v168, v168
    v_cvt_pk_bf16_f32 v64, v204, v205
    v_mfma_f32_16x16x32_bf16 v[180:183], a[240:243], v[40:43], 0
    v_exp_f32 v169, v169
    v_accvgpr_read_b32 v206, a66
    v_accvgpr_read_b32 v207, a94
    v_exp_f32 v170, v170
    v_pk_mul_f32 v[206:207], v[206:207], v[252:253]
    v_add_f32 v20, v168, v169
    v_cvt_pk_bf16_f32 v65, v206, v207
    v_accvgpr_read_b32 v208, a122
    v_exp_f32 v171, v171
    v_accvgpr_read_b32 v209, a150
    v_exp_f32 v172, v172
    v_pk_mul_f32 v[208:209], v[208:209], v[252:253]
    v_cvt_pk_bf16_f32 v66, v208, v209
    v_add_f32 v21, v170, v171
    v_mfma_f32_16x16x32_bf16 v[180:183], a[244:247], v[44:47], v[180:183]
    v_accvgpr_read_b32 v210, a178
    v_exp_f32 v173, v173
    v_accvgpr_read_b32 v211, a206
    v_pk_mul_f32 v[210:211], v[210:211], v[252:253]
    v_add_f32 v20, v20, v21
    v_cvt_pk_bf16_f32 v67, v210, v211
    v_exp_f32 v174, v174
    v_accvgpr_read_b32 v204, a11
    v_accvgpr_read_b32 v205, a39
    v_add_f32 v22, v172, v173
    v_pk_mul_f32 v[204:205], v[204:205], v[252:253]
    v_exp_f32 v175, v175
    v_cvt_pk_bf16_f32 v68, v204, v205
    v_mfma_f32_16x16x32_bf16 v[180:183], a[248:251], v[48:51], v[180:183]
    v_accvgpr_read_b32 v206, a67
    v_add_f32 v20, v20, v247
    v_accvgpr_read_b32 v207, a95
    v_cvt_pk_bf16_f32 v184, v168, v169
    v_pk_mul_f32 v[206:207], v[206:207], v[252:253]
    v_cvt_pk_bf16_f32 v69, v206, v207
    v_add_f32 v240, v174, v175
    v_accvgpr_read_b32 v208, a123
    v_cvt_pk_bf16_f32 v185, v170, v171
    v_accvgpr_read_b32 v209, a151
    v_pk_mul_f32 v[208:209], v[208:209], v[252:253]
    v_add_f32 v240, v240, v22
    v_cvt_pk_bf16_f32 v70, v208, v209
    v_mfma_f32_16x16x32_bf16 v[180:183], a[252:255], v[52:55], v[180:183]
    v_cvt_pk_bf16_f32 v186, v172, v173
    v_accvgpr_read_b32 v210, a179
    v_accvgpr_read_b32 v211, a207
    v_add_f32 v240, v240, v20
    v_pk_mul_f32 v[210:211], v[210:211], v[252:253]
    v_cvt_pk_bf16_f32 v187, v174, v175
    v_cvt_pk_bf16_f32 v71, v210, v211
    v_accvgpr_read_b32 v204, a12
    v_max3_f32 v18, v176, v177, v178
    v_accvgpr_read_b32 v205, a40
    v_max3_f32 v18, v18, v179, v180
    v_pk_mul_f32 v[204:205], v[204:205], v[252:253]
    v_cvt_pk_bf16_f32 v72, v204, v205
    v_max3_f32 v18, v18, v181, v182
    v_mfma_f32_16x16x32_bf16 v[168:171], a[224:227], v[56:59], 0
    v_accvgpr_read_b32 v206, a68
    v_max_f32 v18, v18, v183
    v_accvgpr_read_b32 v207, a96
    v_pk_mul_f32 v[206:207], v[206:207], v[252:253]
    v_mov_b32 v19, v18
    v_cvt_pk_bf16_f32 v73, v206, v207
    s_nop 0
    v_permlane16_swap_b32 v18, v19
    v_accvgpr_read_b32 v208, a124
    v_accvgpr_read_b32 v209, a152
    v_max_f32 v18, v18, v19
    v_pk_mul_f32 v[208:209], v[208:209], v[252:253]
    v_mov_b32 v19, v18
    v_cvt_pk_bf16_f32 v74, v208, v209
    v_mfma_f32_16x16x32_bf16 v[168:171], a[228:231], v[60:63], v[168:171]
    v_accvgpr_read_b32 v210, a180
    v_permlane32_swap_b32 v18, v19
    v_accvgpr_read_b32 v211, a208
    v_max_f32 v18, v18, v19
    v_pk_mul_f32 v[210:211], v[210:211], v[252:253]
    v_cvt_pk_bf16_f32 v75, v210, v211
    v_sub_f32 v216, 0, v18
    v_accvgpr_read_b32 v204, a13
    v_sub_f32 v217, 0, v18
    v_accvgpr_read_b32 v205, a41
    v_pk_mul_f32 v[204:205], v[204:205], v[252:253]
    v_sub_f32 v218, 0, v18
    v_cvt_pk_bf16_f32 v76, v204, v205
    v_mfma_f32_16x16x32_bf16 v[168:171], a[232:235], v[64:67], v[168:171]
    v_sub_f32 v219, 0, v18
    v_accvgpr_read_b32 v206, a69
    v_accvgpr_read_b32 v207, a97
    v_mov_b32 v248, 0
    v_pk_mul_f32 v[206:207], v[206:207], v[252:253]
    v_add_f32 v176, v176, v216
    v_cvt_pk_bf16_f32 v77, v206, v207
    v_accvgpr_read_b32 v208, a125
    v_add_f32 v177, v177, v216
    v_accvgpr_read_b32 v209, a153
    v_add_f32 v178, v178, v216
    v_pk_mul_f32 v[208:209], v[208:209], v[252:253]
    v_cvt_pk_bf16_f32 v78, v208, v209
    v_add_f32 v179, v179, v216
    v_mfma_f32_16x16x32_bf16 v[168:171], a[236:239], v[68:71], v[168:171]
    v_accvgpr_read_b32 v210, a181
    v_add_f32 v180, v180, v216
    v_accvgpr_read_b32 v211, a209
    v_pk_mul_f32 v[210:211], v[210:211], v[252:253]
    v_add_f32 v181, v181, v216
    v_cvt_pk_bf16_f32 v79, v210, v211
    v_add_f32 v182, v182, v216
    v_accvgpr_read_b32 v204, a14
    v_add_f32 v183, v183, v216
    v_accvgpr_read_b32 v205, a42
    v_pk_mul_f32 v[204:205], v[204:205], v[252:253]
    v_exp_f32 v176, v176
    v_cvt_pk_bf16_f32 v80, v204, v205
    v_mfma_f32_16x16x32_bf16 v[172:175], a[240:243], v[56:59], 0
    v_exp_f32 v177, v177
    v_accvgpr_read_b32 v206, a70
    v_accvgpr_read_b32 v207, a98
    v_exp_f32 v178, v178
    v_pk_mul_f32 v[206:207], v[206:207], v[252:253]
    v_add_f32 v20, v176, v177
    v_cvt_pk_bf16_f32 v81, v206, v207
    v_accvgpr_read_b32 v208, a126
    v_exp_f32 v179, v179
    v_accvgpr_read_b32 v209, a154
    v_exp_f32 v180, v180
    v_pk_mul_f32 v[208:209], v[208:209], v[252:253]
    v_cvt_pk_bf16_f32 v82, v208, v209
    v_add_f32 v21, v178, v179
    v_mfma_f32_16x16x32_bf16 v[172:175], a[244:247], v[60:63], v[172:175]
    v_accvgpr_read_b32 v210, a182
    v_exp_f32 v181, v181
    v_accvgpr_read_b32 v211, a210
    v_pk_mul_f32 v[210:211], v[210:211], v[252:253]
    v_add_f32 v20, v20, v21
    v_cvt_pk_bf16_f32 v83, v210, v211
    v_exp_f32 v182, v182
    v_accvgpr_read_b32 v204, a15
    v_accvgpr_read_b32 v205, a43
    v_add_f32 v22, v180, v181
    v_pk_mul_f32 v[204:205], v[204:205], v[252:253]
    v_exp_f32 v183, v183
    v_cvt_pk_bf16_f32 v84, v204, v205
    v_mfma_f32_16x16x32_bf16 v[172:175], a[248:251], v[64:67], v[172:175]
    v_accvgpr_read_b32 v206, a71
    v_add_f32 v20, v20, v248
    v_accvgpr_read_b32 v207, a99
    v_cvt_pk_bf16_f32 v188, v176, v177
    v_pk_mul_f32 v[206:207], v[206:207], v[252:253]
    v_cvt_pk_bf16_f32 v85, v206, v207
    v_add_f32 v241, v182, v183
    v_accvgpr_read_b32 v208, a127
    v_cvt_pk_bf16_f32 v189, v178, v179
    v_accvgpr_read_b32 v209, a155
    v_pk_mul_f32 v[208:209], v[208:209], v[252:253]
    v_add_f32 v241, v241, v22
    v_cvt_pk_bf16_f32 v86, v208, v209
    v_mfma_f32_16x16x32_bf16 v[172:175], a[252:255], v[68:71], v[172:175]
    v_cvt_pk_bf16_f32 v190, v180, v181
    v_accvgpr_read_b32 v210, a183
    v_accvgpr_read_b32 v211, a211
    v_add_f32 v241, v241, v20
    v_pk_mul_f32 v[210:211], v[210:211], v[252:253]
    v_cvt_pk_bf16_f32 v191, v182, v183
    v_cvt_pk_bf16_f32 v87, v210, v211
    v_accvgpr_read_b32 v204, a16
    v_max3_f32 v18, v168, v169, v170
    v_accvgpr_read_b32 v205, a44
    v_max3_f32 v18, v18, v171, v172
    v_pk_mul_f32 v[204:205], v[204:205], v[252:253]
    v_cvt_pk_bf16_f32 v88, v204, v205
    v_max3_f32 v18, v18, v173, v174
    v_mfma_f32_16x16x32_bf16 v[176:179], a[224:227], v[72:75], 0
    v_accvgpr_read_b32 v206, a72
    v_max_f32 v18, v18, v175
    v_accvgpr_read_b32 v207, a100
    v_pk_mul_f32 v[206:207], v[206:207], v[252:253]
    v_mov_b32 v19, v18
    v_cvt_pk_bf16_f32 v89, v206, v207
    s_nop 0
    v_permlane16_swap_b32 v18, v19
    v_accvgpr_read_b32 v208, a128
    v_accvgpr_read_b32 v209, a156
    v_max_f32 v18, v18, v19
    v_pk_mul_f32 v[208:209], v[208:209], v[252:253]
    v_mov_b32 v19, v18
    v_cvt_pk_bf16_f32 v90, v208, v209
    v_mfma_f32_16x16x32_bf16 v[176:179], a[228:231], v[76:79], v[176:179]
    v_accvgpr_read_b32 v210, a184
    v_permlane32_swap_b32 v18, v19
    v_accvgpr_read_b32 v211, a212
    v_max_f32 v18, v18, v19
    v_pk_mul_f32 v[210:211], v[210:211], v[252:253]
    v_cvt_pk_bf16_f32 v91, v210, v211
    v_sub_f32 v220, 0, v18
    v_accvgpr_read_b32 v204, a17
    v_sub_f32 v221, 0, v18
    v_accvgpr_read_b32 v205, a45
    v_pk_mul_f32 v[204:205], v[204:205], v[252:253]
    v_sub_f32 v222, 0, v18
    v_cvt_pk_bf16_f32 v92, v204, v205
    v_mfma_f32_16x16x32_bf16 v[176:179], a[232:235], v[80:83], v[176:179]
    v_sub_f32 v223, 0, v18
    v_accvgpr_read_b32 v206, a73
    v_accvgpr_read_b32 v207, a101
    v_mov_b32 v249, 0
    v_pk_mul_f32 v[206:207], v[206:207], v[252:253]
    v_add_f32 v168, v168, v220
    v_cvt_pk_bf16_f32 v93, v206, v207
    v_accvgpr_read_b32 v208, a129
    v_add_f32 v169, v169, v220
    v_accvgpr_read_b32 v209, a157
    v_add_f32 v170, v170, v220
    v_pk_mul_f32 v[208:209], v[208:209], v[252:253]
    v_cvt_pk_bf16_f32 v94, v208, v209
    v_add_f32 v171, v171, v220
    v_mfma_f32_16x16x32_bf16 v[176:179], a[236:239], v[84:87], v[176:179]
    v_accvgpr_read_b32 v210, a185
    v_add_f32 v172, v172, v220
    v_accvgpr_read_b32 v211, a213
    v_pk_mul_f32 v[210:211], v[210:211], v[252:253]
    v_add_f32 v173, v173, v220
    v_cvt_pk_bf16_f32 v95, v210, v211
    v_add_f32 v174, v174, v220
    v_accvgpr_read_b32 v204, a18
    v_add_f32 v175, v175, v220
    v_accvgpr_read_b32 v205, a46
    v_pk_mul_f32 v[204:205], v[204:205], v[252:253]
    v_exp_f32 v168, v168
    v_cvt_pk_bf16_f32 v96, v204, v205
    v_mfma_f32_16x16x32_bf16 v[180:183], a[240:243], v[72:75], 0
    v_exp_f32 v169, v169
    v_accvgpr_read_b32 v206, a74
    v_accvgpr_read_b32 v207, a102
    v_exp_f32 v170, v170
    v_pk_mul_f32 v[206:207], v[206:207], v[252:253]
    v_add_f32 v20, v168, v169
    v_cvt_pk_bf16_f32 v97, v206, v207
    v_accvgpr_read_b32 v208, a130
    v_exp_f32 v171, v171
    v_accvgpr_read_b32 v209, a158
    v_exp_f32 v172, v172
    v_pk_mul_f32 v[208:209], v[208:209], v[252:253]
    v_cvt_pk_bf16_f32 v98, v208, v209
    v_add_f32 v21, v170, v171
    v_mfma_f32_16x16x32_bf16 v[180:183], a[244:247], v[76:79], v[180:183]
    v_accvgpr_read_b32 v210, a186
    v_exp_f32 v173, v173
    v_accvgpr_read_b32 v211, a214
    v_pk_mul_f32 v[210:211], v[210:211], v[252:253]
    v_add_f32 v20, v20, v21
    v_cvt_pk_bf16_f32 v99, v210, v211
    v_exp_f32 v174, v174
    v_accvgpr_read_b32 v204, a19
    v_accvgpr_read_b32 v205, a47
    v_add_f32 v22, v172, v173
    v_pk_mul_f32 v[204:205], v[204:205], v[252:253]
    v_exp_f32 v175, v175
    v_cvt_pk_bf16_f32 v100, v204, v205
    v_mfma_f32_16x16x32_bf16 v[180:183], a[248:251], v[80:83], v[180:183]
    v_accvgpr_read_b32 v206, a75
    v_add_f32 v20, v20, v249
    v_accvgpr_read_b32 v207, a103
    v_cvt_pk_bf16_f32 v192, v168, v169
    v_pk_mul_f32 v[206:207], v[206:207], v[252:253]
    v_cvt_pk_bf16_f32 v101, v206, v207
    v_add_f32 v242, v174, v175
    v_accvgpr_read_b32 v208, a131
    v_cvt_pk_bf16_f32 v193, v170, v171
    v_accvgpr_read_b32 v209, a159
    v_pk_mul_f32 v[208:209], v[208:209], v[252:253]
    v_add_f32 v242, v242, v22
    v_cvt_pk_bf16_f32 v102, v208, v209
    v_mfma_f32_16x16x32_bf16 v[180:183], a[252:255], v[84:87], v[180:183]
    v_cvt_pk_bf16_f32 v194, v172, v173
    v_accvgpr_read_b32 v210, a187
    v_accvgpr_read_b32 v211, a215
    v_add_f32 v242, v242, v20
    v_pk_mul_f32 v[210:211], v[210:211], v[252:253]
    v_cvt_pk_bf16_f32 v195, v174, v175
    v_cvt_pk_bf16_f32 v103, v210, v211
    v_accvgpr_read_b32 v204, a20
    v_max3_f32 v18, v176, v177, v178
    v_accvgpr_read_b32 v205, a48
    v_max3_f32 v18, v18, v179, v180
    v_pk_mul_f32 v[204:205], v[204:205], v[252:253]
    v_cvt_pk_bf16_f32 v104, v204, v205
    v_max3_f32 v18, v18, v181, v182
    v_mfma_f32_16x16x32_bf16 v[168:171], a[224:227], v[88:91], 0
    v_accvgpr_read_b32 v206, a76
    v_max_f32 v18, v18, v183
    v_accvgpr_read_b32 v207, a104
    v_pk_mul_f32 v[206:207], v[206:207], v[252:253]
    v_mov_b32 v19, v18
    v_cvt_pk_bf16_f32 v105, v206, v207
    s_nop 0
    v_permlane16_swap_b32 v18, v19
    v_accvgpr_read_b32 v208, a132
    v_accvgpr_read_b32 v209, a160
    v_max_f32 v18, v18, v19
    v_pk_mul_f32 v[208:209], v[208:209], v[252:253]
    v_mov_b32 v19, v18
    v_cvt_pk_bf16_f32 v106, v208, v209
    v_mfma_f32_16x16x32_bf16 v[168:171], a[228:231], v[92:95], v[168:171]
    v_accvgpr_read_b32 v210, a188
    v_permlane32_swap_b32 v18, v19
    v_accvgpr_read_b32 v211, a216
    v_max_f32 v18, v18, v19
    v_pk_mul_f32 v[210:211], v[210:211], v[252:253]
    v_cvt_pk_bf16_f32 v107, v210, v211
    v_sub_f32 v224, 0, v18
    v_accvgpr_read_b32 v204, a21
    v_sub_f32 v225, 0, v18
    v_accvgpr_read_b32 v205, a49
    v_pk_mul_f32 v[204:205], v[204:205], v[252:253]
    v_sub_f32 v226, 0, v18
    v_cvt_pk_bf16_f32 v108, v204, v205
    v_mfma_f32_16x16x32_bf16 v[168:171], a[232:235], v[96:99], v[168:171]
    v_sub_f32 v227, 0, v18
    v_accvgpr_read_b32 v206, a77
    v_accvgpr_read_b32 v207, a105
    v_mov_b32 v250, 0
    v_pk_mul_f32 v[206:207], v[206:207], v[252:253]
    v_add_f32 v176, v176, v224
    v_cvt_pk_bf16_f32 v109, v206, v207
    v_accvgpr_read_b32 v208, a133
    v_add_f32 v177, v177, v224
    v_accvgpr_read_b32 v209, a161
    v_add_f32 v178, v178, v224
    v_pk_mul_f32 v[208:209], v[208:209], v[252:253]
    v_cvt_pk_bf16_f32 v110, v208, v209
    v_add_f32 v179, v179, v224
    v_mfma_f32_16x16x32_bf16 v[168:171], a[236:239], v[100:103], v[168:171]
    v_accvgpr_read_b32 v210, a189
    v_add_f32 v180, v180, v224
    v_accvgpr_read_b32 v211, a217
    v_pk_mul_f32 v[210:211], v[210:211], v[252:253]
    v_add_f32 v181, v181, v224
    v_cvt_pk_bf16_f32 v111, v210, v211
    v_add_f32 v182, v182, v224
    v_accvgpr_read_b32 v204, a22
    v_add_f32 v183, v183, v224
    v_accvgpr_read_b32 v205, a50
    v_pk_mul_f32 v[204:205], v[204:205], v[252:253]
    v_exp_f32 v176, v176
    v_cvt_pk_bf16_f32 v112, v204, v205
    v_mfma_f32_16x16x32_bf16 v[172:175], a[240:243], v[88:91], 0
    v_exp_f32 v177, v177
    v_accvgpr_read_b32 v206, a78
    v_accvgpr_read_b32 v207, a106
    v_exp_f32 v178, v178
    v_pk_mul_f32 v[206:207], v[206:207], v[252:253]
    v_add_f32 v20, v176, v177
    v_cvt_pk_bf16_f32 v113, v206, v207
    v_accvgpr_read_b32 v208, a134
    v_exp_f32 v179, v179
    v_accvgpr_read_b32 v209, a162
    v_exp_f32 v180, v180
    v_pk_mul_f32 v[208:209], v[208:209], v[252:253]
    v_cvt_pk_bf16_f32 v114, v208, v209
    v_add_f32 v21, v178, v179
    v_mfma_f32_16x16x32_bf16 v[172:175], a[244:247], v[92:95], v[172:175]
    v_accvgpr_read_b32 v210, a190
    v_exp_f32 v181, v181
    v_accvgpr_read_b32 v211, a218
    v_pk_mul_f32 v[210:211], v[210:211], v[252:253]
    v_add_f32 v20, v20, v21
    v_cvt_pk_bf16_f32 v115, v210, v211
    v_exp_f32 v182, v182
    v_accvgpr_read_b32 v204, a23
    v_accvgpr_read_b32 v205, a51
    v_add_f32 v22, v180, v181
    v_pk_mul_f32 v[204:205], v[204:205], v[252:253]
    v_exp_f32 v183, v183
    v_cvt_pk_bf16_f32 v116, v204, v205
    v_mfma_f32_16x16x32_bf16 v[172:175], a[248:251], v[96:99], v[172:175]
    v_accvgpr_read_b32 v206, a79
    v_add_f32 v20, v20, v250
    v_accvgpr_read_b32 v207, a107
    v_cvt_pk_bf16_f32 v196, v176, v177
    v_pk_mul_f32 v[206:207], v[206:207], v[252:253]
    v_cvt_pk_bf16_f32 v117, v206, v207
    v_add_f32 v243, v182, v183
    v_accvgpr_read_b32 v208, a135
    v_cvt_pk_bf16_f32 v197, v178, v179
    v_accvgpr_read_b32 v209, a163
    v_pk_mul_f32 v[208:209], v[208:209], v[252:253]
    v_add_f32 v243, v243, v22
    v_cvt_pk_bf16_f32 v118, v208, v209
    v_mfma_f32_16x16x32_bf16 v[172:175], a[252:255], v[100:103], v[172:175]
    v_cvt_pk_bf16_f32 v198, v180, v181
    v_accvgpr_read_b32 v210, a191
    v_accvgpr_read_b32 v211, a219
    v_add_f32 v243, v243, v20
    v_pk_mul_f32 v[210:211], v[210:211], v[252:253]
    v_cvt_pk_bf16_f32 v199, v182, v183
    v_cvt_pk_bf16_f32 v119, v210, v211
    v_accvgpr_read_b32 v204, a24
    v_max3_f32 v18, v168, v169, v170
    v_accvgpr_read_b32 v205, a52
    v_max3_f32 v18, v18, v171, v172
    v_pk_mul_f32 v[204:205], v[204:205], v[252:253]
    v_cvt_pk_bf16_f32 v120, v204, v205
    v_max3_f32 v18, v18, v173, v174
    v_mfma_f32_16x16x32_bf16 v[176:179], a[224:227], v[104:107], 0
    v_accvgpr_read_b32 v206, a80
    v_max_f32 v18, v18, v175
    v_accvgpr_read_b32 v207, a108
    v_pk_mul_f32 v[206:207], v[206:207], v[252:253]
    v_mov_b32 v19, v18
    v_cvt_pk_bf16_f32 v121, v206, v207
    s_nop 0
    v_permlane16_swap_b32 v18, v19
    v_accvgpr_read_b32 v208, a136
    v_accvgpr_read_b32 v209, a164
    v_max_f32 v18, v18, v19
    v_pk_mul_f32 v[208:209], v[208:209], v[252:253]
    v_mov_b32 v19, v18
    v_cvt_pk_bf16_f32 v122, v208, v209
    v_mfma_f32_16x16x32_bf16 v[176:179], a[228:231], v[108:111], v[176:179]
    v_accvgpr_read_b32 v210, a192
    v_permlane32_swap_b32 v18, v19
    v_accvgpr_read_b32 v211, a220
    v_max_f32 v18, v18, v19
    v_pk_mul_f32 v[210:211], v[210:211], v[252:253]
    v_cvt_pk_bf16_f32 v123, v210, v211
    v_sub_f32 v228, 0, v18
    v_accvgpr_read_b32 v204, a25
    v_sub_f32 v229, 0, v18
    v_accvgpr_read_b32 v205, a53
    v_pk_mul_f32 v[204:205], v[204:205], v[252:253]
    v_sub_f32 v230, 0, v18
    v_cvt_pk_bf16_f32 v124, v204, v205
    v_mfma_f32_16x16x32_bf16 v[176:179], a[232:235], v[112:115], v[176:179]
    v_sub_f32 v231, 0, v18
    v_accvgpr_read_b32 v206, a81
    v_accvgpr_read_b32 v207, a109
    v_mov_b32 v251, 0
    v_pk_mul_f32 v[206:207], v[206:207], v[252:253]
    v_add_f32 v168, v168, v228
    v_cvt_pk_bf16_f32 v125, v206, v207
    v_accvgpr_read_b32 v208, a137
    v_add_f32 v169, v169, v228
    v_accvgpr_read_b32 v209, a165
    v_add_f32 v170, v170, v228
    v_pk_mul_f32 v[208:209], v[208:209], v[252:253]
    v_cvt_pk_bf16_f32 v126, v208, v209
    v_add_f32 v171, v171, v228
    v_mfma_f32_16x16x32_bf16 v[176:179], a[236:239], v[116:119], v[176:179]
    v_accvgpr_read_b32 v210, a193
    v_add_f32 v172, v172, v228
    v_accvgpr_read_b32 v211, a221
    v_pk_mul_f32 v[210:211], v[210:211], v[252:253]
    v_add_f32 v173, v173, v228
    v_cvt_pk_bf16_f32 v127, v210, v211
    v_add_f32 v174, v174, v228
    v_accvgpr_read_b32 v204, a26
    v_add_f32 v175, v175, v228
    v_accvgpr_read_b32 v205, a54
    v_pk_mul_f32 v[204:205], v[204:205], v[252:253]
    v_exp_f32 v168, v168
    v_cvt_pk_bf16_f32 v128, v204, v205
    v_mfma_f32_16x16x32_bf16 v[180:183], a[240:243], v[104:107], 0
    v_exp_f32 v169, v169
    v_accvgpr_read_b32 v206, a82
    v_accvgpr_read_b32 v207, a110
    v_exp_f32 v170, v170
    v_pk_mul_f32 v[206:207], v[206:207], v[252:253]
    v_add_f32 v20, v168, v169
    v_cvt_pk_bf16_f32 v129, v206, v207
    v_accvgpr_read_b32 v208, a138
    v_exp_f32 v171, v171
    v_accvgpr_read_b32 v209, a166
    v_exp_f32 v172, v172
    v_pk_mul_f32 v[208:209], v[208:209], v[252:253]
    v_cvt_pk_bf16_f32 v130, v208, v209
    v_add_f32 v21, v170, v171
    v_mfma_f32_16x16x32_bf16 v[180:183], a[244:247], v[108:111], v[180:183]
    v_accvgpr_read_b32 v210, a194
    v_exp_f32 v173, v173
    v_accvgpr_read_b32 v211, a222
    v_pk_mul_f32 v[210:211], v[210:211], v[252:253]
    v_add_f32 v20, v20, v21
    v_cvt_pk_bf16_f32 v131, v210, v211
    v_exp_f32 v174, v174
    v_accvgpr_read_b32 v204, a27
    v_accvgpr_read_b32 v205, a55
    v_add_f32 v22, v172, v173
    v_pk_mul_f32 v[204:205], v[204:205], v[252:253]
    v_exp_f32 v175, v175
    v_cvt_pk_bf16_f32 v132, v204, v205
    v_mfma_f32_16x16x32_bf16 v[180:183], a[248:251], v[112:115], v[180:183]
    v_accvgpr_read_b32 v206, a83
    v_add_f32 v20, v20, v251
    v_accvgpr_read_b32 v207, a111
    v_cvt_pk_bf16_f32 v200, v168, v169
    v_pk_mul_f32 v[206:207], v[206:207], v[252:253]
    v_cvt_pk_bf16_f32 v133, v206, v207
    v_add_f32 v244, v174, v175
    v_accvgpr_read_b32 v208, a139
    v_cvt_pk_bf16_f32 v201, v170, v171
    v_accvgpr_read_b32 v209, a167
    v_pk_mul_f32 v[208:209], v[208:209], v[252:253]
    v_add_f32 v244, v244, v22
    v_cvt_pk_bf16_f32 v134, v208, v209
    v_mfma_f32_16x16x32_bf16 v[180:183], a[252:255], v[116:119], v[180:183]
    v_cvt_pk_bf16_f32 v202, v172, v173
    v_accvgpr_read_b32 v210, a195
    v_accvgpr_read_b32 v211, a223
    v_add_f32 v244, v244, v20
    v_pk_mul_f32 v[210:211], v[210:211], v[252:253]
    v_cvt_pk_bf16_f32 v203, v174, v175
    v_cvt_pk_bf16_f32 v135, v210, v211
    v_max3_f32 v18, v176, v177, v178
    s_waitcnt vmcnt(63)
    v_max3_f32 v18, v18, v179, v180
    v_max3_f32 v18, v18, v181, v182
    v_max_f32 v18, v18, v183
    v_mfma_f32_16x16x32_bf16 v[168:171], a[224:227], v[120:123], 0
    v_mov_b32 v19, v18
    s_nop 1
    v_permlane16_swap_b32 v18, v19
    ds_read_b128 a[224:227], v6 offset:16384
    v_max_f32 v18, v18, v19
    v_mov_b32 v19, v18
    s_nop 1
    v_permlane32_swap_b32 v18, v19
    v_mfma_f32_16x16x32_bf16 v[168:171], a[228:231], v[124:127], v[168:171]
    v_max_f32 v18, v18, v19
    v_sub_f32 v232, 0, v18
    ds_read_b128 a[228:231], v7 offset:16384
    v_sub_f32 v233, 0, v18
    v_sub_f32 v234, 0, v18
    v_sub_f32 v235, 0, v18
    v_mfma_f32_16x16x32_bf16 v[168:171], a[232:235], v[128:131], v[168:171]
    v_mov_b32 v252, 0
    v_add_f32 v176, v176, v232
    ds_read_b128 a[232:235], v8 offset:16384
    v_add_f32 v177, v177, v232
    v_add_f32 v178, v178, v232
    v_add_f32 v179, v179, v232
    v_mfma_f32_16x16x32_bf16 v[168:171], a[236:239], v[132:135], v[168:171]
    v_add_f32 v180, v180, v232
    v_add_f32 v181, v181, v232
    ds_read_b128 a[236:239], v9 offset:16384
    v_add_f32 v182, v182, v232
    v_add_f32 v183, v183, v232
    v_exp_f32 v176, v176
    v_mfma_f32_16x16x32_bf16 v[172:175], a[240:243], v[120:123], 0
    v_exp_f32 v177, v177
    v_exp_f32 v178, v178
    v_add_f32 v20, v176, v177
    ds_read_b128 a[240:243], v6 offset:20480
    v_exp_f32 v179, v179
    v_exp_f32 v180, v180
    v_mfma_f32_16x16x32_bf16 v[172:175], a[244:247], v[124:127], v[172:175]
    v_add_f32 v21, v178, v179
    v_exp_f32 v181, v181
    v_add_f32 v20, v20, v21
    ds_read_b128 a[244:247], v7 offset:20480
    v_exp_f32 v182, v182
    v_add_f32 v22, v180, v181
    v_mfma_f32_16x16x32_bf16 v[172:175], a[248:251], v[128:131], v[172:175]
    v_exp_f32 v183, v183
    v_add_f32 v20, v20, v252
    v_cvt_pk_bf16_f32 v204, v176, v177
    ds_read_b128 a[248:251], v8 offset:20480
    v_add_f32 v245, v182, v183
    v_cvt_pk_bf16_f32 v205, v178, v179
    v_mfma_f32_16x16x32_bf16 v[172:175], a[252:255], v[132:135], v[172:175]
    v_add_f32 v245, v245, v22
    v_cvt_pk_bf16_f32 v206, v180, v181
    v_add_f32 v245, v245, v20
    ds_read_b128 a[252:255], v9 offset:20480
    v_cvt_pk_bf16_f32 v207, v182, v183
    v_max3_f32 v18, v168, v169, v170
    s_nop 1
    v_max3_f32 v18, v18, v171, v172
    v_max3_f32 v18, v18, v173, v174
    v_max_f32 v18, v18, v175
    v_mov_b32 v19, v18
    s_nop 1
    v_permlane16_swap_b32 v18, v19
    v_max_f32 v18, v18, v19
    v_mov_b32 v19, v18
    s_nop 1
    v_permlane32_swap_b32 v18, v19
    v_max_f32 v18, v18, v19
    v_sub_f32 v236, 0, v18
    v_sub_f32 v237, 0, v18
    v_sub_f32 v238, 0, v18
    v_sub_f32 v239, 0, v18
    v_mov_b32 v253, 0
    v_add_f32 v168, v168, v236
    v_add_f32 v169, v169, v236
    v_add_f32 v170, v170, v236
    v_add_f32 v171, v171, v236
    v_add_f32 v172, v172, v236
    v_add_f32 v173, v173, v236
    v_add_f32 v174, v174, v236
    v_add_f32 v175, v175, v236
    v_exp_f32 v168, v168
    v_exp_f32 v169, v169
    v_exp_f32 v170, v170
    v_add_f32 v20, v168, v169
    v_exp_f32 v171, v171
    v_exp_f32 v172, v172
    v_add_f32 v21, v170, v171
    v_exp_f32 v173, v173
    v_add_f32 v20, v20, v21
    v_exp_f32 v174, v174
    v_add_f32 v22, v172, v173
    v_exp_f32 v175, v175
    v_add_f32 v20, v20, v253
    v_cvt_pk_bf16_f32 v208, v168, v169
    v_add_f32 v246, v174, v175
    v_cvt_pk_bf16_f32 v209, v170, v171
    v_add_f32 v246, v246, v22
    v_cvt_pk_bf16_f32 v210, v172, v173
    v_add_f32 v246, v246, v20
    v_cvt_pk_bf16_f32 v211, v174, v175
    s_waitcnt vmcnt(0)
    ds_read_b64_tr_b16 a[24:25], v1 offset:0
    ds_read_b64_tr_b16 a[26:27], v1 offset:2560
    ds_read_b64_tr_b16 a[52:53], v1 offset:32
    ds_read_b64_tr_b16 a[54:55], v1 offset:2592
    ds_read_b64_tr_b16 a[80:81], v1 offset:64
    ds_read_b64_tr_b16 a[82:83], v1 offset:2624
    ds_read_b64_tr_b16 a[108:109], v1 offset:96
    ds_read_b64_tr_b16 a[110:111], v1 offset:2656
    ds_read_b64_tr_b16 a[136:137], v1 offset:128
    ds_read_b64_tr_b16 a[138:139], v1 offset:2688
    v_add_u32 v1, 4096, v254
    s_waitcnt lgkmcnt(0)
    buffer_store_dwordx4 a[24:27], v254, s[64:67], 0 offen offset:0 sc1
    buffer_store_dwordx4 a[52:55], v254, s[64:67], 0 offen offset:1024 sc1
    buffer_store_dwordx4 a[80:83], v254, s[64:67], 0 offen offset:2048 sc1
    buffer_store_dwordx4 a[108:111], v254, s[64:67], 0 offen offset:3072 sc1
    buffer_store_dwordx4 a[136:139], v1, s[64:67], 0 offen offset:0 sc1
    s_waitcnt lgkmcnt(15)
    s_mov_b32 m0, s28
    s_mov_b32 s39, 0x40000
    v_mfma_f32_16x16x32_bf16 v[168:171], a[224:227], v[24:27], v[212:215]
    buffer_load_dwordx4 v2, s[12:15], s42 offen offset:0 nt lds
    v_mfma_f32_16x16x32_bf16 v[168:171], a[228:231], v[28:31], v[168:171]
    buffer_load_dwordx4 v3, s[12:15], s42 offen offset:1024 nt lds
    v_mfma_f32_16x16x32_bf16 v[168:171], a[232:235], v[32:35], v[168:171]
    buffer_load_dwordx4 v4, s[12:15], s42 offen offset:2048 nt lds
    v_mfma_f32_16x16x32_bf16 v[168:171], a[236:239], v[36:39], v[168:171]
    buffer_load_dwordx4 v5, s[12:15], s42 offen offset:3072 nt lds
    s_mov_b32 m0, s29
    v_mfma_f32_16x16x32_bf16 v[172:175], a[240:243], v[24:27], v[212:215]
    s_add_u32 s42, s42, 8192
    buffer_load_dwordx4 v2, s[12:15], s43 offen offset:0 nt lds
    v_mfma_f32_16x16x32_bf16 v[172:175], a[244:247], v[28:31], v[172:175]
    buffer_load_dwordx4 v3, s[12:15], s43 offen offset:1024 nt lds
    v_mfma_f32_16x16x32_bf16 v[172:175], a[248:251], v[32:35], v[172:175]
    buffer_load_dwordx4 v4, s[12:15], s43 offen offset:2048 nt lds
    v_mfma_f32_16x16x32_bf16 v[172:175], a[252:255], v[36:39], v[172:175]
    s_waitcnt lgkmcnt(8)
    buffer_load_dwordx4 v5, s[12:15], s43 offen offset:3072 nt lds
    s_add_u32 s43, s43, 8192
    v_mfma_f32_16x16x32_bf16 a[0:3], v[136:139], v[184:187], 0
    v_exp_f32 v168, v168
    v_mfma_f32_16x16x32_bf16 a[28:31], v[140:143], v[184:187], 0
    v_exp_f32 v169, v169
    v_mfma_f32_16x16x32_bf16 a[56:59], v[144:147], v[184:187], 0
    v_exp_f32 v170, v170
    v_mfma_f32_16x16x32_bf16 a[84:87], v[148:151], v[184:187], 0
    s_waitcnt lgkmcnt(0)
    v_exp_f32 v171, v171
    v_mfma_f32_16x16x32_bf16 a[112:115], v[152:155], v[184:187], 0
    v_exp_f32 v172, v172
    v_mfma_f32_16x16x32_bf16 a[140:143], v[156:159], v[184:187], 0
    v_add_f32 v20, v168, v169
    v_add_f32 v21, v170, v171
    v_mfma_f32_16x16x32_bf16 a[168:171], v[160:163], v[184:187], 0
    v_exp_f32 v173, v173
    v_mfma_f32_16x16x32_bf16 a[196:199], v[164:167], v[184:187], 0
    s_mov_b32 m0, s63
    v_mfma_f32_16x16x32_bf16 v[176:179], a[224:227], v[40:43], v[216:219]
    v_exp_f32 v174, v174
    v_mfma_f32_16x16x32_bf16 v[176:179], a[228:231], v[44:47], v[176:179]
    v_cvt_pk_bf16_f32 v184, v168, v169
    v_add_f32 v20, v20, v21
    v_mfma_f32_16x16x32_bf16 v[176:179], a[232:235], v[48:51], v[176:179]
    v_exp_f32 v175, v175
    v_mfma_f32_16x16x32_bf16 v[176:179], a[236:239], v[52:55], v[176:179]
    v_cvt_pk_bf16_f32 v185, v170, v171
    v_add_f32 v22, v172, v173
    v_mfma_f32_16x16x32_bf16 v[180:183], a[240:243], v[40:43], v[216:219]
    v_add_f32 v20, v20, v240
    v_cvt_pk_bf16_f32 v186, v172, v173
    v_mfma_f32_16x16x32_bf16 v[180:183], a[244:247], v[44:47], v[180:183]
    v_add_f32 v247, v174, v175
    v_cvt_pk_bf16_f32 v187, v174, v175
    v_mfma_f32_16x16x32_bf16 v[180:183], a[248:251], v[48:51], v[180:183]
    v_add_f32 v247, v247, v22
    v_add_f32 v247, v247, v20
    v_mfma_f32_16x16x32_bf16 v[180:183], a[252:255], v[52:55], v[180:183]
    buffer_load_dwordx4 v2, s[16:19], s39 offen offset:0 lds
    v_mfma_f32_16x16x32_bf16 a[4:7], v[136:139], v[188:191], 0
    v_exp_f32 v176, v176
    v_mfma_f32_16x16x32_bf16 a[32:35], v[140:143], v[188:191], 0
    v_exp_f32 v177, v177
    v_mfma_f32_16x16x32_bf16 a[60:63], v[144:147], v[188:191], 0
    v_exp_f32 v178, v178
    v_mfma_f32_16x16x32_bf16 a[88:91], v[148:151], v[188:191], 0
    v_exp_f32 v179, v179
    v_mfma_f32_16x16x32_bf16 a[116:119], v[152:155], v[188:191], 0
    v_exp_f32 v180, v180
    v_mfma_f32_16x16x32_bf16 a[144:147], v[156:159], v[188:191], 0
    v_add_f32 v20, v176, v177
    v_add_f32 v21, v178, v179
    v_mfma_f32_16x16x32_bf16 a[172:175], v[160:163], v[188:191], 0
    v_exp_f32 v181, v181
    v_mfma_f32_16x16x32_bf16 a[200:203], v[164:167], v[188:191], 0
    buffer_load_dwordx4 v3, s[16:19], s39 offen offset:1024 lds
    v_mfma_f32_16x16x32_bf16 v[168:171], a[224:227], v[56:59], v[220:223]
    v_exp_f32 v182, v182
    v_mfma_f32_16x16x32_bf16 v[168:171], a[228:231], v[60:63], v[168:171]
    v_cvt_pk_bf16_f32 v188, v176, v177
    v_add_f32 v20, v20, v21
    v_mfma_f32_16x16x32_bf16 v[168:171], a[232:235], v[64:67], v[168:171]
    v_exp_f32 v183, v183
    v_mfma_f32_16x16x32_bf16 v[168:171], a[236:239], v[68:71], v[168:171]
    v_cvt_pk_bf16_f32 v189, v178, v179
    v_add_f32 v22, v180, v181
    v_mfma_f32_16x16x32_bf16 v[172:175], a[240:243], v[56:59], v[220:223]
    v_add_f32 v20, v20, v241
    v_cvt_pk_bf16_f32 v190, v180, v181
    v_mfma_f32_16x16x32_bf16 v[172:175], a[244:247], v[60:63], v[172:175]
    v_add_f32 v248, v182, v183
    v_cvt_pk_bf16_f32 v191, v182, v183
    v_mfma_f32_16x16x32_bf16 v[172:175], a[248:251], v[64:67], v[172:175]
    v_add_f32 v248, v248, v22
    v_add_f32 v248, v248, v20
    v_mfma_f32_16x16x32_bf16 v[172:175], a[252:255], v[68:71], v[172:175]
    buffer_load_dwordx4 v4, s[16:19], s39 offen offset:2048 lds
    v_mfma_f32_16x16x32_bf16 a[8:11], v[136:139], v[192:195], 0
    v_exp_f32 v168, v168
    v_mfma_f32_16x16x32_bf16 a[36:39], v[140:143], v[192:195], 0
    v_exp_f32 v169, v169
    v_mfma_f32_16x16x32_bf16 a[64:67], v[144:147], v[192:195], 0
    v_exp_f32 v170, v170
    v_mfma_f32_16x16x32_bf16 a[92:95], v[148:151], v[192:195], 0
    v_exp_f32 v171, v171
    v_mfma_f32_16x16x32_bf16 a[120:123], v[152:155], v[192:195], 0
    v_exp_f32 v172, v172
    v_mfma_f32_16x16x32_bf16 a[148:151], v[156:159], v[192:195], 0
    v_add_f32 v20, v168, v169
    v_add_f32 v21, v170, v171
    v_mfma_f32_16x16x32_bf16 a[176:179], v[160:163], v[192:195], 0
    v_exp_f32 v173, v173
    v_mfma_f32_16x16x32_bf16 a[204:207], v[164:167], v[192:195], 0
    buffer_load_dwordx4 v5, s[16:19], s39 offen offset:3072 lds
    s_mov_b32 m0, s63
    v_mfma_f32_16x16x32_bf16 v[176:179], a[224:227], v[72:75], v[224:227]
    v_exp_f32 v174, v174
    v_mfma_f32_16x16x32_bf16 v[176:179], a[228:231], v[76:79], v[176:179]
    v_cvt_pk_bf16_f32 v192, v168, v169
    v_add_f32 v20, v20, v21
    v_mfma_f32_16x16x32_bf16 v[176:179], a[232:235], v[80:83], v[176:179]
    v_exp_f32 v175, v175
    v_mfma_f32_16x16x32_bf16 v[176:179], a[236:239], v[84:87], v[176:179]
    v_cvt_pk_bf16_f32 v193, v170, v171
    v_add_f32 v22, v172, v173
    v_mfma_f32_16x16x32_bf16 v[180:183], a[240:243], v[72:75], v[224:227]
    v_add_f32 v20, v20, v242
    v_cvt_pk_bf16_f32 v194, v172, v173
    v_mfma_f32_16x16x32_bf16 v[180:183], a[244:247], v[76:79], v[180:183]
    v_add_f32 v249, v174, v175
    v_cvt_pk_bf16_f32 v195, v174, v175
    v_mfma_f32_16x16x32_bf16 v[180:183], a[248:251], v[80:83], v[180:183]
    v_add_f32 v249, v249, v22
    v_add_f32 v249, v249, v20
    v_mfma_f32_16x16x32_bf16 v[180:183], a[252:255], v[84:87], v[180:183]
    s_nop 0
    buffer_load_dwordx4 v2, s[16:19], s39 offen offset:0 lds
    v_mfma_f32_16x16x32_bf16 a[12:15], v[136:139], v[196:199], 0
    v_exp_f32 v176, v176
    v_mfma_f32_16x16x32_bf16 a[40:43], v[140:143], v[196:199], 0
    v_exp_f32 v177, v177
    v_mfma_f32_16x16x32_bf16 a[68:71], v[144:147], v[196:199], 0
    v_exp_f32 v178, v178
    v_mfma_f32_16x16x32_bf16 a[96:99], v[148:151], v[196:199], 0
    v_exp_f32 v179, v179
    v_mfma_f32_16x16x32_bf16 a[124:127], v[152:155], v[196:199], 0
    v_exp_f32 v180, v180
    v_mfma_f32_16x16x32_bf16 a[152:155], v[156:159], v[196:199], 0
    v_add_f32 v20, v176, v177
    v_add_f32 v21, v178, v179
    v_mfma_f32_16x16x32_bf16 a[180:183], v[160:163], v[196:199], 0
    v_exp_f32 v181, v181
    v_mfma_f32_16x16x32_bf16 a[208:211], v[164:167], v[196:199], 0
    buffer_load_dwordx4 v3, s[16:19], s39 offen offset:1024 lds
    v_mfma_f32_16x16x32_bf16 v[168:171], a[224:227], v[88:91], v[228:231]
    v_exp_f32 v182, v182
    v_mfma_f32_16x16x32_bf16 v[168:171], a[228:231], v[92:95], v[168:171]
    v_cvt_pk_bf16_f32 v196, v176, v177
    v_add_f32 v20, v20, v21
    v_mfma_f32_16x16x32_bf16 v[168:171], a[232:235], v[96:99], v[168:171]
    v_exp_f32 v183, v183
    v_mfma_f32_16x16x32_bf16 v[168:171], a[236:239], v[100:103], v[168:171]
    v_cvt_pk_bf16_f32 v197, v178, v179
    v_add_f32 v22, v180, v181
    v_mfma_f32_16x16x32_bf16 v[172:175], a[240:243], v[88:91], v[228:231]
    v_add_f32 v20, v20, v243
    v_cvt_pk_bf16_f32 v198, v180, v181
    v_mfma_f32_16x16x32_bf16 v[172:175], a[244:247], v[92:95], v[172:175]
    v_add_f32 v250, v182, v183
    v_cvt_pk_bf16_f32 v199, v182, v183
    v_mfma_f32_16x16x32_bf16 v[172:175], a[248:251], v[96:99], v[172:175]
    v_add_f32 v250, v250, v22
    v_add_f32 v250, v250, v20
    v_mfma_f32_16x16x32_bf16 v[172:175], a[252:255], v[100:103], v[172:175]
    buffer_load_dwordx4 v4, s[16:19], s39 offen offset:2048 lds
    v_mfma_f32_16x16x32_bf16 a[16:19], v[136:139], v[200:203], 0
    v_exp_f32 v168, v168
    v_mfma_f32_16x16x32_bf16 a[44:47], v[140:143], v[200:203], 0
    v_exp_f32 v169, v169
    v_mfma_f32_16x16x32_bf16 a[72:75], v[144:147], v[200:203], 0
    v_exp_f32 v170, v170
    v_mfma_f32_16x16x32_bf16 a[100:103], v[148:151], v[200:203], 0
    v_exp_f32 v171, v171
    v_mfma_f32_16x16x32_bf16 a[128:131], v[152:155], v[200:203], 0
    v_exp_f32 v172, v172
    v_mfma_f32_16x16x32_bf16 a[156:159], v[156:159], v[200:203], 0
    v_add_f32 v20, v168, v169
    v_add_f32 v21, v170, v171
    v_mfma_f32_16x16x32_bf16 a[184:187], v[160:163], v[200:203], 0
    v_exp_f32 v173, v173
    v_mfma_f32_16x16x32_bf16 a[212:215], v[164:167], v[200:203], 0
    buffer_load_dwordx4 v5, s[16:19], s39 offen offset:3072 lds
    s_nop 0
    v_mfma_f32_16x16x32_bf16 v[176:179], a[224:227], v[104:107], v[232:235]
    v_exp_f32 v174, v174
    v_mfma_f32_16x16x32_bf16 v[176:179], a[228:231], v[108:111], v[176:179]
    v_cvt_pk_bf16_f32 v200, v168, v169
    v_add_f32 v20, v20, v21
    v_mfma_f32_16x16x32_bf16 v[176:179], a[232:235], v[112:115], v[176:179]
    v_exp_f32 v175, v175
    v_mfma_f32_16x16x32_bf16 v[176:179], a[236:239], v[116:119], v[176:179]
    v_cvt_pk_bf16_f32 v201, v170, v171
    v_add_f32 v22, v172, v173
    v_mfma_f32_16x16x32_bf16 v[180:183], a[240:243], v[104:107], v[232:235]
    v_add_f32 v20, v20, v244
    v_cvt_pk_bf16_f32 v202, v172, v173
    v_mfma_f32_16x16x32_bf16 v[180:183], a[244:247], v[108:111], v[180:183]
    v_add_f32 v251, v174, v175
    v_cvt_pk_bf16_f32 v203, v174, v175
    v_mfma_f32_16x16x32_bf16 v[180:183], a[248:251], v[112:115], v[180:183]
    v_add_f32 v251, v251, v22
    v_add_f32 v251, v251, v20
    v_mfma_f32_16x16x32_bf16 v[180:183], a[252:255], v[116:119], v[180:183]
    v_mfma_f32_16x16x32_bf16 a[20:23], v[136:139], v[204:207], 0
    v_exp_f32 v176, v176
    v_mfma_f32_16x16x32_bf16 a[48:51], v[140:143], v[204:207], 0
    v_exp_f32 v177, v177
    v_mfma_f32_16x16x32_bf16 a[76:79], v[144:147], v[204:207], 0
    v_exp_f32 v178, v178
    v_mfma_f32_16x16x32_bf16 a[104:107], v[148:151], v[204:207], 0
    v_exp_f32 v179, v179
    v_mfma_f32_16x16x32_bf16 a[132:135], v[152:155], v[204:207], 0
    v_exp_f32 v180, v180
    v_mfma_f32_16x16x32_bf16 a[160:163], v[156:159], v[204:207], 0
    v_add_f32 v20, v176, v177
    v_add_f32 v21, v178, v179
    v_mfma_f32_16x16x32_bf16 a[188:191], v[160:163], v[204:207], 0
    v_exp_f32 v181, v181
    v_mfma_f32_16x16x32_bf16 a[216:219], v[164:167], v[204:207], 0
    s_waitcnt vmcnt(50)
    v_max3_f32 v23, v247, v248, v249
    v_max3_f32 v23, v23, v250, v251
    v_mfma_f32_16x16x32_bf16 v[168:171], a[224:227], v[120:123], v[236:239]
    v_exp_f32 v182, v182
    ds_read_b128 a[224:227], v6 offset:0
    v_mfma_f32_16x16x32_bf16 v[168:171], a[228:231], v[124:127], v[168:171]
    v_cvt_pk_bf16_f32 v204, v176, v177
    v_add_f32 v20, v20, v21
    ds_read_b128 a[228:231], v7 offset:0
    v_mfma_f32_16x16x32_bf16 v[168:171], a[232:235], v[128:131], v[168:171]
    v_exp_f32 v183, v183
    ds_read_b128 a[232:235], v8 offset:0
    v_mfma_f32_16x16x32_bf16 v[168:171], a[236:239], v[132:135], v[168:171]
    v_cvt_pk_bf16_f32 v205, v178, v179
    v_add_f32 v22, v180, v181
    ds_read_b128 a[236:239], v9 offset:0
    v_mfma_f32_16x16x32_bf16 v[172:175], a[240:243], v[120:123], v[236:239]
    v_add_f32 v20, v20, v245
    v_cvt_pk_bf16_f32 v206, v180, v181
    ds_read_b128 a[240:243], v6 offset:4096
    v_mfma_f32_16x16x32_bf16 v[172:175], a[244:247], v[124:127], v[172:175]
    v_add_f32 v252, v182, v183
    v_cvt_pk_bf16_f32 v207, v182, v183
    ds_read_b128 a[244:247], v7 offset:4096
    v_mfma_f32_16x16x32_bf16 v[172:175], a[248:251], v[128:131], v[172:175]
    v_add_f32 v252, v252, v22
    v_add_f32 v252, v252, v20
    ds_read_b128 a[248:251], v8 offset:4096
    v_mfma_f32_16x16x32_bf16 v[172:175], a[252:255], v[132:135], v[172:175]
    ds_read_b128 a[252:255], v9 offset:4096
    v_mfma_f32_16x16x32_bf16 a[24:27], v[136:139], v[208:211], 0
    v_exp_f32 v168, v168
    v_mfma_f32_16x16x32_bf16 a[52:55], v[140:143], v[208:211], 0
    v_exp_f32 v169, v169
    v_mfma_f32_16x16x32_bf16 a[80:83], v[144:147], v[208:211], 0
    v_exp_f32 v170, v170
    v_mfma_f32_16x16x32_bf16 a[108:111], v[148:151], v[208:211], 0
    v_exp_f32 v171, v171
    v_mfma_f32_16x16x32_bf16 a[136:139], v[152:155], v[208:211], 0
    v_exp_f32 v172, v172
    v_mfma_f32_16x16x32_bf16 a[164:167], v[156:159], v[208:211], 0
    v_exp_f32 v173, v173
    v_mfma_f32_16x16x32_bf16 a[192:195], v[160:163], v[208:211], 0
    v_exp_f32 v174, v174
    v_mfma_f32_16x16x32_bf16 a[220:223], v[164:167], v[208:211], 0
    v_exp_f32 v175, v175
    v_add_f32 v20, v168, v169
    v_add_f32 v21, v170, v171
    v_add_f32 v22, v172, v173
    v_add_f32 v20, v20, v21
    v_add_f32 v253, v174, v175
    v_add_f32 v20, v20, v246
    v_add_f32 v253, v253, v22
    v_add_f32 v253, v253, v20
    v_max3_f32 v23, v23, v252, v253
    v_cmp_lt_f32 vcc, 0x49800000, v23
    v_cvt_pk_bf16_f32 v208, v168, v169
    v_cvt_pk_bf16_f32 v209, v170, v171
    v_cvt_pk_bf16_f32 v210, v172, v173
    v_cvt_pk_bf16_f32 v211, v174, v175
    s_waitcnt vmcnt(63)
    s_cbranch_vccnz L_slowP
L_slowP_ret:
    ds_read_b64_tr_b16 v[136:137], v10 offset:24576
    ds_read_b64_tr_b16 v[138:139], v10 offset:28672
    ds_read_b64_tr_b16 v[140:141], v11 offset:24576
    ds_read_b64_tr_b16 v[142:143], v11 offset:28672
    ds_read_b64_tr_b16 v[144:145], v12 offset:24576
    ds_read_b64_tr_b16 v[146:147], v12 offset:28672
    ds_read_b64_tr_b16 v[148:149], v13 offset:24576
    ds_read_b64_tr_b16 v[150:151], v13 offset:28672
    ds_read_b64_tr_b16 v[152:153], v14 offset:24576
    ds_read_b64_tr_b16 v[154:155], v14 offset:28672
    ds_read_b64_tr_b16 v[156:157], v15 offset:24576
    ds_read_b64_tr_b16 v[158:159], v15 offset:28672
    ds_read_b64_tr_b16 v[160:161], v16 offset:24576
    ds_read_b64_tr_b16 v[162:163], v16 offset:28672
    ds_read_b64_tr_b16 v[164:165], v17 offset:24576
    ds_read_b64_tr_b16 v[166:167], v17 offset:28672
    s_add_u32 s76, s92, 0
    s_addc_u32 s77, s93, 0
    s_mov_b32 s78, 256
    s_mov_b32 s79, 0x20000
    v_mov_b32 v18, 1
    v_mov_b32 v1, s2
    s_waitcnt vmcnt(16)
    s_barrier
    s_cmp_lg_u32 s3, 0
    s_cbranch_scc1 L_nopub
    buffer_store_byte v18, v1, s[76:79], 0 offen sc1
L_nopub:
    s_mov_b32 s41, 2
L_loop:
    s_waitcnt lgkmcnt(15)
    s_mov_b32 m0, s24
    v_mfma_f32_16x16x32_bf16 v[168:171], a[224:227], v[24:27], v[212:215]
    buffer_load_dwordx4 v2, s[12:15], s42 offen offset:0 nt lds
    v_mfma_f32_16x16x32_bf16 v[168:171], a[228:231], v[28:31], v[168:171]
    buffer_load_dwordx4 v3, s[12:15], s42 offen offset:1024 nt lds
    v_mfma_f32_16x16x32_bf16 v[168:171], a[232:235], v[32:35], v[168:171]
    buffer_load_dwordx4 v4, s[12:15], s42 offen offset:2048 nt lds
    v_mfma_f32_16x16x32_bf16 v[168:171], a[236:239], v[36:39], v[168:171]
    buffer_load_dwordx4 v5, s[12:15], s42 offen offset:3072 nt lds
    s_mov_b32 m0, s25
    v_mfma_f32_16x16x32_bf16 v[172:175], a[240:243], v[24:27], v[212:215]
    s_add_u32 s42, s42, 8192
    buffer_load_dwordx4 v2, s[12:15], s43 offen offset:0 nt lds
    v_mfma_f32_16x16x32_bf16 v[172:175], a[244:247], v[28:31], v[172:175]
    buffer_load_dwordx4 v3, s[12:15], s43 offen offset:1024 nt lds
    v_mfma_f32_16x16x32_bf16 v[172:175], a[248:251], v[32:35], v[172:175]
    buffer_load_dwordx4 v4, s[12:15], s43 offen offset:2048 nt lds
    v_mfma_f32_16x16x32_bf16 v[172:175], a[252:255], v[36:39], v[172:175]
    s_waitcnt lgkmcnt(8)
    buffer_load_dwordx4 v5, s[12:15], s43 offen offset:3072 nt lds
    s_add_u32 s43, s43, 8192
    v_mfma_f32_16x16x32_bf16 a[0:3], v[136:139], v[184:187], a[0:3]
    v_exp_f32 v168, v168
    v_mfma_f32_16x16x32_bf16 a[28:31], v[140:143], v[184:187], a[28:31]
    v_exp_f32 v169, v169
    v_mfma_f32_16x16x32_bf16 a[56:59], v[144:147], v[184:187], a[56:59]
    v_exp_f32 v170, v170
    v_mfma_f32_16x16x32_bf16 a[84:87], v[148:151], v[184:187], a[84:87]
    s_waitcnt lgkmcnt(0)
    v_exp_f32 v171, v171
    v_mfma_f32_16x16x32_bf16 a[112:115], v[152:155], v[184:187], a[112:115]
    v_exp_f32 v172, v172
    v_mfma_f32_16x16x32_bf16 a[140:143], v[156:159], v[184:187], a[140:143]
    v_add_f32 v20, v168, v169
    v_add_f32 v21, v170, v171
    v_mfma_f32_16x16x32_bf16 a[168:171], v[160:163], v[184:187], a[168:171]
    v_exp_f32 v173, v173
    v_mfma_f32_16x16x32_bf16 a[196:199], v[164:167], v[184:187], a[196:199]
    s_mov_b32 m0, s30
    v_mfma_f32_16x16x32_bf16 v[176:179], a[224:227], v[40:43], v[216:219]
    v_exp_f32 v174, v174
    v_mfma_f32_16x16x32_bf16 v[176:179], a[228:231], v[44:47], v[176:179]
    v_cvt_pk_bf16_f32 v184, v168, v169
    v_add_f32 v20, v20, v21
    v_mfma_f32_16x16x32_bf16 v[176:179], a[232:235], v[48:51], v[176:179]
    v_exp_f32 v175, v175
    v_mfma_f32_16x16x32_bf16 v[176:179], a[236:239], v[52:55], v[176:179]
    v_cvt_pk_bf16_f32 v185, v170, v171
    v_add_f32 v22, v172, v173
    v_mfma_f32_16x16x32_bf16 v[180:183], a[240:243], v[40:43], v[216:219]
    v_add_f32 v20, v20, v247
    v_cvt_pk_bf16_f32 v186, v172, v173
    v_mfma_f32_16x16x32_bf16 v[180:183], a[244:247], v[44:47], v[180:183]
    v_add_f32 v240, v174, v175
    v_cvt_pk_bf16_f32 v187, v174, v175
    v_mfma_f32_16x16x32_bf16 v[180:183], a[248:251], v[48:51], v[180:183]
    v_add_f32 v240, v240, v22
    v_add_f32 v240, v240, v20
    v_mfma_f32_16x16x32_bf16 v[180:183], a[252:255], v[52:55], v[180:183]
    buffer_load_dwordx4 v2, s[16:19], s44 offen offset:0 nt lds
    v_mfma_f32_16x16x32_bf16 a[4:7], v[136:139], v[188:191], a[4:7]
    v_exp_f32 v176, v176
    v_mfma_f32_16x16x32_bf16 a[32:35], v[140:143], v[188:191], a[32:35]
    v_exp_f32 v177, v177
    v_mfma_f32_16x16x32_bf16 a[60:63], v[144:147], v[188:191], a[60:63]
    v_exp_f32 v178, v178
    v_mfma_f32_16x16x32_bf16 a[88:91], v[148:151], v[188:191], a[88:91]
    v_exp_f32 v179, v179
    v_mfma_f32_16x16x32_bf16 a[116:119], v[152:155], v[188:191], a[116:119]
    v_exp_f32 v180, v180
    v_mfma_f32_16x16x32_bf16 a[144:147], v[156:159], v[188:191], a[144:147]
    v_add_f32 v20, v176, v177
    v_add_f32 v21, v178, v179
    v_mfma_f32_16x16x32_bf16 a[172:175], v[160:163], v[188:191], a[172:175]
    v_exp_f32 v181, v181
    v_mfma_f32_16x16x32_bf16 a[200:203], v[164:167], v[188:191], a[200:203]
    buffer_load_dwordx4 v3, s[16:19], s44 offen offset:1024 nt lds
    v_mfma_f32_16x16x32_bf16 v[168:171], a[224:227], v[56:59], v[220:223]
    v_exp_f32 v182, v182
    v_mfma_f32_16x16x32_bf16 v[168:171], a[228:231], v[60:63], v[168:171]
    v_cvt_pk_bf16_f32 v188, v176, v177
    v_add_f32 v20, v20, v21
    v_mfma_f32_16x16x32_bf16 v[168:171], a[232:235], v[64:67], v[168:171]
    v_exp_f32 v183, v183
    v_mfma_f32_16x16x32_bf16 v[168:171], a[236:239], v[68:71], v[168:171]
    v_cvt_pk_bf16_f32 v189, v178, v179
    v_add_f32 v22, v180, v181
    v_mfma_f32_16x16x32_bf16 v[172:175], a[240:243], v[56:59], v[220:223]
    v_add_f32 v20, v20, v248
    v_cvt_pk_bf16_f32 v190, v180, v181
    v_mfma_f32_16x16x32_bf16 v[172:175], a[244:247], v[60:63], v[172:175]
    v_add_f32 v241, v182, v183
    v_cvt_pk_bf16_f32 v191, v182, v183
    v_mfma_f32_16x16x32_bf16 v[172:175], a[248:251], v[64:67], v[172:175]
    v_add_f32 v241, v241, v22
    v_add_f32 v241, v241, v20
    v_mfma_f32_16x16x32_bf16 v[172:175], a[252:255], v[68:71], v[172:175]
    buffer_load_dwordx4 v4, s[16:19], s44 offen offset:2048 nt lds
    v_mfma_f32_16x16x32_bf16 a[8:11], v[136:139], v[192:195], a[8:11]
    v_exp_f32 v168, v168
    v_mfma_f32_16x16x32_bf16 a[36:39], v[140:143], v[192:195], a[36:39]
    v_exp_f32 v169, v169
    v_mfma_f32_16x16x32_bf16 a[64:67], v[144:147], v[192:195], a[64:67]
    v_exp_f32 v170, v170
    v_mfma_f32_16x16x32_bf16 a[92:95], v[148:151], v[192:195], a[92:95]
    v_exp_f32 v171, v171
    v_mfma_f32_16x16x32_bf16 a[120:123], v[152:155], v[192:195], a[120:123]
    v_exp_f32 v172, v172
    v_mfma_f32_16x16x32_bf16 a[148:151], v[156:159], v[192:195], a[148:151]
    v_add_f32 v20, v168, v169
    v_add_f32 v21, v170, v171
    v_mfma_f32_16x16x32_bf16 a[176:179], v[160:163], v[192:195], a[176:179]
    v_exp_f32 v173, v173
    v_mfma_f32_16x16x32_bf16 a[204:207], v[164:167], v[192:195], a[204:207]
    buffer_load_dwordx4 v5, s[16:19], s44 offen offset:3072 nt lds
    s_mov_b32 m0, s31
    v_mfma_f32_16x16x32_bf16 v[176:179], a[224:227], v[72:75], v[224:227]
    v_exp_f32 v174, v174
    v_mfma_f32_16x16x32_bf16 v[176:179], a[228:231], v[76:79], v[176:179]
    v_cvt_pk_bf16_f32 v192, v168, v169
    v_add_f32 v20, v20, v21
    v_mfma_f32_16x16x32_bf16 v[176:179], a[232:235], v[80:83], v[176:179]
    v_exp_f32 v175, v175
    v_mfma_f32_16x16x32_bf16 v[176:179], a[236:239], v[84:87], v[176:179]
    v_cvt_pk_bf16_f32 v193, v170, v171
    v_add_f32 v22, v172, v173
    v_mfma_f32_16x16x32_bf16 v[180:183], a[240:243], v[72:75], v[224:227]
    v_add_f32 v20, v20, v249
    v_cvt_pk_bf16_f32 v194, v172, v173
    v_mfma_f32_16x16x32_bf16 v[180:183], a[244:247], v[76:79], v[180:183]
    v_add_f32 v242, v174, v175
    v_cvt_pk_bf16_f32 v195, v174, v175
    v_mfma_f32_16x16x32_bf16 v[180:183], a[248:251], v[80:83], v[180:183]
    v_add_f32 v242, v242, v22
    v_add_f32 v242, v242, v20
    v_mfma_f32_16x16x32_bf16 v[180:183], a[252:255], v[84:87], v[180:183]
    s_add_u32 s44, s44, 8192
    buffer_load_dwordx4 v2, s[16:19], s45 offen offset:0 nt lds
    v_mfma_f32_16x16x32_bf16 a[12:15], v[136:139], v[196:199], a[12:15]
    v_exp_f32 v176, v176
    v_mfma_f32_16x16x32_bf16 a[40:43], v[140:143], v[196:199], a[40:43]
    v_exp_f32 v177, v177
    v_mfma_f32_16x16x32_bf16 a[68:71], v[144:147], v[196:199], a[68:71]
    v_exp_f32 v178, v178
    v_mfma_f32_16x16x32_bf16 a[96:99], v[148:151], v[196:199], a[96:99]
    v_exp_f32 v179, v179
    v_mfma_f32_16x16x32_bf16 a[124:127], v[152:155], v[196:199], a[124:127]
    v_exp_f32 v180, v180
    v_mfma_f32_16x16x32_bf16 a[152:155], v[156:159], v[196:199], a[152:155]
    v_add_f32 v20, v176, v177
    v_add_f32 v21, v178, v179
    v_mfma_f32_16x16x32_bf16 a[180:183], v[160:163], v[196:199], a[180:183]
    v_exp_f32 v181, v181
    v_mfma_f32_16x16x32_bf16 a[208:211], v[164:167], v[196:199], a[208:211]
    buffer_load_dwordx4 v3, s[16:19], s45 offen offset:1024 nt lds
    v_mfma_f32_16x16x32_bf16 v[168:171], a[224:227], v[88:91], v[228:231]
    v_exp_f32 v182, v182
    v_mfma_f32_16x16x32_bf16 v[168:171], a[228:231], v[92:95], v[168:171]
    v_cvt_pk_bf16_f32 v196, v176, v177
    v_add_f32 v20, v20, v21
    v_mfma_f32_16x16x32_bf16 v[168:171], a[232:235], v[96:99], v[168:171]
    v_exp_f32 v183, v183
    v_mfma_f32_16x16x32_bf16 v[168:171], a[236:239], v[100:103], v[168:171]
    v_cvt_pk_bf16_f32 v197, v178, v179
    v_add_f32 v22, v180, v181
    v_mfma_f32_16x16x32_bf16 v[172:175], a[240:243], v[88:91], v[228:231]
    v_add_f32 v20, v20, v250
    v_cvt_pk_bf16_f32 v198, v180, v181
    v_mfma_f32_16x16x32_bf16 v[172:175], a[244:247], v[92:95], v[172:175]
    v_add_f32 v243, v182, v183
    v_cvt_pk_bf16_f32 v199, v182, v183
    v_mfma_f32_16x16x32_bf16 v[172:175], a[248:251], v[96:99], v[172:175]
    v_add_f32 v243, v243, v22
    v_add_f32 v243, v243, v20
    v_mfma_f32_16x16x32_bf16 v[172:175], a[252:255], v[100:103], v[172:175]
    buffer_load_dwordx4 v4, s[16:19], s45 offen offset:2048 nt lds
    v_mfma_f32_16x16x32_bf16 a[16:19], v[136:139], v[200:203], a[16:19]
    v_exp_f32 v168, v168
    v_mfma_f32_16x16x32_bf16 a[44:47], v[140:143], v[200:203], a[44:47]
    v_exp_f32 v169, v169
    v_mfma_f32_16x16x32_bf16 a[72:75], v[144:147], v[200:203], a[72:75]
    v_exp_f32 v170, v170
    v_mfma_f32_16x16x32_bf16 a[100:103], v[148:151], v[200:203], a[100:103]
    v_exp_f32 v171, v171
    v_mfma_f32_16x16x32_bf16 a[128:131], v[152:155], v[200:203], a[128:131]
    v_exp_f32 v172, v172
    v_mfma_f32_16x16x32_bf16 a[156:159], v[156:159], v[200:203], a[156:159]
    v_add_f32 v20, v168, v169
    v_add_f32 v21, v170, v171
    v_mfma_f32_16x16x32_bf16 a[184:187], v[160:163], v[200:203], a[184:187]
    v_exp_f32 v173, v173
    v_mfma_f32_16x16x32_bf16 a[212:215], v[164:167], v[200:203], a[212:215]
    buffer_load_dwordx4 v5, s[16:19], s45 offen offset:3072 nt lds
    s_add_u32 s45, s45, 8192
    v_mfma_f32_16x16x32_bf16 v[176:179], a[224:227], v[104:107], v[232:235]
    v_exp_f32 v174, v174
    v_mfma_f32_16x16x32_bf16 v[176:179], a[228:231], v[108:111], v[176:179]
    v_cvt_pk_bf16_f32 v200, v168, v169
    v_add_f32 v20, v20, v21
    v_mfma_f32_16x16x32_bf16 v[176:179], a[232:235], v[112:115], v[176:179]
    v_exp_f32 v175, v175
    v_mfma_f32_16x16x32_bf16 v[176:179], a[236:239], v[116:119], v[176:179]
    v_cvt_pk_bf16_f32 v201, v170, v171
    v_add_f32 v22, v172, v173
    v_mfma_f32_16x16x32_bf16 v[180:183], a[240:243], v[104:107], v[232:235]
    v_add_f32 v20, v20, v251
    v_cvt_pk_bf16_f32 v202, v172, v173
    v_mfma_f32_16x16x32_bf16 v[180:183], a[244:247], v[108:111], v[180:183]
    v_add_f32 v244, v174, v175
    v_cvt_pk_bf16_f32 v203, v174, v175
    v_mfma_f32_16x16x32_bf16 v[180:183], a[248:251], v[112:115], v[180:183]
    v_add_f32 v244, v244, v22
    v_add_f32 v244, v244, v20
    v_mfma_f32_16x16x32_bf16 v[180:183], a[252:255], v[116:119], v[180:183]
    v_mfma_f32_16x16x32_bf16 a[20:23], v[136:139], v[204:207], a[20:23]
    v_exp_f32 v176, v176
    v_mfma_f32_16x16x32_bf16 a[48:51], v[140:143], v[204:207], a[48:51]
    v_exp_f32 v177, v177
    v_mfma_f32_16x16x32_bf16 a[76:79], v[144:147], v[204:207], a[76:79]
    v_exp_f32 v178, v178
    v_mfma_f32_16x16x32_bf16 a[104:107], v[148:151], v[204:207], a[104:107]
    v_exp_f32 v179, v179
    v_mfma_f32_16x16x32_bf16 a[132:135], v[152:155], v[204:207], a[132:135]
    v_exp_f32 v180, v180
    v_mfma_f32_16x16x32_bf16 a[160:163], v[156:159], v[204:207], a[160:163]
    v_add_f32 v20, v176, v177
    v_add_f32 v21, v178, v179
    v_mfma_f32_16x16x32_bf16 a[188:191], v[160:163], v[204:207], a[188:191]
    v_exp_f32 v181, v181
    v_mfma_f32_16x16x32_bf16 a[216:219], v[164:167], v[204:207], a[216:219]
    s_waitcnt vmcnt(24)
    v_max3_f32 v23, v240, v241, v242
    v_max3_f32 v23, v23, v243, v244
    v_mfma_f32_16x16x32_bf16 v[168:171], a[224:227], v[120:123], v[236:239]
    v_exp_f32 v182, v182
    ds_read_b128 a[224:227], v6 offset:16384
    v_mfma_f32_16x16x32_bf16 v[168:171], a[228:231], v[124:127], v[168:171]
    v_cvt_pk_bf16_f32 v204, v176, v177
    v_add_f32 v20, v20, v21
    ds_read_b128 a[228:231], v7 offset:16384
    v_mfma_f32_16x16x32_bf16 v[168:171], a[232:235], v[128:131], v[168:171]
    v_exp_f32 v183, v183
    ds_read_b128 a[232:235], v8 offset:16384
    v_mfma_f32_16x16x32_bf16 v[168:171], a[236:239], v[132:135], v[168:171]
    v_cvt_pk_bf16_f32 v205, v178, v179
    v_add_f32 v22, v180, v181
    ds_read_b128 a[236:239], v9 offset:16384
    v_mfma_f32_16x16x32_bf16 v[172:175], a[240:243], v[120:123], v[236:239]
    v_add_f32 v20, v20, v252
    v_cvt_pk_bf16_f32 v206, v180, v181
    ds_read_b128 a[240:243], v6 offset:20480
    v_mfma_f32_16x16x32_bf16 v[172:175], a[244:247], v[124:127], v[172:175]
    v_add_f32 v245, v182, v183
    v_cvt_pk_bf16_f32 v207, v182, v183
    ds_read_b128 a[244:247], v7 offset:20480
    v_mfma_f32_16x16x32_bf16 v[172:175], a[248:251], v[128:131], v[172:175]
    v_add_f32 v245, v245, v22
    v_add_f32 v245, v245, v20
    ds_read_b128 a[248:251], v8 offset:20480
    v_mfma_f32_16x16x32_bf16 v[172:175], a[252:255], v[132:135], v[172:175]
    ds_read_b128 a[252:255], v9 offset:20480
    v_mfma_f32_16x16x32_bf16 a[24:27], v[136:139], v[208:211], a[24:27]
    v_exp_f32 v168, v168
    v_mfma_f32_16x16x32_bf16 a[52:55], v[140:143], v[208:211], a[52:55]
    v_exp_f32 v169, v169
    v_mfma_f32_16x16x32_bf16 a[80:83], v[144:147], v[208:211], a[80:83]
    v_exp_f32 v170, v170
    v_mfma_f32_16x16x32_bf16 a[108:111], v[148:151], v[208:211], a[108:111]
    v_exp_f32 v171, v171
    v_mfma_f32_16x16x32_bf16 a[136:139], v[152:155], v[208:211], a[136:139]
    v_exp_f32 v172, v172
    v_mfma_f32_16x16x32_bf16 a[164:167], v[156:159], v[208:211], a[164:167]
    v_exp_f32 v173, v173
    v_mfma_f32_16x16x32_bf16 a[192:195], v[160:163], v[208:211], a[192:195]
    v_exp_f32 v174, v174
    v_mfma_f32_16x16x32_bf16 a[220:223], v[164:167], v[208:211], a[220:223]
    v_exp_f32 v175, v175
    v_add_f32 v20, v168, v169
    v_add_f32 v21, v170, v171
    v_add_f32 v22, v172, v173
    v_add_f32 v20, v20, v21
    v_add_f32 v246, v174, v175
    v_add_f32 v20, v20, v253
    v_add_f32 v246, v246, v22
    v_add_f32 v246, v246, v20
    v_max3_f32 v23, v23, v245, v246
    v_cmp_lt_f32 vcc, 0x49800000, v23
    v_cvt_pk_bf16_f32 v208, v168, v169
    v_cvt_pk_bf16_f32 v209, v170, v171
    v_cvt_pk_bf16_f32 v210, v172, v173
    v_cvt_pk_bf16_f32 v211, v174, v175
    s_waitcnt vmcnt(16)
    s_cbranch_vccnz L_slowE
L_slowE_ret:
    ds_read_b64_tr_b16 v[136:137], v10 offset:8192
    ds_read_b64_tr_b16 v[138:139], v10 offset:12288
    ds_read_b64_tr_b16 v[140:141], v11 offset:8192
    ds_read_b64_tr_b16 v[142:143], v11 offset:12288
    ds_read_b64_tr_b16 v[144:145], v12 offset:8192
    ds_read_b64_tr_b16 v[146:147], v12 offset:12288
    ds_read_b64_tr_b16 v[148:149], v13 offset:8192
    ds_read_b64_tr_b16 v[150:151], v13 offset:12288
    ds_read_b64_tr_b16 v[152:153], v14 offset:8192
    ds_read_b64_tr_b16 v[154:155], v14 offset:12288
    ds_read_b64_tr_b16 v[156:157], v15 offset:8192
    ds_read_b64_tr_b16 v[158:159], v15 offset:12288
    ds_read_b64_tr_b16 v[160:161], v16 offset:8192
    ds_read_b64_tr_b16 v[162:163], v16 offset:12288
    ds_read_b64_tr_b16 v[164:165], v17 offset:8192
    ds_read_b64_tr_b16 v[166:167], v17 offset:12288
    s_waitcnt lgkmcnt(15)
    s_mov_b32 m0, s28
    v_mfma_f32_16x16x32_bf16 v[168:171], a[224:227], v[24:27], v[212:215]
    buffer_load_dwordx4 v2, s[12:15], s42 offen offset:0 nt lds
    v_mfma_f32_16x16x32_bf16 v[168:171], a[228:231], v[28:31], v[168:171]
    buffer_load_dwordx4 v3, s[12:15], s42 offen offset:1024 nt lds
    v_mfma_f32_16x16x32_bf16 v[168:171], a[232:235], v[32:35], v[168:171]
    buffer_load_dwordx4 v4, s[12:15], s42 offen offset:2048 nt lds
    v_mfma_f32_16x16x32_bf16 v[168:171], a[236:239], v[36:39], v[168:171]
    buffer_load_dwordx4 v5, s[12:15], s42 offen offset:3072 nt lds
    s_mov_b32 m0, s29
    v_mfma_f32_16x16x32_bf16 v[172:175], a[240:243], v[24:27], v[212:215]
    s_add_u32 s42, s42, 8192
    buffer_load_dwordx4 v2, s[12:15], s43 offen offset:0 nt lds
    v_mfma_f32_16x16x32_bf16 v[172:175], a[244:247], v[28:31], v[172:175]
    buffer_load_dwordx4 v3, s[12:15], s43 offen offset:1024 nt lds
    v_mfma_f32_16x16x32_bf16 v[172:175], a[248:251], v[32:35], v[172:175]
    buffer_load_dwordx4 v4, s[12:15], s43 offen offset:2048 nt lds
    v_mfma_f32_16x16x32_bf16 v[172:175], a[252:255], v[36:39], v[172:175]
    s_waitcnt lgkmcnt(8)
    buffer_load_dwordx4 v5, s[12:15], s43 offen offset:3072 nt lds
    s_add_u32 s43, s43, 8192
    v_mfma_f32_16x16x32_bf16 a[0:3], v[136:139], v[184:187], a[0:3]
    v_exp_f32 v168, v168
    v_mfma_f32_16x16x32_bf16 a[28:31], v[140:143], v[184:187], a[28:31]
    v_exp_f32 v169, v169
    v_mfma_f32_16x16x32_bf16 a[56:59], v[144:147], v[184:187], a[56:59]
    v_exp_f32 v170, v170
    v_mfma_f32_16x16x32_bf16 a[84:87], v[148:151], v[184:187], a[84:87]
    s_waitcnt lgkmcnt(0)
    v_exp_f32 v171, v171
    v_mfma_f32_16x16x32_bf16 a[112:115], v[152:155], v[184:187], a[112:115]
    v_exp_f32 v172, v172
    v_mfma_f32_16x16x32_bf16 a[140:143], v[156:159], v[184:187], a[140:143]
    v_add_f32 v20, v168, v169
    v_add_f32 v21, v170, v171
    v_mfma_f32_16x16x32_bf16 a[168:171], v[160:163], v[184:187], a[168:171]
    v_exp_f32 v173, v173
    v_mfma_f32_16x16x32_bf16 a[196:199], v[164:167], v[184:187], a[196:199]
    s_mov_b32 m0, s26
    v_mfma_f32_16x16x32_bf16 v[176:179], a[224:227], v[40:43], v[216:219]
    v_exp_f32 v174, v174
    v_mfma_f32_16x16x32_bf16 v[176:179], a[228:231], v[44:47], v[176:179]
    v_cvt_pk_bf16_f32 v184, v168, v169
    v_add_f32 v20, v20, v21
    v_mfma_f32_16x16x32_bf16 v[176:179], a[232:235], v[48:51], v[176:179]
    v_exp_f32 v175, v175
    v_mfma_f32_16x16x32_bf16 v[176:179], a[236:239], v[52:55], v[176:179]
    v_cvt_pk_bf16_f32 v185, v170, v171
    v_add_f32 v22, v172, v173
    v_mfma_f32_16x16x32_bf16 v[180:183], a[240:243], v[40:43], v[216:219]
    v_add_f32 v20, v20, v240
    v_cvt_pk_bf16_f32 v186, v172, v173
    v_mfma_f32_16x16x32_bf16 v[180:183], a[244:247], v[44:47], v[180:183]
    v_add_f32 v247, v174, v175
    v_cvt_pk_bf16_f32 v187, v174, v175
    v_mfma_f32_16x16x32_bf16 v[180:183], a[248:251], v[48:51], v[180:183]
    v_add_f32 v247, v247, v22
    v_add_f32 v247, v247, v20
    v_mfma_f32_16x16x32_bf16 v[180:183], a[252:255], v[52:55], v[180:183]
    buffer_load_dwordx4 v2, s[16:19], s44 offen offset:0 nt lds
    v_mfma_f32_16x16x32_bf16 a[4:7], v[136:139], v[188:191], a[4:7]
    v_exp_f32 v176, v176
    v_mfma_f32_16x16x32_bf16 a[32:35], v[140:143], v[188:191], a[32:35]
    v_exp_f32 v177, v177
    v_mfma_f32_16x16x32_bf16 a[60:63], v[144:147], v[188:191], a[60:63]
    v_exp_f32 v178, v178
    v_mfma_f32_16x16x32_bf16 a[88:91], v[148:151], v[188:191], a[88:91]
    v_exp_f32 v179, v179
    v_mfma_f32_16x16x32_bf16 a[116:119], v[152:155], v[188:191], a[116:119]
    v_exp_f32 v180, v180
    v_mfma_f32_16x16x32_bf16 a[144:147], v[156:159], v[188:191], a[144:147]
    v_add_f32 v20, v176, v177
    v_add_f32 v21, v178, v179
    v_mfma_f32_16x16x32_bf16 a[172:175], v[160:163], v[188:191], a[172:175]
    v_exp_f32 v181, v181
    v_mfma_f32_16x16x32_bf16 a[200:203], v[164:167], v[188:191], a[200:203]
    buffer_load_dwordx4 v3, s[16:19], s44 offen offset:1024 nt lds
    v_mfma_f32_16x16x32_bf16 v[168:171], a[224:227], v[56:59], v[220:223]
    v_exp_f32 v182, v182
    v_mfma_f32_16x16x32_bf16 v[168:171], a[228:231], v[60:63], v[168:171]
    v_cvt_pk_bf16_f32 v188, v176, v177
    v_add_f32 v20, v20, v21
    v_mfma_f32_16x16x32_bf16 v[168:171], a[232:235], v[64:67], v[168:171]
    v_exp_f32 v183, v183
    v_mfma_f32_16x16x32_bf16 v[168:171], a[236:239], v[68:71], v[168:171]
    v_cvt_pk_bf16_f32 v189, v178, v179
    v_add_f32 v22, v180, v181
    v_mfma_f32_16x16x32_bf16 v[172:175], a[240:243], v[56:59], v[220:223]
    v_add_f32 v20, v20, v241
    v_cvt_pk_bf16_f32 v190, v180, v181
    v_mfma_f32_16x16x32_bf16 v[172:175], a[244:247], v[60:63], v[172:175]
    v_add_f32 v248, v182, v183
    v_cvt_pk_bf16_f32 v191, v182, v183
    v_mfma_f32_16x16x32_bf16 v[172:175], a[248:251], v[64:67], v[172:175]
    v_add_f32 v248, v248, v22
    v_add_f32 v248, v248, v20
    v_mfma_f32_16x16x32_bf16 v[172:175], a[252:255], v[68:71], v[172:175]
    buffer_load_dwordx4 v4, s[16:19], s44 offen offset:2048 nt lds
    v_mfma_f32_16x16x32_bf16 a[8:11], v[136:139], v[192:195], a[8:11]
    v_exp_f32 v168, v168
    v_mfma_f32_16x16x32_bf16 a[36:39], v[140:143], v[192:195], a[36:39]
    v_exp_f32 v169, v169
    v_mfma_f32_16x16x32_bf16 a[64:67], v[144:147], v[192:195], a[64:67]
    v_exp_f32 v170, v170
    v_mfma_f32_16x16x32_bf16 a[92:95], v[148:151], v[192:195], a[92:95]
    v_exp_f32 v171, v171
    v_mfma_f32_16x16x32_bf16 a[120:123], v[152:155], v[192:195], a[120:123]
    v_exp_f32 v172, v172
    v_mfma_f32_16x16x32_bf16 a[148:151], v[156:159], v[192:195], a[148:151]
    v_add_f32 v20, v168, v169
    v_add_f32 v21, v170, v171
    v_mfma_f32_16x16x32_bf16 a[176:179], v[160:163], v[192:195], a[176:179]
    v_exp_f32 v173, v173
    v_mfma_f32_16x16x32_bf16 a[204:207], v[164:167], v[192:195], a[204:207]
    buffer_load_dwordx4 v5, s[16:19], s44 offen offset:3072 nt lds
    s_mov_b32 m0, s27
    v_mfma_f32_16x16x32_bf16 v[176:179], a[224:227], v[72:75], v[224:227]
    v_exp_f32 v174, v174
    v_mfma_f32_16x16x32_bf16 v[176:179], a[228:231], v[76:79], v[176:179]
    v_cvt_pk_bf16_f32 v192, v168, v169
    v_add_f32 v20, v20, v21
    v_mfma_f32_16x16x32_bf16 v[176:179], a[232:235], v[80:83], v[176:179]
    v_exp_f32 v175, v175
    v_mfma_f32_16x16x32_bf16 v[176:179], a[236:239], v[84:87], v[176:179]
    v_cvt_pk_bf16_f32 v193, v170, v171
    v_add_f32 v22, v172, v173
    v_mfma_f32_16x16x32_bf16 v[180:183], a[240:243], v[72:75], v[224:227]
    v_add_f32 v20, v20, v242
    v_cvt_pk_bf16_f32 v194, v172, v173
    v_mfma_f32_16x16x32_bf16 v[180:183], a[244:247], v[76:79], v[180:183]
    v_add_f32 v249, v174, v175
    v_cvt_pk_bf16_f32 v195, v174, v175
    v_mfma_f32_16x16x32_bf16 v[180:183], a[248:251], v[80:83], v[180:183]
    v_add_f32 v249, v249, v22
    v_add_f32 v249, v249, v20
    v_mfma_f32_16x16x32_bf16 v[180:183], a[252:255], v[84:87], v[180:183]
    s_add_u32 s44, s44, 8192
    buffer_load_dwordx4 v2, s[16:19], s45 offen offset:0 nt lds
    v_mfma_f32_16x16x32_bf16 a[12:15], v[136:139], v[196:199], a[12:15]
    v_exp_f32 v176, v176
    v_mfma_f32_16x16x32_bf16 a[40:43], v[140:143], v[196:199], a[40:43]
    v_exp_f32 v177, v177
    v_mfma_f32_16x16x32_bf16 a[68:71], v[144:147], v[196:199], a[68:71]
    v_exp_f32 v178, v178
    v_mfma_f32_16x16x32_bf16 a[96:99], v[148:151], v[196:199], a[96:99]
    v_exp_f32 v179, v179
    v_mfma_f32_16x16x32_bf16 a[124:127], v[152:155], v[196:199], a[124:127]
    v_exp_f32 v180, v180
    v_mfma_f32_16x16x32_bf16 a[152:155], v[156:159], v[196:199], a[152:155]
    v_add_f32 v20, v176, v177
    v_add_f32 v21, v178, v179
    v_mfma_f32_16x16x32_bf16 a[180:183], v[160:163], v[196:199], a[180:183]
    v_exp_f32 v181, v181
    v_mfma_f32_16x16x32_bf16 a[208:211], v[164:167], v[196:199], a[208:211]
    buffer_load_dwordx4 v3, s[16:19], s45 offen offset:1024 nt lds
    v_mfma_f32_16x16x32_bf16 v[168:171], a[224:227], v[88:91], v[228:231]
    v_exp_f32 v182, v182
    v_mfma_f32_16x16x32_bf16 v[168:171], a[228:231], v[92:95], v[168:171]
    v_cvt_pk_bf16_f32 v196, v176, v177
    v_add_f32 v20, v20, v21
    v_mfma_f32_16x16x32_bf16 v[168:171], a[232:235], v[96:99], v[168:171]
    v_exp_f32 v183, v183
    v_mfma_f32_16x16x32_bf16 v[168:171], a[236:239], v[100:103], v[168:171]
    v_cvt_pk_bf16_f32 v197, v178, v179
    v_add_f32 v22, v180, v181
    v_mfma_f32_16x16x32_bf16 v[172:175], a[240:243], v[88:91], v[228:231]
    v_add_f32 v20, v20, v243
    v_cvt_pk_bf16_f32 v198, v180, v181
    v_mfma_f32_16x16x32_bf16 v[172:175], a[244:247], v[92:95], v[172:175]
    v_add_f32 v250, v182, v183
    v_cvt_pk_bf16_f32 v199, v182, v183
    v_mfma_f32_16x16x32_bf16 v[172:175], a[248:251], v[96:99], v[172:175]
    v_add_f32 v250, v250, v22
    v_add_f32 v250, v250, v20
    v_mfma_f32_16x16x32_bf16 v[172:175], a[252:255], v[100:103], v[172:175]
    buffer_load_dwordx4 v4, s[16:19], s45 offen offset:2048 nt lds
    v_mfma_f32_16x16x32_bf16 a[16:19], v[136:139], v[200:203], a[16:19]
    v_exp_f32 v168, v168
    v_mfma_f32_16x16x32_bf16 a[44:47], v[140:143], v[200:203], a[44:47]
    v_exp_f32 v169, v169
    v_mfma_f32_16x16x32_bf16 a[72:75], v[144:147], v[200:203], a[72:75]
    v_exp_f32 v170, v170
    v_mfma_f32_16x16x32_bf16 a[100:103], v[148:151], v[200:203], a[100:103]
    v_exp_f32 v171, v171
    v_mfma_f32_16x16x32_bf16 a[128:131], v[152:155], v[200:203], a[128:131]
    v_exp_f32 v172, v172
    v_mfma_f32_16x16x32_bf16 a[156:159], v[156:159], v[200:203], a[156:159]
    v_add_f32 v20, v168, v169
    v_add_f32 v21, v170, v171
    v_mfma_f32_16x16x32_bf16 a[184:187], v[160:163], v[200:203], a[184:187]
    v_exp_f32 v173, v173
    v_mfma_f32_16x16x32_bf16 a[212:215], v[164:167], v[200:203], a[212:215]
    buffer_load_dwordx4 v5, s[16:19], s45 offen offset:3072 nt lds
    s_add_u32 s45, s45, 8192
    v_mfma_f32_16x16x32_bf16 v[176:179], a[224:227], v[104:107], v[232:235]
    v_exp_f32 v174, v174
    v_mfma_f32_16x16x32_bf16 v[176:179], a[228:231], v[108:111], v[176:179]
    v_cvt_pk_bf16_f32 v200, v168, v169
    v_add_f32 v20, v20, v21
    v_mfma_f32_16x16x32_bf16 v[176:179], a[232:235], v[112:115], v[176:179]
    v_exp_f32 v175, v175
    v_mfma_f32_16x16x32_bf16 v[176:179], a[236:239], v[116:119], v[176:179]
    v_cvt_pk_bf16_f32 v201, v170, v171
    v_add_f32 v22, v172, v173
    v_mfma_f32_16x16x32_bf16 v[180:183], a[240:243], v[104:107], v[232:235]
    v_add_f32 v20, v20, v244
    v_cvt_pk_bf16_f32 v202, v172, v173
    v_mfma_f32_16x16x32_bf16 v[180:183], a[244:247], v[108:111], v[180:183]
    v_add_f32 v251, v174, v175
    v_cvt_pk_bf16_f32 v203, v174, v175
    v_mfma_f32_16x16x32_bf16 v[180:183], a[248:251], v[112:115], v[180:183]
    v_add_f32 v251, v251, v22
    v_add_f32 v251, v251, v20
    v_mfma_f32_16x16x32_bf16 v[180:183], a[252:255], v[116:119], v[180:183]
    v_mfma_f32_16x16x32_bf16 a[20:23], v[136:139], v[204:207], a[20:23]
    v_exp_f32 v176, v176
    v_mfma_f32_16x16x32_bf16 a[48:51], v[140:143], v[204:207], a[48:51]
    v_exp_f32 v177, v177
    v_mfma_f32_16x16x32_bf16 a[76:79], v[144:147], v[204:207], a[76:79]
    v_exp_f32 v178, v178
    v_mfma_f32_16x16x32_bf16 a[104:107], v[148:151], v[204:207], a[104:107]
    v_exp_f32 v179, v179
    v_mfma_f32_16x16x32_bf16 a[132:135], v[152:155], v[204:207], a[132:135]
    v_exp_f32 v180, v180
    v_mfma_f32_16x16x32_bf16 a[160:163], v[156:159], v[204:207], a[160:163]
    v_add_f32 v20, v176, v177
    v_add_f32 v21, v178, v179
    v_mfma_f32_16x16x32_bf16 a[188:191], v[160:163], v[204:207], a[188:191]
    v_exp_f32 v181, v181
    v_mfma_f32_16x16x32_bf16 a[216:219], v[164:167], v[204:207], a[216:219]
    s_waitcnt vmcnt(24)
    v_max3_f32 v23, v247, v248, v249
    v_max3_f32 v23, v23, v250, v251
    v_mfma_f32_16x16x32_bf16 v[168:171], a[224:227], v[120:123], v[236:239]
    v_exp_f32 v182, v182
    ds_read_b128 a[224:227], v6 offset:0
    v_mfma_f32_16x16x32_bf16 v[168:171], a[228:231], v[124:127], v[168:171]
    v_cvt_pk_bf16_f32 v204, v176, v177
    v_add_f32 v20, v20, v21
    ds_read_b128 a[228:231], v7 offset:0
    v_mfma_f32_16x16x32_bf16 v[168:171], a[232:235], v[128:131], v[168:171]
    v_exp_f32 v183, v183
    ds_read_b128 a[232:235], v8 offset:0
    v_mfma_f32_16x16x32_bf16 v[168:171], a[236:239], v[132:135], v[168:171]
    v_cvt_pk_bf16_f32 v205, v178, v179
    v_add_f32 v22, v180, v181
    ds_read_b128 a[236:239], v9 offset:0
    v_mfma_f32_16x16x32_bf16 v[172:175], a[240:243], v[120:123], v[236:239]
    v_add_f32 v20, v20, v245
    v_cvt_pk_bf16_f32 v206, v180, v181
    ds_read_b128 a[240:243], v6 offset:4096
    v_mfma_f32_16x16x32_bf16 v[172:175], a[244:247], v[124:127], v[172:175]
    v_add_f32 v252, v182, v183
    v_cvt_pk_bf16_f32 v207, v182, v183
    ds_read_b128 a[244:247], v7 offset:4096
    v_mfma_f32_16x16x32_bf16 v[172:175], a[248:251], v[128:131], v[172:175]
    v_add_f32 v252, v252, v22
    v_add_f32 v252, v252, v20
    ds_read_b128 a[248:251], v8 offset:4096
    v_mfma_f32_16x16x32_bf16 v[172:175], a[252:255], v[132:135], v[172:175]
    ds_read_b128 a[252:255], v9 offset:4096
    v_mfma_f32_16x16x32_bf16 a[24:27], v[136:139], v[208:211], a[24:27]
    v_exp_f32 v168, v168
    v_mfma_f32_16x16x32_bf16 a[52:55], v[140:143], v[208:211], a[52:55]
    v_exp_f32 v169, v169
    v_mfma_f32_16x16x32_bf16 a[80:83], v[144:147], v[208:211], a[80:83]
    v_exp_f32 v170, v170
    v_mfma_f32_16x16x32_bf16 a[108:111], v[148:151], v[208:211], a[108:111]
    v_exp_f32 v171, v171
    v_mfma_f32_16x16x32_bf16 a[136:139], v[152:155], v[208:211], a[136:139]
    v_exp_f32 v172, v172
    v_mfma_f32_16x16x32_bf16 a[164:167], v[156:159], v[208:211], a[164:167]
    v_exp_f32 v173, v173
    v_mfma_f32_16x16x32_bf16 a[192:195], v[160:163], v[208:211], a[192:195]
    v_exp_f32 v174, v174
    v_mfma_f32_16x16x32_bf16 a[220:223], v[164:167], v[208:211], a[220:223]
    v_exp_f32 v175, v175
    v_add_f32 v20, v168, v169
    v_add_f32 v21, v170, v171
    v_add_f32 v22, v172, v173
    v_add_f32 v20, v20, v21
    v_add_f32 v253, v174, v175
    v_add_f32 v20, v20, v246
    v_add_f32 v253, v253, v22
    v_add_f32 v253, v253, v20
    v_max3_f32 v23, v23, v252, v253
    v_cmp_lt_f32 vcc, 0x49800000, v23
    v_cvt_pk_bf16_f32 v208, v168, v169
    v_cvt_pk_bf16_f32 v209, v170, v171
    v_cvt_pk_bf16_f32 v210, v172, v173
    v_cvt_pk_bf16_f32 v211, v174, v175
    s_waitcnt vmcnt(16)
    s_cbranch_vccnz L_slowO
L_slowO_ret:
    ds_read_b64_tr_b16 v[136:137], v10 offset:24576
    ds_read_b64_tr_b16 v[138:139], v10 offset:28672
    ds_read_b64_tr_b16 v[140:141], v11 offset:24576
    ds_read_b64_tr_b16 v[142:143], v11 offset:28672
    ds_read_b64_tr_b16 v[144:145], v12 offset:24576
    ds_read_b64_tr_b16 v[146:147], v12 offset:28672
    ds_read_b64_tr_b16 v[148:149], v13 offset:24576
    ds_read_b64_tr_b16 v[150:151], v13 offset:28672
    ds_read_b64_tr_b16 v[152:153], v14 offset:24576
    ds_read_b64_tr_b16 v[154:155], v14 offset:28672
    ds_read_b64_tr_b16 v[156:157], v15 offset:24576
    ds_read_b64_tr_b16 v[158:159], v15 offset:28672
    ds_read_b64_tr_b16 v[160:161], v16 offset:24576
    ds_read_b64_tr_b16 v[162:163], v16 offset:28672
    ds_read_b64_tr_b16 v[164:165], v17 offset:24576
    ds_read_b64_tr_b16 v[166:167], v17 offset:28672
    s_add_u32 s41, s41, 2
    s_cmp_lt_u32 s41, 16
    s_cbranch_scc1 L_loop
    v_lshlrev_b32 v21, 2, v0
    buffer_load_dword v20, v21, s[76:79], 0 offen sc1
    s_waitcnt lgkmcnt(0)
    s_waitcnt lgkmcnt(8)
    v_mfma_f32_16x16x32_bf16 a[0:3], v[136:139], v[184:187], a[0:3]
    v_mov_b32 v18, v247
    s_nop 0
    s_nop 0
    v_permlane16_swap_b32 v247, v18
    v_mfma_f32_16x16x32_bf16 a[28:31], v[140:143], v[184:187], a[28:31]
    v_add_f32 v247, v247, v18
    v_mov_b32 v18, v247
    v_mfma_f32_16x16x32_bf16 a[56:59], v[144:147], v[184:187], a[56:59]
    s_nop 0
    v_permlane32_swap_b32 v247, v18
    v_mfma_f32_16x16x32_bf16 a[84:87], v[148:151], v[184:187], a[84:87]
    s_waitcnt lgkmcnt(0)
    v_add_f32 v247, v247, v18
    v_rcp_f32 v228, v247
    v_rcp_f32 v229, v247
    v_mfma_f32_16x16x32_bf16 a[112:115], v[152:155], v[184:187], a[112:115]
    v_mov_b32 v18, v248
    s_nop 0
    v_mfma_f32_16x16x32_bf16 a[140:143], v[156:159], v[184:187], a[140:143]
    v_permlane16_swap_b32 v248, v18
    v_add_f32 v248, v248, v18
    v_mfma_f32_16x16x32_bf16 a[168:171], v[160:163], v[184:187], a[168:171]
    v_mov_b32 v18, v248
    s_nop 0
    s_nop 0
    v_permlane32_swap_b32 v248, v18
    v_mfma_f32_16x16x32_bf16 a[196:199], v[164:167], v[184:187], a[196:199]
    v_add_f32 v248, v248, v18
    v_rcp_f32 v230, v248
    v_mfma_f32_16x16x32_bf16 a[4:7], v[136:139], v[188:191], a[4:7]
    v_rcp_f32 v231, v248
    v_mov_b32 v18, v249
    v_mfma_f32_16x16x32_bf16 a[32:35], v[140:143], v[188:191], a[32:35]
    s_nop 0
    v_permlane16_swap_b32 v249, v18
    v_add_f32 v249, v249, v18
    v_mfma_f32_16x16x32_bf16 a[60:63], v[144:147], v[188:191], a[60:63]
    v_mov_b32 v18, v249
    s_nop 0
    v_mfma_f32_16x16x32_bf16 a[88:91], v[148:151], v[188:191], a[88:91]
    v_permlane32_swap_b32 v249, v18
    v_add_f32 v249, v249, v18
    v_mfma_f32_16x16x32_bf16 a[116:119], v[152:155], v[188:191], a[116:119]
    v_rcp_f32 v232, v249
    v_rcp_f32 v233, v249
    v_mov_b32 v18, v250
    v_mfma_f32_16x16x32_bf16 a[144:147], v[156:159], v[188:191], a[144:147]
    s_nop 0
    v_permlane16_swap_b32 v250, v18
    v_mfma_f32_16x16x32_bf16 a[172:175], v[160:163], v[188:191], a[172:175]
    v_add_f32 v250, v250, v18
    v_mov_b32 v18, v250
    v_mfma_f32_16x16x32_bf16 a[200:203], v[164:167], v[188:191], a[200:203]
    s_nop 0
    v_permlane32_swap_b32 v250, v18
    v_add_f32 v250, v250, v18
    v_mfma_f32_16x16x32_bf16 a[8:11], v[136:139], v[192:195], a[8:11]
    v_rcp_f32 v234, v250
    v_rcp_f32 v235, v250
    v_mfma_f32_16x16x32_bf16 a[36:39], v[140:143], v[192:195], a[36:39]
    v_mov_b32 v18, v251
    s_nop 0
    v_mfma_f32_16x16x32_bf16 a[64:67], v[144:147], v[192:195], a[64:67]
    v_permlane16_swap_b32 v251, v18
    v_add_f32 v251, v251, v18
    v_mov_b32 v18, v251
    v_mfma_f32_16x16x32_bf16 a[92:95], v[148:151], v[192:195], a[92:95]
    s_nop 0
    v_permlane32_swap_b32 v251, v18
    v_mfma_f32_16x16x32_bf16 a[120:123], v[152:155], v[192:195], a[120:123]
    v_add_f32 v251, v251, v18
    v_rcp_f32 v236, v251
    v_mfma_f32_16x16x32_bf16 a[148:151], v[156:159], v[192:195], a[148:151]
    v_rcp_f32 v237, v251
    v_mov_b32 v18, v252
    s_nop 0
    v_mfma_f32_16x16x32_bf16 a[176:179], v[160:163], v[192:195], a[176:179]
    v_permlane16_swap_b32 v252, v18
    v_add_f32 v252, v252, v18
    v_mfma_f32_16x16x32_bf16 a[204:207], v[164:167], v[192:195], a[204:207]
    v_mov_b32 v18, v252
    s_nop 0
    v_mfma_f32_16x16x32_bf16 a[12:15], v[136:139], v[196:199], a[12:15]
    v_permlane32_swap_b32 v252, v18
    v_add_f32 v252, v252, v18
    v_rcp_f32 v238, v252
    v_mfma_f32_16x16x32_bf16 a[40:43], v[140:143], v[196:199], a[40:43]
    v_rcp_f32 v239, v252
    v_mov_b32 v18, v253
    v_mfma_f32_16x16x32_bf16 a[68:71], v[144:147], v[196:199], a[68:71]
    s_nop 0
    v_permlane16_swap_b32 v253, v18
    v_mfma_f32_16x16x32_bf16 a[96:99], v[148:151], v[196:199], a[96:99]
    v_add_f32 v253, v253, v18
    v_mov_b32 v18, v253
    s_nop 0
    v_mfma_f32_16x16x32_bf16 a[124:127], v[152:155], v[196:199], a[124:127]
    v_permlane32_swap_b32 v253, v18
    v_add_f32 v253, v253, v18
    v_mfma_f32_16x16x32_bf16 a[152:155], v[156:159], v[196:199], a[152:155]
    v_rcp_f32 v240, v253
    v_rcp_f32 v241, v253
    v_mfma_f32_16x16x32_bf16 a[180:183], v[160:163], v[196:199], a[180:183]
    v_accvgpr_read_b32 v168, a0
    v_accvgpr_read_b32 v169, a1
    v_mfma_f32_16x16x32_bf16 a[208:211], v[164:167], v[196:199], a[208:211]
    v_pk_mul_f32 v[168:169], v[168:169], v[228:229]
    v_cvt_pk_bf16_f32 v24, v168, v169
    v_mfma_f32_16x16x32_bf16 a[16:19], v[136:139], v[200:203], a[16:19]
    v_accvgpr_read_b32 v170, a2
    v_accvgpr_read_b32 v171, a3
    v_mfma_f32_16x16x32_bf16 a[44:47], v[140:143], v[200:203], a[44:47]
    v_pk_mul_f32 v[170:171], v[170:171], v[228:229]
    v_cvt_pk_bf16_f32 v25, v170, v171
    v_mfma_f32_16x16x32_bf16 a[72:75], v[144:147], v[200:203], a[72:75]
    v_accvgpr_read_b32 v172, a28
    v_accvgpr_read_b32 v173, a29
    v_mfma_f32_16x16x32_bf16 a[100:103], v[148:151], v[200:203], a[100:103]
    v_pk_mul_f32 v[172:173], v[172:173], v[228:229]
    v_cvt_pk_bf16_f32 v26, v172, v173
    v_mfma_f32_16x16x32_bf16 a[128:131], v[152:155], v[200:203], a[128:131]
    v_accvgpr_read_b32 v174, a30
    v_accvgpr_read_b32 v175, a31
    v_mfma_f32_16x16x32_bf16 a[156:159], v[156:159], v[200:203], a[156:159]
    v_pk_mul_f32 v[174:175], v[174:175], v[228:229]
    v_cvt_pk_bf16_f32 v27, v174, v175
    v_mfma_f32_16x16x32_bf16 a[184:187], v[160:163], v[200:203], a[184:187]
    v_accvgpr_read_b32 v168, a56
    v_accvgpr_read_b32 v169, a57
    v_mfma_f32_16x16x32_bf16 a[212:215], v[164:167], v[200:203], a[212:215]
    v_pk_mul_f32 v[168:169], v[168:169], v[228:229]
    v_cvt_pk_bf16_f32 v52, v168, v169
    v_mfma_f32_16x16x32_bf16 a[20:23], v[136:139], v[204:207], a[20:23]
    v_accvgpr_read_b32 v170, a58
    v_accvgpr_read_b32 v171, a59
    v_mfma_f32_16x16x32_bf16 a[48:51], v[140:143], v[204:207], a[48:51]
    v_pk_mul_f32 v[170:171], v[170:171], v[228:229]
    v_cvt_pk_bf16_f32 v53, v170, v171
    v_mfma_f32_16x16x32_bf16 a[76:79], v[144:147], v[204:207], a[76:79]
    v_accvgpr_read_b32 v172, a84
    v_accvgpr_read_b32 v173, a85
    v_mfma_f32_16x16x32_bf16 a[104:107], v[148:151], v[204:207], a[104:107]
    v_pk_mul_f32 v[172:173], v[172:173], v[228:229]
    v_cvt_pk_bf16_f32 v54, v172, v173
    v_mfma_f32_16x16x32_bf16 a[132:135], v[152:155], v[204:207], a[132:135]
    v_accvgpr_read_b32 v174, a86
    v_accvgpr_read_b32 v175, a87
    v_mfma_f32_16x16x32_bf16 a[160:163], v[156:159], v[204:207], a[160:163]
    v_pk_mul_f32 v[174:175], v[174:175], v[228:229]
    v_cvt_pk_bf16_f32 v55, v174, v175
    v_mfma_f32_16x16x32_bf16 a[188:191], v[160:163], v[204:207], a[188:191]
    v_accvgpr_read_b32 v168, a112
    v_accvgpr_read_b32 v169, a113
    v_mfma_f32_16x16x32_bf16 a[216:219], v[164:167], v[204:207], a[216:219]
    v_pk_mul_f32 v[168:169], v[168:169], v[228:229]
    v_cvt_pk_bf16_f32 v80, v168, v169
    v_mfma_f32_16x16x32_bf16 a[24:27], v[136:139], v[208:211], a[24:27]
    v_accvgpr_read_b32 v170, a114
    v_accvgpr_read_b32 v171, a115
    v_mfma_f32_16x16x32_bf16 a[52:55], v[140:143], v[208:211], a[52:55]
    v_pk_mul_f32 v[170:171], v[170:171], v[228:229]
    v_cvt_pk_bf16_f32 v81, v170, v171
    v_mfma_f32_16x16x32_bf16 a[80:83], v[144:147], v[208:211], a[80:83]
    v_accvgpr_read_b32 v172, a140
    v_accvgpr_read_b32 v173, a141
    v_mfma_f32_16x16x32_bf16 a[108:111], v[148:151], v[208:211], a[108:111]
    v_pk_mul_f32 v[172:173], v[172:173], v[228:229]
    v_cvt_pk_bf16_f32 v82, v172, v173
    v_mfma_f32_16x16x32_bf16 a[136:139], v[152:155], v[208:211], a[136:139]
    v_accvgpr_read_b32 v174, a142
    v_accvgpr_read_b32 v175, a143
    v_mfma_f32_16x16x32_bf16 a[164:167], v[156:159], v[208:211], a[164:167]
    v_pk_mul_f32 v[174:175], v[174:175], v[228:229]
    v_cvt_pk_bf16_f32 v83, v174, v175
    v_mfma_f32_16x16x32_bf16 a[192:195], v[160:163], v[208:211], a[192:195]
    v_accvgpr_read_b32 v168, a168
    v_accvgpr_read_b32 v169, a169
    v_mfma_f32_16x16x32_bf16 a[220:223], v[164:167], v[208:211], a[220:223]
    v_pk_mul_f32 v[168:169], v[168:169], v[228:229]
    v_cvt_pk_bf16_f32 v108, v168, v169
    s_waitcnt vmcnt(0)
    v_and_b32 v20, 0x01010101, v20
    v_cmp_ne_u32 vcc, 0x01010101, v20
    s_nop 0
    s_cbranch_vccz L_pollw_done
    s_mov_b32 s48, 0
L_pollw:
    buffer_load_dword v20, v21, s[76:79], 0 offen sc1
    s_waitcnt vmcnt(0)
    v_and_b32 v20, 0x01010101, v20
    v_cmp_ne_u32 vcc, 0x01010101, v20
    s_nop 0
    s_cbranch_vccz L_pollw_done
    s_sleep 8
    s_add_u32 s48, s48, 1
    s_cmp_lt_u32 s48, 200000
    s_cbranch_scc1 L_pollw
L_pollw_done:
    s_lshl_b32 s32, s3, 8
    s_lshl_b32 s39, s97, 4
    s_add_u32 s32, s32, s39
    s_mul_i32 s32, s32, 5120
    s_add_u32 s32, s32, 41943040
    s_add_u32 s64, s94, s32
    s_addc_u32 s65, s95, 0
    s_mov_b32 s66, 737280
    s_mov_b32 s67, 0x20000
    v_add_u32 v1, 4096, v254
    s_add_u32 s37, s3, 0
    s_and_b32 s37, s37, 3
    s_mul_i32 s52, s37, 20480
    s_add_u32 s53, s52, 5120
    s_add_u32 s54, s52, 10240
    s_add_u32 s55, s52, 15360
    buffer_load_dwordx4 v[136:139], v254, s[64:67], s52 offen offset:0 sc1
    buffer_load_dwordx4 v[140:143], v254, s[64:67], s52 offen offset:1024 sc1
    buffer_load_dwordx4 v[144:147], v254, s[64:67], s52 offen offset:2048 sc1
    buffer_load_dwordx4 v[148:151], v254, s[64:67], s52 offen offset:3072 sc1
    buffer_load_dwordx4 v[152:155], v1, s[64:67], s52 offen offset:0 sc1
    buffer_load_dwordx4 v[156:159], v254, s[64:67], s53 offen offset:0 sc1
    buffer_load_dwordx4 v[160:163], v254, s[64:67], s53 offen offset:1024 sc1
    buffer_load_dwordx4 v[164:167], v254, s[64:67], s53 offen offset:2048 sc1
    buffer_load_dwordx4 v[184:187], v254, s[64:67], s53 offen offset:3072 sc1
    buffer_load_dwordx4 v[188:191], v1, s[64:67], s53 offen offset:0 sc1
    buffer_load_dwordx4 v[192:195], v254, s[64:67], s54 offen offset:0 sc1
    buffer_load_dwordx4 v[196:199], v254, s[64:67], s54 offen offset:1024 sc1
    buffer_load_dwordx4 v[200:203], v254, s[64:67], s54 offen offset:2048 sc1
    buffer_load_dwordx4 v[204:207], v254, s[64:67], s54 offen offset:3072 sc1
    buffer_load_dwordx4 v[208:211], v1, s[64:67], s54 offen offset:0 sc1
    buffer_load_dwordx4 v[212:215], v254, s[64:67], s55 offen offset:0 sc1
    buffer_load_dwordx4 v[216:219], v254, s[64:67], s55 offen offset:1024 sc1
    buffer_load_dwordx4 v[220:223], v254, s[64:67], s55 offen offset:2048 sc1
    buffer_load_dwordx4 v[224:227], v254, s[64:67], s55 offen offset:3072 sc1
    s_add_u32 s32, s3, 0
    s_and_b32 s32, s32, 3
    s_lshl_b32 s32, s32, 15
    v_add_u32 v2, s32, v254
    s_add_u32 s32, s3, 1
    s_and_b32 s32, s32, 3
    s_lshl_b32 s32, s32, 15
    v_add_u32 v3, s32, v254
    s_add_u32 s32, s3, 2
    s_and_b32 s32, s32, 3
    s_lshl_b32 s32, s32, 15
    v_add_u32 v4, s32, v254
    s_add_u32 s32, s3, 3
    s_and_b32 s32, s32, 3
    s_lshl_b32 s32, s32, 15
    v_add_u32 v5, s32, v254
    v_accvgpr_read_b32 v170, a170
    v_accvgpr_read_b32 v171, a171
    v_pk_mul_f32 v[170:171], v[170:171], v[228:229]
    v_cvt_pk_bf16_f32 v109, v170, v171
    v_accvgpr_read_b32 v172, a196
    v_accvgpr_read_b32 v173, a197
    v_pk_mul_f32 v[172:173], v[172:173], v[228:229]
    v_cvt_pk_bf16_f32 v110, v172, v173
    v_accvgpr_read_b32 v174, a198
    v_accvgpr_read_b32 v175, a199
    v_pk_mul_f32 v[174:175], v[174:175], v[228:229]
    v_cvt_pk_bf16_f32 v111, v174, v175
    ds_write_b128 v2, v[24:27] offset:0
    ds_write_b128 v2, v[52:55] offset:7168
    ds_write_b128 v2, v[80:83] offset:14336
    ds_write_b128 v2, v[108:111] offset:21504
    v_accvgpr_read_b32 v168, a4
    v_accvgpr_read_b32 v169, a5
    v_pk_mul_f32 v[168:169], v[168:169], v[230:231]
    v_cvt_pk_bf16_f32 v28, v168, v169
    v_accvgpr_read_b32 v170, a6
    v_accvgpr_read_b32 v171, a7
    v_pk_mul_f32 v[170:171], v[170:171], v[230:231]
    v_cvt_pk_bf16_f32 v29, v170, v171
    v_accvgpr_read_b32 v172, a32
    v_accvgpr_read_b32 v173, a33
    v_pk_mul_f32 v[172:173], v[172:173], v[230:231]
    v_cvt_pk_bf16_f32 v30, v172, v173
    v_accvgpr_read_b32 v174, a34
    v_accvgpr_read_b32 v175, a35
    v_pk_mul_f32 v[174:175], v[174:175], v[230:231]
    v_cvt_pk_bf16_f32 v31, v174, v175
    v_accvgpr_read_b32 v168, a60
    v_accvgpr_read_b32 v169, a61
    v_pk_mul_f32 v[168:169], v[168:169], v[230:231]
    v_cvt_pk_bf16_f32 v56, v168, v169
    v_accvgpr_read_b32 v170, a62
    v_accvgpr_read_b32 v171, a63
    v_pk_mul_f32 v[170:171], v[170:171], v[230:231]
    v_cvt_pk_bf16_f32 v57, v170, v171
    v_accvgpr_read_b32 v172, a88
    v_accvgpr_read_b32 v173, a89
    v_pk_mul_f32 v[172:173], v[172:173], v[230:231]
    v_cvt_pk_bf16_f32 v58, v172, v173
    v_accvgpr_read_b32 v174, a90
    v_accvgpr_read_b32 v175, a91
    v_pk_mul_f32 v[174:175], v[174:175], v[230:231]
    v_cvt_pk_bf16_f32 v59, v174, v175
    v_accvgpr_read_b32 v168, a116
    v_accvgpr_read_b32 v169, a117
    v_pk_mul_f32 v[168:169], v[168:169], v[230:231]
    v_cvt_pk_bf16_f32 v84, v168, v169
    v_accvgpr_read_b32 v170, a118
    v_accvgpr_read_b32 v171, a119
    v_pk_mul_f32 v[170:171], v[170:171], v[230:231]
    v_cvt_pk_bf16_f32 v85, v170, v171
    v_accvgpr_read_b32 v172, a144
    v_accvgpr_read_b32 v173, a145
    v_pk_mul_f32 v[172:173], v[172:173], v[230:231]
    v_cvt_pk_bf16_f32 v86, v172, v173
    v_accvgpr_read_b32 v174, a146
    v_accvgpr_read_b32 v175, a147
    v_pk_mul_f32 v[174:175], v[174:175], v[230:231]
    v_cvt_pk_bf16_f32 v87, v174, v175
    v_accvgpr_read_b32 v168, a172
    v_accvgpr_read_b32 v169, a173
    v_pk_mul_f32 v[168:169], v[168:169], v[230:231]
    v_cvt_pk_bf16_f32 v112, v168, v169
    v_accvgpr_read_b32 v170, a174
    v_accvgpr_read_b32 v171, a175
    v_pk_mul_f32 v[170:171], v[170:171], v[230:231]
    v_cvt_pk_bf16_f32 v113, v170, v171
    v_accvgpr_read_b32 v172, a200
    v_accvgpr_read_b32 v173, a201
    v_pk_mul_f32 v[172:173], v[172:173], v[230:231]
    v_cvt_pk_bf16_f32 v114, v172, v173
    v_accvgpr_read_b32 v174, a202
    v_accvgpr_read_b32 v175, a203
    v_pk_mul_f32 v[174:175], v[174:175], v[230:231]
    v_cvt_pk_bf16_f32 v115, v174, v175
    ds_write_b128 v2, v[28:31] offset:1024
    ds_write_b128 v2, v[56:59] offset:8192
    ds_write_b128 v2, v[84:87] offset:15360
    ds_write_b128 v2, v[112:115] offset:22528
    v_accvgpr_read_b32 v168, a8
    v_accvgpr_read_b32 v169, a9
    v_pk_mul_f32 v[168:169], v[168:169], v[232:233]
    v_cvt_pk_bf16_f32 v32, v168, v169
    v_accvgpr_read_b32 v170, a10
    v_accvgpr_read_b32 v171, a11
    v_pk_mul_f32 v[170:171], v[170:171], v[232:233]
    v_cvt_pk_bf16_f32 v33, v170, v171
    v_accvgpr_read_b32 v172, a36
    v_accvgpr_read_b32 v173, a37
    v_pk_mul_f32 v[172:173], v[172:173], v[232:233]
    v_cvt_pk_bf16_f32 v34, v172, v173
    v_accvgpr_read_b32 v174, a38
    v_accvgpr_read_b32 v175, a39
    v_pk_mul_f32 v[174:175], v[174:175], v[232:233]
    v_cvt_pk_bf16_f32 v35, v174, v175
    v_accvgpr_read_b32 v168, a64
    v_accvgpr_read_b32 v169, a65
    v_pk_mul_f32 v[168:169], v[168:169], v[232:233]
    v_cvt_pk_bf16_f32 v60, v168, v169
    v_accvgpr_read_b32 v170, a66
    v_accvgpr_read_b32 v171, a67
    v_pk_mul_f32 v[170:171], v[170:171], v[232:233]
    v_cvt_pk_bf16_f32 v61, v170, v171
    v_accvgpr_read_b32 v172, a92
    v_accvgpr_read_b32 v173, a93
    v_pk_mul_f32 v[172:173], v[172:173], v[232:233]
    v_cvt_pk_bf16_f32 v62, v172, v173
    v_accvgpr_read_b32 v174, a94
    v_accvgpr_read_b32 v175, a95
    v_pk_mul_f32 v[174:175], v[174:175], v[232:233]
    v_cvt_pk_bf16_f32 v63, v174, v175
    v_accvgpr_read_b32 v168, a120
    v_accvgpr_read_b32 v169, a121
    v_pk_mul_f32 v[168:169], v[168:169], v[232:233]
    v_cvt_pk_bf16_f32 v88, v168, v169
    v_accvgpr_read_b32 v170, a122
    v_accvgpr_read_b32 v171, a123
    v_pk_mul_f32 v[170:171], v[170:171], v[232:233]
    v_cvt_pk_bf16_f32 v89, v170, v171
    v_accvgpr_read_b32 v172, a148
    v_accvgpr_read_b32 v173, a149
    v_pk_mul_f32 v[172:173], v[172:173], v[232:233]
    v_cvt_pk_bf16_f32 v90, v172, v173
    v_accvgpr_read_b32 v174, a150
    v_accvgpr_read_b32 v175, a151
    v_pk_mul_f32 v[174:175], v[174:175], v[232:233]
    v_cvt_pk_bf16_f32 v91, v174, v175
    v_accvgpr_read_b32 v168, a176
    v_accvgpr_read_b32 v169, a177
    v_pk_mul_f32 v[168:169], v[168:169], v[232:233]
    v_cvt_pk_bf16_f32 v116, v168, v169
    v_accvgpr_read_b32 v170, a178
    v_accvgpr_read_b32 v171, a179
    v_pk_mul_f32 v[170:171], v[170:171], v[232:233]
    v_cvt_pk_bf16_f32 v117, v170, v171
    v_accvgpr_read_b32 v172, a204
    v_accvgpr_read_b32 v173, a205
    v_pk_mul_f32 v[172:173], v[172:173], v[232:233]
    v_cvt_pk_bf16_f32 v118, v172, v173
    v_accvgpr_read_b32 v174, a206
    v_accvgpr_read_b32 v175, a207
    v_pk_mul_f32 v[174:175], v[174:175], v[232:233]
    v_cvt_pk_bf16_f32 v119, v174, v175
    ds_write_b128 v2, v[32:35] offset:2048
    ds_write_b128 v2, v[60:63] offset:9216
    ds_write_b128 v2, v[88:91] offset:16384
    ds_write_b128 v2, v[116:119] offset:23552
    v_accvgpr_read_b32 v168, a12
    v_accvgpr_read_b32 v169, a13
    v_pk_mul_f32 v[168:169], v[168:169], v[234:235]
    v_cvt_pk_bf16_f32 v36, v168, v169
    v_accvgpr_read_b32 v170, a14
    v_accvgpr_read_b32 v171, a15
    v_pk_mul_f32 v[170:171], v[170:171], v[234:235]
    v_cvt_pk_bf16_f32 v37, v170, v171
    v_accvgpr_read_b32 v172, a40
    v_accvgpr_read_b32 v173, a41
    v_pk_mul_f32 v[172:173], v[172:173], v[234:235]
    v_cvt_pk_bf16_f32 v38, v172, v173
    v_accvgpr_read_b32 v174, a42
    v_accvgpr_read_b32 v175, a43
    v_pk_mul_f32 v[174:175], v[174:175], v[234:235]
    v_cvt_pk_bf16_f32 v39, v174, v175
    v_accvgpr_read_b32 v168, a68
    v_accvgpr_read_b32 v169, a69
    v_pk_mul_f32 v[168:169], v[168:169], v[234:235]
    v_cvt_pk_bf16_f32 v64, v168, v169
    v_accvgpr_read_b32 v170, a70
    v_accvgpr_read_b32 v171, a71
    v_pk_mul_f32 v[170:171], v[170:171], v[234:235]
    v_cvt_pk_bf16_f32 v65, v170, v171
    v_accvgpr_read_b32 v172, a96
    v_accvgpr_read_b32 v173, a97
    v_pk_mul_f32 v[172:173], v[172:173], v[234:235]
    v_cvt_pk_bf16_f32 v66, v172, v173
    v_accvgpr_read_b32 v174, a98
    v_accvgpr_read_b32 v175, a99
    v_pk_mul_f32 v[174:175], v[174:175], v[234:235]
    v_cvt_pk_bf16_f32 v67, v174, v175
    v_accvgpr_read_b32 v168, a124
    v_accvgpr_read_b32 v169, a125
    v_pk_mul_f32 v[168:169], v[168:169], v[234:235]
    v_cvt_pk_bf16_f32 v92, v168, v169
    v_accvgpr_read_b32 v170, a126
    v_accvgpr_read_b32 v171, a127
    v_pk_mul_f32 v[170:171], v[170:171], v[234:235]
    v_cvt_pk_bf16_f32 v93, v170, v171
    v_accvgpr_read_b32 v172, a152
    v_accvgpr_read_b32 v173, a153
    v_pk_mul_f32 v[172:173], v[172:173], v[234:235]
    v_cvt_pk_bf16_f32 v94, v172, v173
    v_accvgpr_read_b32 v174, a154
    v_accvgpr_read_b32 v175, a155
    v_pk_mul_f32 v[174:175], v[174:175], v[234:235]
    v_cvt_pk_bf16_f32 v95, v174, v175
    v_accvgpr_read_b32 v168, a180
    v_accvgpr_read_b32 v169, a181
    v_pk_mul_f32 v[168:169], v[168:169], v[234:235]
    v_cvt_pk_bf16_f32 v120, v168, v169
    v_accvgpr_read_b32 v170, a182
    v_accvgpr_read_b32 v171, a183
    v_pk_mul_f32 v[170:171], v[170:171], v[234:235]
    v_cvt_pk_bf16_f32 v121, v170, v171
    v_accvgpr_read_b32 v172, a208
    v_accvgpr_read_b32 v173, a209
    v_pk_mul_f32 v[172:173], v[172:173], v[234:235]
    v_cvt_pk_bf16_f32 v122, v172, v173
    v_accvgpr_read_b32 v174, a210
    v_accvgpr_read_b32 v175, a211
    v_pk_mul_f32 v[174:175], v[174:175], v[234:235]
    v_cvt_pk_bf16_f32 v123, v174, v175
    ds_write_b128 v2, v[36:39] offset:3072
    ds_write_b128 v2, v[64:67] offset:10240
    ds_write_b128 v2, v[92:95] offset:17408
    ds_write_b128 v2, v[120:123] offset:24576
    v_accvgpr_read_b32 v168, a16
    v_accvgpr_read_b32 v169, a17
    v_pk_mul_f32 v[168:169], v[168:169], v[236:237]
    v_cvt_pk_bf16_f32 v40, v168, v169
    v_accvgpr_read_b32 v170, a18
    v_accvgpr_read_b32 v171, a19
    v_pk_mul_f32 v[170:171], v[170:171], v[236:237]
    v_cvt_pk_bf16_f32 v41, v170, v171
    v_accvgpr_read_b32 v172, a44
    v_accvgpr_read_b32 v173, a45
    v_pk_mul_f32 v[172:173], v[172:173], v[236:237]
    v_cvt_pk_bf16_f32 v42, v172, v173
    v_accvgpr_read_b32 v174, a46
    v_accvgpr_read_b32 v175, a47
    v_pk_mul_f32 v[174:175], v[174:175], v[236:237]
    v_cvt_pk_bf16_f32 v43, v174, v175
    v_accvgpr_read_b32 v168, a72
    v_accvgpr_read_b32 v169, a73
    v_pk_mul_f32 v[168:169], v[168:169], v[236:237]
    v_cvt_pk_bf16_f32 v68, v168, v169
    v_accvgpr_read_b32 v170, a74
    v_accvgpr_read_b32 v171, a75
    v_pk_mul_f32 v[170:171], v[170:171], v[236:237]
    v_cvt_pk_bf16_f32 v69, v170, v171
    v_accvgpr_read_b32 v172, a100
    v_accvgpr_read_b32 v173, a101
    v_pk_mul_f32 v[172:173], v[172:173], v[236:237]
    v_cvt_pk_bf16_f32 v70, v172, v173
    v_accvgpr_read_b32 v174, a102
    v_accvgpr_read_b32 v175, a103
    v_pk_mul_f32 v[174:175], v[174:175], v[236:237]
    v_cvt_pk_bf16_f32 v71, v174, v175
    v_accvgpr_read_b32 v168, a128
    v_accvgpr_read_b32 v169, a129
    v_pk_mul_f32 v[168:169], v[168:169], v[236:237]
    v_cvt_pk_bf16_f32 v96, v168, v169
    v_accvgpr_read_b32 v170, a130
    v_accvgpr_read_b32 v171, a131
    v_pk_mul_f32 v[170:171], v[170:171], v[236:237]
    v_cvt_pk_bf16_f32 v97, v170, v171
    v_accvgpr_read_b32 v172, a156
    v_accvgpr_read_b32 v173, a157
    v_pk_mul_f32 v[172:173], v[172:173], v[236:237]
    v_cvt_pk_bf16_f32 v98, v172, v173
    v_accvgpr_read_b32 v174, a158
    v_accvgpr_read_b32 v175, a159
    v_pk_mul_f32 v[174:175], v[174:175], v[236:237]
    v_cvt_pk_bf16_f32 v99, v174, v175
    v_accvgpr_read_b32 v168, a184
    v_accvgpr_read_b32 v169, a185
    v_pk_mul_f32 v[168:169], v[168:169], v[236:237]
    v_cvt_pk_bf16_f32 v124, v168, v169
    v_accvgpr_read_b32 v170, a186
    v_accvgpr_read_b32 v171, a187
    v_pk_mul_f32 v[170:171], v[170:171], v[236:237]
    v_cvt_pk_bf16_f32 v125, v170, v171
    v_accvgpr_read_b32 v172, a212
    v_accvgpr_read_b32 v173, a213
    v_pk_mul_f32 v[172:173], v[172:173], v[236:237]
    v_cvt_pk_bf16_f32 v126, v172, v173
    v_accvgpr_read_b32 v174, a214
    v_accvgpr_read_b32 v175, a215
    v_pk_mul_f32 v[174:175], v[174:175], v[236:237]
    v_cvt_pk_bf16_f32 v127, v174, v175
    ds_write_b128 v2, v[40:43] offset:4096
    ds_write_b128 v2, v[68:71] offset:11264
    ds_write_b128 v2, v[96:99] offset:18432
    ds_write_b128 v2, v[124:127] offset:25600
    v_accvgpr_read_b32 v168, a20
    v_accvgpr_read_b32 v169, a21
    v_pk_mul_f32 v[168:169], v[168:169], v[238:239]
    v_cvt_pk_bf16_f32 v44, v168, v169
    v_accvgpr_read_b32 v170, a22
    v_accvgpr_read_b32 v171, a23
    v_pk_mul_f32 v[170:171], v[170:171], v[238:239]
    v_cvt_pk_bf16_f32 v45, v170, v171
    v_accvgpr_read_b32 v172, a48
    v_accvgpr_read_b32 v173, a49
    v_pk_mul_f32 v[172:173], v[172:173], v[238:239]
    v_cvt_pk_bf16_f32 v46, v172, v173
    v_accvgpr_read_b32 v174, a50
    v_accvgpr_read_b32 v175, a51
    v_pk_mul_f32 v[174:175], v[174:175], v[238:239]
    v_cvt_pk_bf16_f32 v47, v174, v175
    v_accvgpr_read_b32 v168, a76
    v_accvgpr_read_b32 v169, a77
    v_pk_mul_f32 v[168:169], v[168:169], v[238:239]
    v_cvt_pk_bf16_f32 v72, v168, v169
    v_accvgpr_read_b32 v170, a78
    v_accvgpr_read_b32 v171, a79
    v_pk_mul_f32 v[170:171], v[170:171], v[238:239]
    v_cvt_pk_bf16_f32 v73, v170, v171
    v_accvgpr_read_b32 v172, a104
    v_accvgpr_read_b32 v173, a105
    v_pk_mul_f32 v[172:173], v[172:173], v[238:239]
    v_cvt_pk_bf16_f32 v74, v172, v173
    v_accvgpr_read_b32 v174, a106
    v_accvgpr_read_b32 v175, a107
    v_pk_mul_f32 v[174:175], v[174:175], v[238:239]
    v_cvt_pk_bf16_f32 v75, v174, v175
    v_accvgpr_read_b32 v168, a132
    v_accvgpr_read_b32 v169, a133
    v_pk_mul_f32 v[168:169], v[168:169], v[238:239]
    v_cvt_pk_bf16_f32 v100, v168, v169
    v_accvgpr_read_b32 v170, a134
    v_accvgpr_read_b32 v171, a135
    v_pk_mul_f32 v[170:171], v[170:171], v[238:239]
    v_cvt_pk_bf16_f32 v101, v170, v171
    v_accvgpr_read_b32 v172, a160
    v_accvgpr_read_b32 v173, a161
    v_pk_mul_f32 v[172:173], v[172:173], v[238:239]
    v_cvt_pk_bf16_f32 v102, v172, v173
    v_accvgpr_read_b32 v174, a162
    v_accvgpr_read_b32 v175, a163
    v_pk_mul_f32 v[174:175], v[174:175], v[238:239]
    v_cvt_pk_bf16_f32 v103, v174, v175
    v_accvgpr_read_b32 v168, a188
    v_accvgpr_read_b32 v169, a189
    v_pk_mul_f32 v[168:169], v[168:169], v[238:239]
    v_cvt_pk_bf16_f32 v128, v168, v169
    v_accvgpr_read_b32 v170, a190
    v_accvgpr_read_b32 v171, a191
    v_pk_mul_f32 v[170:171], v[170:171], v[238:239]
    v_cvt_pk_bf16_f32 v129, v170, v171
    v_accvgpr_read_b32 v172, a216
    v_accvgpr_read_b32 v173, a217
    v_pk_mul_f32 v[172:173], v[172:173], v[238:239]
    v_cvt_pk_bf16_f32 v130, v172, v173
    v_accvgpr_read_b32 v174, a218
    v_accvgpr_read_b32 v175, a219
    v_pk_mul_f32 v[174:175], v[174:175], v[238:239]
    v_cvt_pk_bf16_f32 v131, v174, v175
    ds_write_b128 v2, v[44:47] offset:5120
    ds_write_b128 v2, v[72:75] offset:12288
    ds_write_b128 v2, v[100:103] offset:19456
    ds_write_b128 v2, v[128:131] offset:26624
    v_accvgpr_read_b32 v168, a24
    v_accvgpr_read_b32 v169, a25
    v_pk_mul_f32 v[168:169], v[168:169], v[240:241]
    v_cvt_pk_bf16_f32 v48, v168, v169
    v_accvgpr_read_b32 v170, a26
    v_accvgpr_read_b32 v171, a27
    v_pk_mul_f32 v[170:171], v[170:171], v[240:241]
    v_cvt_pk_bf16_f32 v49, v170, v171
    v_accvgpr_read_b32 v172, a52
    v_accvgpr_read_b32 v173, a53
    v_pk_mul_f32 v[172:173], v[172:173], v[240:241]
    v_cvt_pk_bf16_f32 v50, v172, v173
    v_accvgpr_read_b32 v174, a54
    v_accvgpr_read_b32 v175, a55
    v_pk_mul_f32 v[174:175], v[174:175], v[240:241]
    v_cvt_pk_bf16_f32 v51, v174, v175
    v_accvgpr_read_b32 v168, a80
    v_accvgpr_read_b32 v169, a81
    v_pk_mul_f32 v[168:169], v[168:169], v[240:241]
    v_cvt_pk_bf16_f32 v76, v168, v169
    v_accvgpr_read_b32 v170, a82
    v_accvgpr_read_b32 v171, a83
    v_pk_mul_f32 v[170:171], v[170:171], v[240:241]
    v_cvt_pk_bf16_f32 v77, v170, v171
    v_accvgpr_read_b32 v172, a108
    v_accvgpr_read_b32 v173, a109
    v_pk_mul_f32 v[172:173], v[172:173], v[240:241]
    v_cvt_pk_bf16_f32 v78, v172, v173
    v_accvgpr_read_b32 v174, a110
    v_accvgpr_read_b32 v175, a111
    v_pk_mul_f32 v[174:175], v[174:175], v[240:241]
    v_cvt_pk_bf16_f32 v79, v174, v175
    v_accvgpr_read_b32 v168, a136
    v_accvgpr_read_b32 v169, a137
    v_pk_mul_f32 v[168:169], v[168:169], v[240:241]
    v_cvt_pk_bf16_f32 v104, v168, v169
    v_accvgpr_read_b32 v170, a138
    v_accvgpr_read_b32 v171, a139
    v_pk_mul_f32 v[170:171], v[170:171], v[240:241]
    v_cvt_pk_bf16_f32 v105, v170, v171
    v_accvgpr_read_b32 v172, a164
    v_accvgpr_read_b32 v173, a165
    v_pk_mul_f32 v[172:173], v[172:173], v[240:241]
    v_cvt_pk_bf16_f32 v106, v172, v173
    v_accvgpr_read_b32 v174, a166
    v_accvgpr_read_b32 v175, a167
    v_pk_mul_f32 v[174:175], v[174:175], v[240:241]
    v_cvt_pk_bf16_f32 v107, v174, v175
    v_accvgpr_read_b32 v168, a192
    v_accvgpr_read_b32 v169, a193
    v_pk_mul_f32 v[168:169], v[168:169], v[240:241]
    v_cvt_pk_bf16_f32 v132, v168, v169
    v_accvgpr_read_b32 v170, a194
    v_accvgpr_read_b32 v171, a195
    v_pk_mul_f32 v[170:171], v[170:171], v[240:241]
    v_cvt_pk_bf16_f32 v133, v170, v171
    v_accvgpr_read_b32 v172, a220
    v_accvgpr_read_b32 v173, a221
    v_pk_mul_f32 v[172:173], v[172:173], v[240:241]
    v_cvt_pk_bf16_f32 v134, v172, v173
    v_accvgpr_read_b32 v174, a222
    v_accvgpr_read_b32 v175, a223
    v_pk_mul_f32 v[174:175], v[174:175], v[240:241]
    v_cvt_pk_bf16_f32 v135, v174, v175
    ds_write_b128 v2, v[48:51] offset:6144
    ds_write_b128 v2, v[76:79] offset:13312
    ds_write_b128 v2, v[104:107] offset:20480
    ds_write_b128 v2, v[132:135] offset:27648
    s_lshl_b32 s32, s96, 3
    s_lshl_b32 s39, s3, 1
    s_add_u32 s32, s32, s39
    s_lshl_b32 s32, s32, 3
    s_add_u32 s32, s32, s97
    s_mul_i32 s32, s32, 17920
    s_add_u32 s20, s94, s32
    s_addc_u32 s21, s95, 0
    s_mov_b32 s22, 161280
    s_mov_b32 s23, 0x20000
    s_lshl_b32 s32, s96, 8
    s_lshl_b32 s40, s3, 6
    s_add_u32 s32, s32, s40
    s_lshl_b32 s40, s97, 2
    s_add_u32 s32, s32, s40
    v_mov_b32 v23, s32
    v_lshlrev_b32 v22, 3, v0
    s_waitcnt vmcnt(18)
    v_mfma_f32_16x16x32_bf16 a[0:3], v[136:139], v[24:27], 0
    v_mfma_f32_16x16x32_bf16 a[4:7], v[136:139], v[28:31], 0
    v_mfma_f32_16x16x32_bf16 a[8:11], v[136:139], v[32:35], 0
    v_mfma_f32_16x16x32_bf16 a[12:15], v[136:139], v[36:39], 0
    v_mfma_f32_16x16x32_bf16 a[16:19], v[136:139], v[40:43], 0
    v_mfma_f32_16x16x32_bf16 a[20:23], v[136:139], v[44:47], 0
    v_mfma_f32_16x16x32_bf16 a[24:27], v[136:139], v[48:51], 0
    s_waitcnt vmcnt(17)
    v_mfma_f32_16x16x32_bf16 a[28:31], v[140:143], v[24:27], 0
    v_mfma_f32_16x16x32_bf16 a[32:35], v[140:143], v[28:31], 0
    v_mfma_f32_16x16x32_bf16 a[36:39], v[140:143], v[32:35], 0
    v_mfma_f32_16x16x32_bf16 a[40:43], v[140:143], v[36:39], 0
    v_mfma_f32_16x16x32_bf16 a[44:47], v[140:143], v[40:43], 0
    v_mfma_f32_16x16x32_bf16 a[48:51], v[140:143], v[44:47], 0
    v_mfma_f32_16x16x32_bf16 a[52:55], v[140:143], v[48:51], 0
    s_waitcnt vmcnt(16)
    v_mfma_f32_16x16x32_bf16 a[56:59], v[144:147], v[24:27], 0
    v_mfma_f32_16x16x32_bf16 a[60:63], v[144:147], v[28:31], 0
    v_mfma_f32_16x16x32_bf16 a[64:67], v[144:147], v[32:35], 0
    v_mfma_f32_16x16x32_bf16 a[68:71], v[144:147], v[36:39], 0
    v_mfma_f32_16x16x32_bf16 a[72:75], v[144:147], v[40:43], 0
    v_mfma_f32_16x16x32_bf16 a[76:79], v[144:147], v[44:47], 0
    v_mfma_f32_16x16x32_bf16 a[80:83], v[144:147], v[48:51], 0
    s_waitcnt vmcnt(15)
    v_mfma_f32_16x16x32_bf16 a[84:87], v[148:151], v[24:27], 0
    v_mfma_f32_16x16x32_bf16 a[88:91], v[148:151], v[28:31], 0
    v_mfma_f32_16x16x32_bf16 a[92:95], v[148:151], v[32:35], 0
    v_mfma_f32_16x16x32_bf16 a[96:99], v[148:151], v[36:39], 0
    v_mfma_f32_16x16x32_bf16 a[100:103], v[148:151], v[40:43], 0
    v_mfma_f32_16x16x32_bf16 a[104:107], v[148:151], v[44:47], 0
    v_mfma_f32_16x16x32_bf16 a[108:111], v[148:151], v[48:51], 0
    s_waitcnt vmcnt(14)
    v_mfma_f32_16x16x32_bf16 a[112:115], v[152:155], v[24:27], 0
    buffer_load_dwordx4 v[168:171], v1, s[64:67], s55 offen offset:0 sc1
    v_mfma_f32_16x16x32_bf16 a[116:119], v[152:155], v[28:31], 0
    v_mfma_f32_16x16x32_bf16 a[120:123], v[152:155], v[32:35], 0
    v_mfma_f32_16x16x32_bf16 a[124:127], v[152:155], v[36:39], 0
    v_mfma_f32_16x16x32_bf16 a[128:131], v[152:155], v[40:43], 0
    v_mfma_f32_16x16x32_bf16 a[132:135], v[152:155], v[44:47], 0
    v_mfma_f32_16x16x32_bf16 a[136:139], v[152:155], v[48:51], 0
    s_waitcnt vmcnt(14)
    v_mfma_f32_16x16x32_bf16 a[0:3], v[156:159], v[52:55], a[0:3]
    s_add_u32 s37, s3, 0
    s_and_b32 s37, s37, 3
    s_mul_i32 s52, s37, 20480
    s_add_u32 s52, s52, 655360
    s_add_u32 s53, s52, 5120
    s_add_u32 s54, s52, 10240
    s_add_u32 s55, s52, 15360
    buffer_load_dwordx4 v[172:175], v254, s[64:67], s52 offen offset:0 sc1
    v_mfma_f32_16x16x32_bf16 a[4:7], v[156:159], v[56:59], a[4:7]
    v_mfma_f32_16x16x32_bf16 a[8:11], v[156:159], v[60:63], a[8:11]
    v_mfma_f32_16x16x32_bf16 a[12:15], v[156:159], v[64:67], a[12:15]
    v_mfma_f32_16x16x32_bf16 a[16:19], v[156:159], v[68:71], a[16:19]
    v_mfma_f32_16x16x32_bf16 a[20:23], v[156:159], v[72:75], a[20:23]
    v_mfma_f32_16x16x32_bf16 a[24:27], v[156:159], v[76:79], a[24:27]
    s_waitcnt vmcnt(14)
    v_mfma_f32_16x16x32_bf16 a[28:31], v[160:163], v[52:55], a[28:31]
    buffer_load_dwordx4 v[176:179], v254, s[64:67], s52 offen offset:1024 sc1
    v_mfma_f32_16x16x32_bf16 a[32:35], v[160:163], v[56:59], a[32:35]
    v_mfma_f32_16x16x32_bf16 a[36:39], v[160:163], v[60:63], a[36:39]
    v_mfma_f32_16x16x32_bf16 a[40:43], v[160:163], v[64:67], a[40:43]
    v_mfma_f32_16x16x32_bf16 a[44:47], v[160:163], v[68:71], a[44:47]
    v_mfma_f32_16x16x32_bf16 a[48:51], v[160:163], v[72:75], a[48:51]
    v_mfma_f32_16x16x32_bf16 a[52:55], v[160:163], v[76:79], a[52:55]
    s_waitcnt vmcnt(14)
    v_mfma_f32_16x16x32_bf16 a[56:59], v[164:167], v[52:55], a[56:59]
    buffer_load_dwordx4 v[180:183], v254, s[64:67], s52 offen offset:2048 sc1
    v_mfma_f32_16x16x32_bf16 a[60:63], v[164:167], v[56:59], a[60:63]
    v_mfma_f32_16x16x32_bf16 a[64:67], v[164:167], v[60:63], a[64:67]
    v_mfma_f32_16x16x32_bf16 a[68:71], v[164:167], v[64:67], a[68:71]
    v_mfma_f32_16x16x32_bf16 a[72:75], v[164:167], v[68:71], a[72:75]
    v_mfma_f32_16x16x32_bf16 a[76:79], v[164:167], v[72:75], a[76:79]
    v_mfma_f32_16x16x32_bf16 a[80:83], v[164:167], v[76:79], a[80:83]
    s_waitcnt vmcnt(14)
    v_mfma_f32_16x16x32_bf16 a[84:87], v[184:187], v[52:55], a[84:87]
    buffer_load_dwordx4 v[136:139], v254, s[64:67], s52 offen offset:3072 sc1
    v_mfma_f32_16x16x32_bf16 a[88:91], v[184:187], v[56:59], a[88:91]
    v_mfma_f32_16x16x32_bf16 a[92:95], v[184:187], v[60:63], a[92:95]
    v_mfma_f32_16x16x32_bf16 a[96:99], v[184:187], v[64:67], a[96:99]
    v_mfma_f32_16x16x32_bf16 a[100:103], v[184:187], v[68:71], a[100:103]
    v_mfma_f32_16x16x32_bf16 a[104:107], v[184:187], v[72:75], a[104:107]
    v_mfma_f32_16x16x32_bf16 a[108:111], v[184:187], v[76:79], a[108:111]
    s_waitcnt vmcnt(14)
    v_mfma_f32_16x16x32_bf16 a[112:115], v[188:191], v[52:55], a[112:115]
    buffer_load_dwordx4 v[140:143], v1, s[64:67], s52 offen offset:0 sc1
    v_mfma_f32_16x16x32_bf16 a[116:119], v[188:191], v[56:59], a[116:119]
    v_mfma_f32_16x16x32_bf16 a[120:123], v[188:191], v[60:63], a[120:123]
    v_mfma_f32_16x16x32_bf16 a[124:127], v[188:191], v[64:67], a[124:127]
    v_mfma_f32_16x16x32_bf16 a[128:131], v[188:191], v[68:71], a[128:131]
    v_mfma_f32_16x16x32_bf16 a[132:135], v[188:191], v[72:75], a[132:135]
    v_mfma_f32_16x16x32_bf16 a[136:139], v[188:191], v[76:79], a[136:139]
    s_waitcnt vmcnt(14)
    v_mfma_f32_16x16x32_bf16 a[0:3], v[192:195], v[80:83], a[0:3]
    buffer_load_dwordx4 v[144:147], v254, s[64:67], s53 offen offset:0 sc1
    v_mfma_f32_16x16x32_bf16 a[4:7], v[192:195], v[84:87], a[4:7]
    v_mfma_f32_16x16x32_bf16 a[8:11], v[192:195], v[88:91], a[8:11]
    v_mfma_f32_16x16x32_bf16 a[12:15], v[192:195], v[92:95], a[12:15]
    v_mfma_f32_16x16x32_bf16 a[16:19], v[192:195], v[96:99], a[16:19]
    v_mfma_f32_16x16x32_bf16 a[20:23], v[192:195], v[100:103], a[20:23]
    v_mfma_f32_16x16x32_bf16 a[24:27], v[192:195], v[104:107], a[24:27]
    s_waitcnt vmcnt(14)
    v_mfma_f32_16x16x32_bf16 a[28:31], v[196:199], v[80:83], a[28:31]
    buffer_load_dwordx4 v[148:151], v254, s[64:67], s53 offen offset:1024 sc1
    v_mfma_f32_16x16x32_bf16 a[32:35], v[196:199], v[84:87], a[32:35]
    v_mfma_f32_16x16x32_bf16 a[36:39], v[196:199], v[88:91], a[36:39]
    v_mfma_f32_16x16x32_bf16 a[40:43], v[196:199], v[92:95], a[40:43]
    v_mfma_f32_16x16x32_bf16 a[44:47], v[196:199], v[96:99], a[44:47]
    v_mfma_f32_16x16x32_bf16 a[48:51], v[196:199], v[100:103], a[48:51]
    v_mfma_f32_16x16x32_bf16 a[52:55], v[196:199], v[104:107], a[52:55]
    s_waitcnt vmcnt(14)
    v_mfma_f32_16x16x32_bf16 a[56:59], v[200:203], v[80:83], a[56:59]
    buffer_load_dwordx4 v[152:155], v254, s[64:67], s53 offen offset:2048 sc1
    v_mfma_f32_16x16x32_bf16 a[60:63], v[200:203], v[84:87], a[60:63]
    v_mfma_f32_16x16x32_bf16 a[64:67], v[200:203], v[88:91], a[64:67]
    v_mfma_f32_16x16x32_bf16 a[68:71], v[200:203], v[92:95], a[68:71]
    v_mfma_f32_16x16x32_bf16 a[72:75], v[200:203], v[96:99], a[72:75]
    v_mfma_f32_16x16x32_bf16 a[76:79], v[200:203], v[100:103], a[76:79]
    v_mfma_f32_16x16x32_bf16 a[80:83], v[200:203], v[104:107], a[80:83]
    s_waitcnt vmcnt(14)
    v_mfma_f32_16x16x32_bf16 a[84:87], v[204:207], v[80:83], a[84:87]
    buffer_load_dwordx4 v[156:159], v254, s[64:67], s53 offen offset:3072 sc1
    v_mfma_f32_16x16x32_bf16 a[88:91], v[204:207], v[84:87], a[88:91]
    v_mfma_f32_16x16x32_bf16 a[92:95], v[204:207], v[88:91], a[92:95]
    v_mfma_f32_16x16x32_bf16 a[96:99], v[204:207], v[92:95], a[96:99]
    v_mfma_f32_16x16x32_bf16 a[100:103], v[204:207], v[96:99], a[100:103]
    v_mfma_f32_16x16x32_bf16 a[104:107], v[204:207], v[100:103], a[104:107]
    v_mfma_f32_16x16x32_bf16 a[108:111], v[204:207], v[104:107], a[108:111]
    s_waitcnt vmcnt(14)
    v_mfma_f32_16x16x32_bf16 a[112:115], v[208:211], v[80:83], a[112:115]
    buffer_load_dwordx4 v[160:163], v1, s[64:67], s53 offen offset:0 sc1
    v_mfma_f32_16x16x32_bf16 a[116:119], v[208:211], v[84:87], a[116:119]
    v_mfma_f32_16x16x32_bf16 a[120:123], v[208:211], v[88:91], a[120:123]
    v_mfma_f32_16x16x32_bf16 a[124:127], v[208:211], v[92:95], a[124:127]
    v_mfma_f32_16x16x32_bf16 a[128:131], v[208:211], v[96:99], a[128:131]
    v_mfma_f32_16x16x32_bf16 a[132:135], v[208:211], v[100:103], a[132:135]
    v_mfma_f32_16x16x32_bf16 a[136:139], v[208:211], v[104:107], a[136:139]
    s_waitcnt vmcnt(14)
    v_mfma_f32_16x16x32_bf16 a[0:3], v[212:215], v[108:111], a[0:3]
    buffer_load_dwordx4 v[164:167], v254, s[64:67], s54 offen offset:0 sc1
    v_mfma_f32_16x16x32_bf16 a[4:7], v[212:215], v[112:115], a[4:7]
    v_mfma_f32_16x16x32_bf16 a[8:11], v[212:215], v[116:119], a[8:11]
    v_mfma_f32_16x16x32_bf16 a[12:15], v[212:215], v[120:123], a[12:15]
    v_mfma_f32_16x16x32_bf16 a[16:19], v[212:215], v[124:127], a[16:19]
    v_mfma_f32_16x16x32_bf16 a[20:23], v[212:215], v[128:131], a[20:23]
    v_mfma_f32_16x16x32_bf16 a[24:27], v[212:215], v[132:135], a[24:27]
    s_waitcnt vmcnt(14)
    v_mfma_f32_16x16x32_bf16 a[28:31], v[216:219], v[108:111], a[28:31]
    buffer_load_dwordx4 v[184:187], v254, s[64:67], s54 offen offset:1024 sc1
    v_mfma_f32_16x16x32_bf16 a[32:35], v[216:219], v[112:115], a[32:35]
    v_mfma_f32_16x16x32_bf16 a[36:39], v[216:219], v[116:119], a[36:39]
    v_mfma_f32_16x16x32_bf16 a[40:43], v[216:219], v[120:123], a[40:43]
    v_mfma_f32_16x16x32_bf16 a[44:47], v[216:219], v[124:127], a[44:47]
    v_mfma_f32_16x16x32_bf16 a[48:51], v[216:219], v[128:131], a[48:51]
    v_mfma_f32_16x16x32_bf16 a[52:55], v[216:219], v[132:135], a[52:55]
    s_waitcnt vmcnt(14)
    v_mfma_f32_16x16x32_bf16 a[56:59], v[220:223], v[108:111], a[56:59]
    buffer_load_dwordx4 v[188:191], v254, s[64:67], s54 offen offset:2048 sc1
    v_mfma_f32_16x16x32_bf16 a[60:63], v[220:223], v[112:115], a[60:63]
    v_mfma_f32_16x16x32_bf16 a[64:67], v[220:223], v[116:119], a[64:67]
    v_mfma_f32_16x16x32_bf16 a[68:71], v[220:223], v[120:123], a[68:71]
    v_mfma_f32_16x16x32_bf16 a[72:75], v[220:223], v[124:127], a[72:75]
    v_mfma_f32_16x16x32_bf16 a[76:79], v[220:223], v[128:131], a[76:79]
    v_mfma_f32_16x16x32_bf16 a[80:83], v[220:223], v[132:135], a[80:83]
    s_waitcnt vmcnt(14)
    v_mfma_f32_16x16x32_bf16 a[84:87], v[224:227], v[108:111], a[84:87]
    buffer_load_dwordx4 v[192:195], v254, s[64:67], s54 offen offset:3072 sc1
    v_mfma_f32_16x16x32_bf16 a[88:91], v[224:227], v[112:115], a[88:91]
    v_mfma_f32_16x16x32_bf16 a[92:95], v[224:227], v[116:119], a[92:95]
    v_mfma_f32_16x16x32_bf16 a[96:99], v[224:227], v[120:123], a[96:99]
    v_mfma_f32_16x16x32_bf16 a[100:103], v[224:227], v[124:127], a[100:103]
    v_mfma_f32_16x16x32_bf16 a[104:107], v[224:227], v[128:131], a[104:107]
    v_mfma_f32_16x16x32_bf16 a[108:111], v[224:227], v[132:135], a[108:111]
    s_waitcnt vmcnt(14)
    v_mfma_f32_16x16x32_bf16 a[112:115], v[168:171], v[108:111], a[112:115]
    buffer_load_dwordx4 v[196:199], v1, s[64:67], s54 offen offset:0 sc1
    v_mfma_f32_16x16x32_bf16 a[116:119], v[168:171], v[112:115], a[116:119]
    v_mfma_f32_16x16x32_bf16 a[120:123], v[168:171], v[116:119], a[120:123]
    v_mfma_f32_16x16x32_bf16 a[124:127], v[168:171], v[120:123], a[124:127]
    v_mfma_f32_16x16x32_bf16 a[128:131], v[168:171], v[124:127], a[128:131]
    v_mfma_f32_16x16x32_bf16 a[132:135], v[168:171], v[128:131], a[132:135]
    v_mfma_f32_16x16x32_bf16 a[136:139], v[168:171], v[132:135], a[136:139]
    s_waitcnt vmcnt(14)
    v_mfma_f32_16x16x32_bf16 a[140:143], v[172:175], v[24:27], 0
    buffer_load_dwordx4 v[200:203], v254, s[64:67], s55 offen offset:0 sc1
    v_mfma_f32_16x16x32_bf16 a[144:147], v[172:175], v[28:31], 0
    v_mfma_f32_16x16x32_bf16 a[148:151], v[172:175], v[32:35], 0
    v_mfma_f32_16x16x32_bf16 a[152:155], v[172:175], v[36:39], 0
    v_mfma_f32_16x16x32_bf16 a[156:159], v[172:175], v[40:43], 0
    v_mfma_f32_16x16x32_bf16 a[160:163], v[172:175], v[44:47], 0
    v_mfma_f32_16x16x32_bf16 a[164:167], v[172:175], v[48:51], 0
    s_waitcnt vmcnt(14)
    v_mfma_f32_16x16x32_bf16 a[168:171], v[176:179], v[24:27], 0
    buffer_load_dwordx4 v[204:207], v254, s[64:67], s55 offen offset:1024 sc1
    v_mfma_f32_16x16x32_bf16 a[172:175], v[176:179], v[28:31], 0
    v_mfma_f32_16x16x32_bf16 a[176:179], v[176:179], v[32:35], 0
    v_mfma_f32_16x16x32_bf16 a[180:183], v[176:179], v[36:39], 0
    v_mfma_f32_16x16x32_bf16 a[184:187], v[176:179], v[40:43], 0
    v_mfma_f32_16x16x32_bf16 a[188:191], v[176:179], v[44:47], 0
    v_mfma_f32_16x16x32_bf16 a[192:195], v[176:179], v[48:51], 0
    s_waitcnt vmcnt(14)
    v_mfma_f32_16x16x32_bf16 a[196:199], v[180:183], v[24:27], 0
    buffer_load_dwordx4 v[208:211], v254, s[64:67], s55 offen offset:2048 sc1
    v_mfma_f32_16x16x32_bf16 a[200:203], v[180:183], v[28:31], 0
    v_mfma_f32_16x16x32_bf16 a[204:207], v[180:183], v[32:35], 0
    v_mfma_f32_16x16x32_bf16 a[208:211], v[180:183], v[36:39], 0
    v_mfma_f32_16x16x32_bf16 a[212:215], v[180:183], v[40:43], 0
    v_mfma_f32_16x16x32_bf16 a[216:219], v[180:183], v[44:47], 0
    v_mfma_f32_16x16x32_bf16 a[220:223], v[180:183], v[48:51], 0
    s_waitcnt vmcnt(14)
    v_mfma_f32_16x16x32_bf16 a[224:227], v[136:139], v[24:27], 0
    buffer_load_dwordx4 v[212:215], v254, s[64:67], s55 offen offset:3072 sc1
    v_mfma_f32_16x16x32_bf16 a[228:231], v[136:139], v[28:31], 0
    v_mfma_f32_16x16x32_bf16 a[232:235], v[136:139], v[32:35], 0
    v_mfma_f32_16x16x32_bf16 a[236:239], v[136:139], v[36:39], 0
    v_mfma_f32_16x16x32_bf16 a[240:243], v[136:139], v[40:43], 0
    v_mfma_f32_16x16x32_bf16 a[244:247], v[136:139], v[44:47], 0
    v_mfma_f32_16x16x32_bf16 a[248:251], v[136:139], v[48:51], 0
    s_waitcnt vmcnt(14)
    v_mfma_f32_16x16x32_bf16 a[252:255], v[140:143], v[24:27], 0
    buffer_load_dwordx4 v[216:219], v1, s[64:67], s55 offen offset:0 sc1
    v_mfma_f32_16x16x32_bf16 v[228:231], v[140:143], v[28:31], 0
    v_mfma_f32_16x16x32_bf16 v[232:235], v[140:143], v[32:35], 0
    v_mfma_f32_16x16x32_bf16 v[236:239], v[140:143], v[36:39], 0
    v_mfma_f32_16x16x32_bf16 v[240:243], v[140:143], v[40:43], 0
    v_mfma_f32_16x16x32_bf16 v[244:247], v[140:143], v[44:47], 0
    v_mfma_f32_16x16x32_bf16 v[248:251], v[140:143], v[48:51], 0
    s_waitcnt vmcnt(14)
    v_mfma_f32_16x16x32_bf16 a[140:143], v[144:147], v[52:55], a[140:143]
    s_add_u32 s37, s3, 1
    s_and_b32 s37, s37, 3
    s_mul_i32 s52, s37, 20480
    s_add_u32 s53, s52, 5120
    s_add_u32 s54, s52, 10240
    s_add_u32 s55, s52, 15360
    buffer_load_dwordx4 v[220:223], v254, s[64:67], s52 offen offset:0 sc1
    v_mfma_f32_16x16x32_bf16 a[144:147], v[144:147], v[56:59], a[144:147]
    v_mfma_f32_16x16x32_bf16 a[148:151], v[144:147], v[60:63], a[148:151]
    v_mfma_f32_16x16x32_bf16 a[152:155], v[144:147], v[64:67], a[152:155]
    v_mfma_f32_16x16x32_bf16 a[156:159], v[144:147], v[68:71], a[156:159]
    v_mfma_f32_16x16x32_bf16 a[160:163], v[144:147], v[72:75], a[160:163]
    v_mfma_f32_16x16x32_bf16 a[164:167], v[144:147], v[76:79], a[164:167]
    s_waitcnt vmcnt(14)
    v_mfma_f32_16x16x32_bf16 a[168:171], v[148:151], v[52:55], a[168:171]
    buffer_load_dwordx4 v[224:227], v254, s[64:67], s52 offen offset:1024 sc1
    v_mfma_f32_16x16x32_bf16 a[172:175], v[148:151], v[56:59], a[172:175]
    v_mfma_f32_16x16x32_bf16 a[176:179], v[148:151], v[60:63], a[176:179]
    v_mfma_f32_16x16x32_bf16 a[180:183], v[148:151], v[64:67], a[180:183]
    v_mfma_f32_16x16x32_bf16 a[184:187], v[148:151], v[68:71], a[184:187]
    v_mfma_f32_16x16x32_bf16 a[188:191], v[148:151], v[72:75], a[188:191]
    v_mfma_f32_16x16x32_bf16 a[192:195], v[148:151], v[76:79], a[192:195]
    s_waitcnt vmcnt(14)
    v_mfma_f32_16x16x32_bf16 a[196:199], v[152:155], v[52:55], a[196:199]
    buffer_load_dwordx4 v[168:171], v254, s[64:67], s52 offen offset:2048 sc1
    v_mfma_f32_16x16x32_bf16 a[200:203], v[152:155], v[56:59], a[200:203]
    v_mfma_f32_16x16x32_bf16 a[204:207], v[152:155], v[60:63], a[204:207]
    v_mfma_f32_16x16x32_bf16 a[208:211], v[152:155], v[64:67], a[208:211]
    v_mfma_f32_16x16x32_bf16 a[212:215], v[152:155], v[68:71], a[212:215]
    v_mfma_f32_16x16x32_bf16 a[216:219], v[152:155], v[72:75], a[216:219]
    v_mfma_f32_16x16x32_bf16 a[220:223], v[152:155], v[76:79], a[220:223]
    s_waitcnt vmcnt(14)
    v_mfma_f32_16x16x32_bf16 a[224:227], v[156:159], v[52:55], a[224:227]
    buffer_load_dwordx4 v[172:175], v254, s[64:67], s52 offen offset:3072 sc1
    v_mfma_f32_16x16x32_bf16 a[228:231], v[156:159], v[56:59], a[228:231]
    v_mfma_f32_16x16x32_bf16 a[232:235], v[156:159], v[60:63], a[232:235]
    v_mfma_f32_16x16x32_bf16 a[236:239], v[156:159], v[64:67], a[236:239]
    v_mfma_f32_16x16x32_bf16 a[240:243], v[156:159], v[68:71], a[240:243]
    v_mfma_f32_16x16x32_bf16 a[244:247], v[156:159], v[72:75], a[244:247]
    v_mfma_f32_16x16x32_bf16 a[248:251], v[156:159], v[76:79], a[248:251]
    s_waitcnt vmcnt(14)
    v_mfma_f32_16x16x32_bf16 a[252:255], v[160:163], v[52:55], a[252:255]
    buffer_load_dwordx4 v[176:179], v1, s[64:67], s52 offen offset:0 sc1
    v_mfma_f32_16x16x32_bf16 v[228:231], v[160:163], v[56:59], v[228:231]
    v_mfma_f32_16x16x32_bf16 v[232:235], v[160:163], v[60:63], v[232:235]
    v_mfma_f32_16x16x32_bf16 v[236:239], v[160:163], v[64:67], v[236:239]
    v_mfma_f32_16x16x32_bf16 v[240:243], v[160:163], v[68:71], v[240:243]
    v_mfma_f32_16x16x32_bf16 v[244:247], v[160:163], v[72:75], v[244:247]
    v_mfma_f32_16x16x32_bf16 v[248:251], v[160:163], v[76:79], v[248:251]
    s_waitcnt lgkmcnt(0)
    s_barrier
    s_waitcnt vmcnt(14)
    v_mfma_f32_16x16x32_bf16 a[140:143], v[164:167], v[80:83], a[140:143]
    buffer_load_dwordx4 v[180:183], v254, s[64:67], s53 offen offset:0 sc1
    v_mfma_f32_16x16x32_bf16 a[144:147], v[164:167], v[84:87], a[144:147]
    v_mfma_f32_16x16x32_bf16 a[148:151], v[164:167], v[88:91], a[148:151]
    v_mfma_f32_16x16x32_bf16 a[152:155], v[164:167], v[92:95], a[152:155]
    v_mfma_f32_16x16x32_bf16 a[156:159], v[164:167], v[96:99], a[156:159]
    v_mfma_f32_16x16x32_bf16 a[160:163], v[164:167], v[100:103], a[160:163]
    v_mfma_f32_16x16x32_bf16 a[164:167], v[164:167], v[104:107], a[164:167]
    s_waitcnt vmcnt(14)
    v_mfma_f32_16x16x32_bf16 a[168:171], v[184:187], v[80:83], a[168:171]
    buffer_load_dwordx4 v[136:139], v254, s[64:67], s53 offen offset:1024 sc1
    v_mfma_f32_16x16x32_bf16 a[172:175], v[184:187], v[84:87], a[172:175]
    v_mfma_f32_16x16x32_bf16 a[176:179], v[184:187], v[88:91], a[176:179]
    v_mfma_f32_16x16x32_bf16 a[180:183], v[184:187], v[92:95], a[180:183]
    v_mfma_f32_16x16x32_bf16 a[184:187], v[184:187], v[96:99], a[184:187]
    v_mfma_f32_16x16x32_bf16 a[188:191], v[184:187], v[100:103], a[188:191]
    v_mfma_f32_16x16x32_bf16 a[192:195], v[184:187], v[104:107], a[192:195]
    s_waitcnt vmcnt(14)
    v_mfma_f32_16x16x32_bf16 a[196:199], v[188:191], v[80:83], a[196:199]
    buffer_load_dwordx4 v[24:27], v254, s[64:67], s53 offen offset:2048 sc1
    v_mfma_f32_16x16x32_bf16 a[200:203], v[188:191], v[84:87], a[200:203]
    v_mfma_f32_16x16x32_bf16 a[204:207], v[188:191], v[88:91], a[204:207]
    v_mfma_f32_16x16x32_bf16 a[208:211], v[188:191], v[92:95], a[208:211]
    v_mfma_f32_16x16x32_bf16 a[212:215], v[188:191], v[96:99], a[212:215]
    v_mfma_f32_16x16x32_bf16 a[216:219], v[188:191], v[100:103], a[216:219]
    v_mfma_f32_16x16x32_bf16 a[220:223], v[188:191], v[104:107], a[220:223]
    s_waitcnt vmcnt(14)
    v_mfma_f32_16x16x32_bf16 a[224:227], v[192:195], v[80:83], a[224:227]
    buffer_load_dwordx4 v[28:31], v254, s[64:67], s53 offen offset:3072 sc1
    v_mfma_f32_16x16x32_bf16 a[228:231], v[192:195], v[84:87], a[228:231]
    v_mfma_f32_16x16x32_bf16 a[232:235], v[192:195], v[88:91], a[232:235]
    v_mfma_f32_16x16x32_bf16 a[236:239], v[192:195], v[92:95], a[236:239]
    v_mfma_f32_16x16x32_bf16 a[240:243], v[192:195], v[96:99], a[240:243]
    v_mfma_f32_16x16x32_bf16 a[244:247], v[192:195], v[100:103], a[244:247]
    v_mfma_f32_16x16x32_bf16 a[248:251], v[192:195], v[104:107], a[248:251]
    s_waitcnt vmcnt(14)
    v_mfma_f32_16x16x32_bf16 a[252:255], v[196:199], v[80:83], a[252:255]
    buffer_load_dwordx4 v[32:35], v1, s[64:67], s53 offen offset:0 sc1
    v_mfma_f32_16x16x32_bf16 v[228:231], v[196:199], v[84:87], v[228:231]
    v_mfma_f32_16x16x32_bf16 v[232:235], v[196:199], v[88:91], v[232:235]
    v_mfma_f32_16x16x32_bf16 v[236:239], v[196:199], v[92:95], v[236:239]
    v_mfma_f32_16x16x32_bf16 v[240:243], v[196:199], v[96:99], v[240:243]
    v_mfma_f32_16x16x32_bf16 v[244:247], v[196:199], v[100:103], v[244:247]
    v_mfma_f32_16x16x32_bf16 v[248:251], v[196:199], v[104:107], v[248:251]
    s_waitcnt vmcnt(14)
    v_mfma_f32_16x16x32_bf16 a[140:143], v[200:203], v[108:111], a[140:143]
    buffer_load_dwordx4 v[36:39], v254, s[64:67], s54 offen offset:0 sc1
    v_mfma_f32_16x16x32_bf16 a[144:147], v[200:203], v[112:115], a[144:147]
    v_mfma_f32_16x16x32_bf16 a[148:151], v[200:203], v[116:119], a[148:151]
    v_mfma_f32_16x16x32_bf16 a[152:155], v[200:203], v[120:123], a[152:155]
    v_mfma_f32_16x16x32_bf16 a[156:159], v[200:203], v[124:127], a[156:159]
    v_mfma_f32_16x16x32_bf16 a[160:163], v[200:203], v[128:131], a[160:163]
    ds_read_b128 v[40:43], v3 offset:0
    v_mfma_f32_16x16x32_bf16 a[164:167], v[200:203], v[132:135], a[164:167]
    ds_read_b128 v[44:47], v3 offset:1024
    s_waitcnt vmcnt(14)
    v_mfma_f32_16x16x32_bf16 a[168:171], v[204:207], v[108:111], a[168:171]
    ds_read_b128 v[48:51], v3 offset:2048
    v_mfma_f32_16x16x32_bf16 a[172:175], v[204:207], v[112:115], a[172:175]
    ds_read_b128 v[140:143], v3 offset:3072
    v_mfma_f32_16x16x32_bf16 a[176:179], v[204:207], v[116:119], a[176:179]
    ds_read_b128 v[144:147], v3 offset:4096
    v_mfma_f32_16x16x32_bf16 a[180:183], v[204:207], v[120:123], a[180:183]
    ds_read_b128 v[148:151], v3 offset:5120
    v_mfma_f32_16x16x32_bf16 a[184:187], v[204:207], v[124:127], a[184:187]
    ds_read_b128 v[152:155], v3 offset:6144
    v_mfma_f32_16x16x32_bf16 a[188:191], v[204:207], v[128:131], a[188:191]
    buffer_load_dwordx4 v[156:159], v254, s[64:67], s54 offen offset:1024 sc1
    v_mfma_f32_16x16x32_bf16 a[192:195], v[204:207], v[132:135], a[192:195]
    s_waitcnt vmcnt(14)
    v_mfma_f32_16x16x32_bf16 a[196:199], v[208:211], v[108:111], a[196:199]
    buffer_load_dwordx4 v[52:55], v254, s[64:67], s54 offen offset:2048 sc1
    v_mfma_f32_16x16x32_bf16 a[200:203], v[208:211], v[112:115], a[200:203]
    v_mfma_f32_16x16x32_bf16 a[204:207], v[208:211], v[116:119], a[204:207]
    v_mfma_f32_16x16x32_bf16 a[208:211], v[208:211], v[120:123], a[208:211]
    v_mfma_f32_16x16x32_bf16 a[212:215], v[208:211], v[124:127], a[212:215]
    v_mfma_f32_16x16x32_bf16 a[216:219], v[208:211], v[128:131], a[216:219]
    v_mfma_f32_16x16x32_bf16 a[220:223], v[208:211], v[132:135], a[220:223]
    s_waitcnt vmcnt(14)
    v_mfma_f32_16x16x32_bf16 a[224:227], v[212:215], v[108:111], a[224:227]
    buffer_load_dwordx4 v[56:59], v254, s[64:67], s54 offen offset:3072 sc1
    v_mfma_f32_16x16x32_bf16 a[228:231], v[212:215], v[112:115], a[228:231]
    v_mfma_f32_16x16x32_bf16 a[232:235], v[212:215], v[116:119], a[232:235]
    v_mfma_f32_16x16x32_bf16 a[236:239], v[212:215], v[120:123], a[236:239]
    v_mfma_f32_16x16x32_bf16 a[240:243], v[212:215], v[124:127], a[240:243]
    v_mfma_f32_16x16x32_bf16 a[244:247], v[212:215], v[128:131], a[244:247]
    v_mfma_f32_16x16x32_bf16 a[248:251], v[212:215], v[132:135], a[248:251]
    s_waitcnt vmcnt(14)
    v_mfma_f32_16x16x32_bf16 a[252:255], v[216:219], v[108:111], a[252:255]
    buffer_load_dwordx4 v[60:63], v1, s[64:67], s54 offen offset:0 sc1
    v_mfma_f32_16x16x32_bf16 v[228:231], v[216:219], v[112:115], v[228:231]
    v_mfma_f32_16x16x32_bf16 v[232:235], v[216:219], v[116:119], v[232:235]
    v_mfma_f32_16x16x32_bf16 v[236:239], v[216:219], v[120:123], v[236:239]
    v_mfma_f32_16x16x32_bf16 v[240:243], v[216:219], v[124:127], v[240:243]
    v_mfma_f32_16x16x32_bf16 v[244:247], v[216:219], v[128:131], v[244:247]
    v_mfma_f32_16x16x32_bf16 v[248:251], v[216:219], v[132:135], v[248:251]
    s_waitcnt vmcnt(14)
    s_waitcnt lgkmcnt(6)
    v_mfma_f32_16x16x32_bf16 a[0:3], v[220:223], v[40:43], a[0:3]
    buffer_load_dwordx4 v[64:67], v254, s[64:67], s55 offen offset:0 sc1
    s_waitcnt lgkmcnt(5)
    v_mfma_f32_16x16x32_bf16 a[4:7], v[220:223], v[44:47], a[4:7]
    s_waitcnt lgkmcnt(4)
    v_mfma_f32_16x16x32_bf16 a[8:11], v[220:223], v[48:51], a[8:11]
    s_waitcnt lgkmcnt(3)
    v_mfma_f32_16x16x32_bf16 a[12:15], v[220:223], v[140:143], a[12:15]
    s_waitcnt lgkmcnt(2)
    v_mfma_f32_16x16x32_bf16 a[16:19], v[220:223], v[144:147], a[16:19]
    s_waitcnt lgkmcnt(1)
    v_mfma_f32_16x16x32_bf16 a[20:23], v[220:223], v[148:151], a[20:23]
    ds_read_b128 v[68:71], v3 offset:7168
    s_waitcnt lgkmcnt(1)
    v_mfma_f32_16x16x32_bf16 a[24:27], v[220:223], v[152:155], a[24:27]
    ds_read_b128 v[72:75], v3 offset:8192
    s_waitcnt vmcnt(14)
    v_mfma_f32_16x16x32_bf16 a[28:31], v[224:227], v[40:43], a[28:31]
    ds_read_b128 v[76:79], v3 offset:9216
    v_mfma_f32_16x16x32_bf16 a[32:35], v[224:227], v[44:47], a[32:35]
    ds_read_b128 v[160:163], v3 offset:10240
    v_mfma_f32_16x16x32_bf16 a[36:39], v[224:227], v[48:51], a[36:39]
    ds_read_b128 v[164:167], v3 offset:11264
    v_mfma_f32_16x16x32_bf16 a[40:43], v[224:227], v[140:143], a[40:43]
    ds_read_b128 v[184:187], v3 offset:12288
    v_mfma_f32_16x16x32_bf16 a[44:47], v[224:227], v[144:147], a[44:47]
    ds_read_b128 v[188:191], v3 offset:13312
    v_mfma_f32_16x16x32_bf16 a[48:51], v[224:227], v[148:151], a[48:51]
    buffer_load_dwordx4 v[192:195], v254, s[64:67], s55 offen offset:1024 sc1
    v_mfma_f32_16x16x32_bf16 a[52:55], v[224:227], v[152:155], a[52:55]
    s_waitcnt vmcnt(14)
    v_mfma_f32_16x16x32_bf16 a[56:59], v[168:171], v[40:43], a[56:59]
    buffer_load_dwordx4 v[80:83], v254, s[64:67], s55 offen offset:2048 sc1
    v_mfma_f32_16x16x32_bf16 a[60:63], v[168:171], v[44:47], a[60:63]
    v_mfma_f32_16x16x32_bf16 a[64:67], v[168:171], v[48:51], a[64:67]
    v_mfma_f32_16x16x32_bf16 a[68:71], v[168:171], v[140:143], a[68:71]
    v_mfma_f32_16x16x32_bf16 a[72:75], v[168:171], v[144:147], a[72:75]
    v_mfma_f32_16x16x32_bf16 a[76:79], v[168:171], v[148:151], a[76:79]
    v_mfma_f32_16x16x32_bf16 a[80:83], v[168:171], v[152:155], a[80:83]
    s_waitcnt vmcnt(14)
    v_mfma_f32_16x16x32_bf16 a[84:87], v[172:175], v[40:43], a[84:87]
    buffer_load_dwordx4 v[84:87], v254, s[64:67], s55 offen offset:3072 sc1
    v_mfma_f32_16x16x32_bf16 a[88:91], v[172:175], v[44:47], a[88:91]
    v_mfma_f32_16x16x32_bf16 a[92:95], v[172:175], v[48:51], a[92:95]
    v_mfma_f32_16x16x32_bf16 a[96:99], v[172:175], v[140:143], a[96:99]
    v_mfma_f32_16x16x32_bf16 a[100:103], v[172:175], v[144:147], a[100:103]
    v_mfma_f32_16x16x32_bf16 a[104:107], v[172:175], v[148:151], a[104:107]
    v_mfma_f32_16x16x32_bf16 a[108:111], v[172:175], v[152:155], a[108:111]
    s_waitcnt vmcnt(14)
    v_mfma_f32_16x16x32_bf16 a[112:115], v[176:179], v[40:43], a[112:115]
    buffer_load_dwordx4 v[88:91], v1, s[64:67], s55 offen offset:0 sc1
    v_mfma_f32_16x16x32_bf16 a[116:119], v[176:179], v[44:47], a[116:119]
    v_mfma_f32_16x16x32_bf16 a[120:123], v[176:179], v[48:51], a[120:123]
    v_mfma_f32_16x16x32_bf16 a[124:127], v[176:179], v[140:143], a[124:127]
    v_mfma_f32_16x16x32_bf16 a[128:131], v[176:179], v[144:147], a[128:131]
    v_mfma_f32_16x16x32_bf16 a[132:135], v[176:179], v[148:151], a[132:135]
    v_mfma_f32_16x16x32_bf16 a[136:139], v[176:179], v[152:155], a[136:139]
    s_waitcnt vmcnt(14)
    s_waitcnt lgkmcnt(6)
    v_mfma_f32_16x16x32_bf16 a[0:3], v[180:183], v[68:71], a[0:3]
    s_add_u32 s37, s3, 2
    s_and_b32 s37, s37, 3
    s_mul_i32 s52, s37, 20480
    s_add_u32 s53, s52, 5120
    s_add_u32 s54, s52, 10240
    s_add_u32 s55, s52, 15360
    buffer_load_dwordx4 v[92:95], v254, s[64:67], s52 offen offset:0 sc1
    s_waitcnt lgkmcnt(5)
    v_mfma_f32_16x16x32_bf16 a[4:7], v[180:183], v[72:75], a[4:7]
    s_waitcnt lgkmcnt(4)
    v_mfma_f32_16x16x32_bf16 a[8:11], v[180:183], v[76:79], a[8:11]
    s_waitcnt lgkmcnt(3)
    v_mfma_f32_16x16x32_bf16 a[12:15], v[180:183], v[160:163], a[12:15]
    s_waitcnt lgkmcnt(2)
    v_mfma_f32_16x16x32_bf16 a[16:19], v[180:183], v[164:167], a[16:19]
    s_waitcnt lgkmcnt(1)
    v_mfma_f32_16x16x32_bf16 a[20:23], v[180:183], v[184:187], a[20:23]
    ds_read_b128 v[96:99], v3 offset:14336
    s_waitcnt lgkmcnt(1)
    v_mfma_f32_16x16x32_bf16 a[24:27], v[180:183], v[188:191], a[24:27]
    ds_read_b128 v[100:103], v3 offset:15360
    s_waitcnt vmcnt(14)
    v_mfma_f32_16x16x32_bf16 a[28:31], v[136:139], v[68:71], a[28:31]
    ds_read_b128 v[104:107], v3 offset:16384
    v_mfma_f32_16x16x32_bf16 a[32:35], v[136:139], v[72:75], a[32:35]
    ds_read_b128 v[196:199], v3 offset:17408
    v_mfma_f32_16x16x32_bf16 a[36:39], v[136:139], v[76:79], a[36:39]
    ds_read_b128 v[200:203], v3 offset:18432
    v_mfma_f32_16x16x32_bf16 a[40:43], v[136:139], v[160:163], a[40:43]
    ds_read_b128 v[204:207], v3 offset:19456
    v_mfma_f32_16x16x32_bf16 a[44:47], v[136:139], v[164:167], a[44:47]
    ds_read_b128 v[208:211], v3 offset:20480
    v_mfma_f32_16x16x32_bf16 a[48:51], v[136:139], v[184:187], a[48:51]
    buffer_load_dwordx4 v[212:215], v254, s[64:67], s52 offen offset:1024 sc1
    v_mfma_f32_16x16x32_bf16 a[52:55], v[136:139], v[188:191], a[52:55]
    s_waitcnt vmcnt(14)
    v_mfma_f32_16x16x32_bf16 a[56:59], v[24:27], v[68:71], a[56:59]
    buffer_load_dwordx4 v[108:111], v254, s[64:67], s52 offen offset:2048 sc1
    v_mfma_f32_16x16x32_bf16 a[60:63], v[24:27], v[72:75], a[60:63]
    v_mfma_f32_16x16x32_bf16 a[64:67], v[24:27], v[76:79], a[64:67]
    v_mfma_f32_16x16x32_bf16 a[68:71], v[24:27], v[160:163], a[68:71]
    v_mfma_f32_16x16x32_bf16 a[72:75], v[24:27], v[164:167], a[72:75]
    v_mfma_f32_16x16x32_bf16 a[76:79], v[24:27], v[184:187], a[76:79]
    v_mfma_f32_16x16x32_bf16 a[80:83], v[24:27], v[188:191], a[80:83]
    s_waitcnt vmcnt(14)
    v_mfma_f32_16x16x32_bf16 a[84:87], v[28:31], v[68:71], a[84:87]
    buffer_load_dwordx4 v[112:115], v254, s[64:67], s52 offen offset:3072 sc1
    v_mfma_f32_16x16x32_bf16 a[88:91], v[28:31], v[72:75], a[88:91]
    v_mfma_f32_16x16x32_bf16 a[92:95], v[28:31], v[76:79], a[92:95]
    v_mfma_f32_16x16x32_bf16 a[96:99], v[28:31], v[160:163], a[96:99]
    v_mfma_f32_16x16x32_bf16 a[100:103], v[28:31], v[164:167], a[100:103]
    v_mfma_f32_16x16x32_bf16 a[104:107], v[28:31], v[184:187], a[104:107]
    v_mfma_f32_16x16x32_bf16 a[108:111], v[28:31], v[188:191], a[108:111]
    s_waitcnt vmcnt(14)
    v_mfma_f32_16x16x32_bf16 a[112:115], v[32:35], v[68:71], a[112:115]
    buffer_load_dwordx4 v[116:119], v1, s[64:67], s52 offen offset:0 sc1
    v_mfma_f32_16x16x32_bf16 a[116:119], v[32:35], v[72:75], a[116:119]
    v_mfma_f32_16x16x32_bf16 a[120:123], v[32:35], v[76:79], a[120:123]
    v_mfma_f32_16x16x32_bf16 a[124:127], v[32:35], v[160:163], a[124:127]
    v_mfma_f32_16x16x32_bf16 a[128:131], v[32:35], v[164:167], a[128:131]
    v_mfma_f32_16x16x32_bf16 a[132:135], v[32:35], v[184:187], a[132:135]
    v_mfma_f32_16x16x32_bf16 a[136:139], v[32:35], v[188:191], a[136:139]
    s_waitcnt vmcnt(14)
    s_waitcnt lgkmcnt(6)
    v_mfma_f32_16x16x32_bf16 a[0:3], v[36:39], v[96:99], a[0:3]
    buffer_load_dwordx4 v[120:123], v254, s[64:67], s53 offen offset:0 sc1
    s_waitcnt lgkmcnt(5)
    v_mfma_f32_16x16x32_bf16 a[4:7], v[36:39], v[100:103], a[4:7]
    s_waitcnt lgkmcnt(4)
    v_mfma_f32_16x16x32_bf16 a[8:11], v[36:39], v[104:107], a[8:11]
    s_waitcnt lgkmcnt(3)
    v_mfma_f32_16x16x32_bf16 a[12:15], v[36:39], v[196:199], a[12:15]
    s_waitcnt lgkmcnt(2)
    v_mfma_f32_16x16x32_bf16 a[16:19], v[36:39], v[200:203], a[16:19]
    s_waitcnt lgkmcnt(1)
    v_mfma_f32_16x16x32_bf16 a[20:23], v[36:39], v[204:207], a[20:23]
    ds_read_b128 v[124:127], v3 offset:21504
    s_waitcnt lgkmcnt(1)
    v_mfma_f32_16x16x32_bf16 a[24:27], v[36:39], v[208:211], a[24:27]
    ds_read_b128 v[128:131], v3 offset:22528
    s_waitcnt vmcnt(14)
    v_mfma_f32_16x16x32_bf16 a[28:31], v[156:159], v[96:99], a[28:31]
    ds_read_b128 v[132:135], v3 offset:23552
    v_mfma_f32_16x16x32_bf16 a[32:35], v[156:159], v[100:103], a[32:35]
    ds_read_b128 v[216:219], v3 offset:24576
    v_mfma_f32_16x16x32_bf16 a[36:39], v[156:159], v[104:107], a[36:39]
    ds_read_b128 v[220:223], v3 offset:25600
    v_mfma_f32_16x16x32_bf16 a[40:43], v[156:159], v[196:199], a[40:43]
    ds_read_b128 v[224:227], v3 offset:26624
    v_mfma_f32_16x16x32_bf16 a[44:47], v[156:159], v[200:203], a[44:47]
    ds_read_b128 v[168:171], v3 offset:27648
    v_mfma_f32_16x16x32_bf16 a[48:51], v[156:159], v[204:207], a[48:51]
    buffer_load_dwordx4 v[172:175], v254, s[64:67], s53 offen offset:1024 sc1
    v_mfma_f32_16x16x32_bf16 a[52:55], v[156:159], v[208:211], a[52:55]
    s_waitcnt vmcnt(14)
    v_mfma_f32_16x16x32_bf16 a[56:59], v[52:55], v[96:99], a[56:59]
    buffer_load_dwordx4 v[40:43], v254, s[64:67], s53 offen offset:2048 sc1
    v_mfma_f32_16x16x32_bf16 a[60:63], v[52:55], v[100:103], a[60:63]
    v_mfma_f32_16x16x32_bf16 a[64:67], v[52:55], v[104:107], a[64:67]
    v_mfma_f32_16x16x32_bf16 a[68:71], v[52:55], v[196:199], a[68:71]
    v_mfma_f32_16x16x32_bf16 a[72:75], v[52:55], v[200:203], a[72:75]
    v_mfma_f32_16x16x32_bf16 a[76:79], v[52:55], v[204:207], a[76:79]
    v_mfma_f32_16x16x32_bf16 a[80:83], v[52:55], v[208:211], a[80:83]
    s_waitcnt vmcnt(14)
    v_mfma_f32_16x16x32_bf16 a[84:87], v[56:59], v[96:99], a[84:87]
    buffer_load_dwordx4 v[44:47], v254, s[64:67], s53 offen offset:3072 sc1
    v_mfma_f32_16x16x32_bf16 a[88:91], v[56:59], v[100:103], a[88:91]
    v_mfma_f32_16x16x32_bf16 a[92:95], v[56:59], v[104:107], a[92:95]
    v_mfma_f32_16x16x32_bf16 a[96:99], v[56:59], v[196:199], a[96:99]
    v_mfma_f32_16x16x32_bf16 a[100:103], v[56:59], v[200:203], a[100:103]
    v_mfma_f32_16x16x32_bf16 a[104:107], v[56:59], v[204:207], a[104:107]
    v_mfma_f32_16x16x32_bf16 a[108:111], v[56:59], v[208:211], a[108:111]
    s_waitcnt vmcnt(14)
    v_mfma_f32_16x16x32_bf16 a[112:115], v[60:63], v[96:99], a[112:115]
    buffer_load_dwordx4 v[48:51], v1, s[64:67], s53 offen offset:0 sc1
    v_mfma_f32_16x16x32_bf16 a[116:119], v[60:63], v[100:103], a[116:119]
    v_mfma_f32_16x16x32_bf16 a[120:123], v[60:63], v[104:107], a[120:123]
    v_mfma_f32_16x16x32_bf16 a[124:127], v[60:63], v[196:199], a[124:127]
    v_mfma_f32_16x16x32_bf16 a[128:131], v[60:63], v[200:203], a[128:131]
    v_mfma_f32_16x16x32_bf16 a[132:135], v[60:63], v[204:207], a[132:135]
    v_mfma_f32_16x16x32_bf16 a[136:139], v[60:63], v[208:211], a[136:139]
    s_waitcnt vmcnt(14)
    s_waitcnt lgkmcnt(6)
    v_mfma_f32_16x16x32_bf16 a[0:3], v[64:67], v[124:127], a[0:3]
    buffer_load_dwordx4 v[140:143], v254, s[64:67], s54 offen offset:0 sc1
    s_waitcnt lgkmcnt(5)
    v_mfma_f32_16x16x32_bf16 a[4:7], v[64:67], v[128:131], a[4:7]
    s_waitcnt lgkmcnt(4)
    v_mfma_f32_16x16x32_bf16 a[8:11], v[64:67], v[132:135], a[8:11]
    s_waitcnt lgkmcnt(3)
    v_mfma_f32_16x16x32_bf16 a[12:15], v[64:67], v[216:219], a[12:15]
    s_waitcnt lgkmcnt(2)
    v_mfma_f32_16x16x32_bf16 a[16:19], v[64:67], v[220:223], a[16:19]
    s_waitcnt lgkmcnt(1)
    v_mfma_f32_16x16x32_bf16 a[20:23], v[64:67], v[224:227], a[20:23]
    ds_read_b128 v[144:147], v4 offset:0
    s_waitcnt lgkmcnt(1)
    v_mfma_f32_16x16x32_bf16 a[24:27], v[64:67], v[168:171], a[24:27]
    ds_read_b128 v[148:151], v4 offset:1024
    s_waitcnt vmcnt(14)
    v_mfma_f32_16x16x32_bf16 a[28:31], v[192:195], v[124:127], a[28:31]
    ds_read_b128 v[152:155], v4 offset:2048
    v_mfma_f32_16x16x32_bf16 a[32:35], v[192:195], v[128:131], a[32:35]
    ds_read_b128 v[176:179], v4 offset:3072
    v_mfma_f32_16x16x32_bf16 a[36:39], v[192:195], v[132:135], a[36:39]
    ds_read_b128 v[180:183], v4 offset:4096
    v_mfma_f32_16x16x32_bf16 a[40:43], v[192:195], v[216:219], a[40:43]
    ds_read_b128 v[136:139], v4 offset:5120
    v_mfma_f32_16x16x32_bf16 a[44:47], v[192:195], v[220:223], a[44:47]
    ds_read_b128 v[24:27], v4 offset:6144
    v_mfma_f32_16x16x32_bf16 a[48:51], v[192:195], v[224:227], a[48:51]
    buffer_load_dwordx4 v[28:31], v254, s[64:67], s54 offen offset:1024 sc1
    v_mfma_f32_16x16x32_bf16 a[52:55], v[192:195], v[168:171], a[52:55]
    s_waitcnt vmcnt(14)
    v_mfma_f32_16x16x32_bf16 a[56:59], v[80:83], v[124:127], a[56:59]
    buffer_load_dwordx4 v[68:71], v254, s[64:67], s54 offen offset:2048 sc1
    v_mfma_f32_16x16x32_bf16 a[60:63], v[80:83], v[128:131], a[60:63]
    v_mfma_f32_16x16x32_bf16 a[64:67], v[80:83], v[132:135], a[64:67]
    v_mfma_f32_16x16x32_bf16 a[68:71], v[80:83], v[216:219], a[68:71]
    v_mfma_f32_16x16x32_bf16 a[72:75], v[80:83], v[220:223], a[72:75]
    v_mfma_f32_16x16x32_bf16 a[76:79], v[80:83], v[224:227], a[76:79]
    v_mfma_f32_16x16x32_bf16 a[80:83], v[80:83], v[168:171], a[80:83]
    s_waitcnt vmcnt(14)
    v_mfma_f32_16x16x32_bf16 a[84:87], v[84:87], v[124:127], a[84:87]
    buffer_load_dwordx4 v[72:75], v254, s[64:67], s54 offen offset:3072 sc1
    v_mfma_f32_16x16x32_bf16 a[88:91], v[84:87], v[128:131], a[88:91]
    v_mfma_f32_16x16x32_bf16 a[92:95], v[84:87], v[132:135], a[92:95]
    v_mfma_f32_16x16x32_bf16 a[96:99], v[84:87], v[216:219], a[96:99]
    v_mfma_f32_16x16x32_bf16 a[100:103], v[84:87], v[220:223], a[100:103]
    v_mfma_f32_16x16x32_bf16 a[104:107], v[84:87], v[224:227], a[104:107]
    v_mfma_f32_16x16x32_bf16 a[108:111], v[84:87], v[168:171], a[108:111]
    s_waitcnt vmcnt(14)
    v_mfma_f32_16x16x32_bf16 a[112:115], v[88:91], v[124:127], a[112:115]
    buffer_load_dwordx4 v[76:79], v1, s[64:67], s54 offen offset:0 sc1
    v_mfma_f32_16x16x32_bf16 a[116:119], v[88:91], v[128:131], a[116:119]
    v_mfma_f32_16x16x32_bf16 a[120:123], v[88:91], v[132:135], a[120:123]
    v_mfma_f32_16x16x32_bf16 a[124:127], v[88:91], v[216:219], a[124:127]
    v_mfma_f32_16x16x32_bf16 a[128:131], v[88:91], v[220:223], a[128:131]
    v_mfma_f32_16x16x32_bf16 a[132:135], v[88:91], v[224:227], a[132:135]
    v_mfma_f32_16x16x32_bf16 a[136:139], v[88:91], v[168:171], a[136:139]
    s_waitcnt vmcnt(14)
    s_waitcnt lgkmcnt(6)
    v_mfma_f32_16x16x32_bf16 a[0:3], v[92:95], v[144:147], a[0:3]
    buffer_load_dwordx4 v[160:163], v254, s[64:67], s55 offen offset:0 sc1
    s_waitcnt lgkmcnt(5)
    v_mfma_f32_16x16x32_bf16 a[4:7], v[92:95], v[148:151], a[4:7]
    s_waitcnt lgkmcnt(4)
    v_mfma_f32_16x16x32_bf16 a[8:11], v[92:95], v[152:155], a[8:11]
    s_waitcnt lgkmcnt(3)
    v_mfma_f32_16x16x32_bf16 a[12:15], v[92:95], v[176:179], a[12:15]
    s_waitcnt lgkmcnt(2)
    v_mfma_f32_16x16x32_bf16 a[16:19], v[92:95], v[180:183], a[16:19]
    s_waitcnt lgkmcnt(1)
    v_mfma_f32_16x16x32_bf16 a[20:23], v[92:95], v[136:139], a[20:23]
    ds_read_b128 v[164:167], v4 offset:7168
    s_waitcnt lgkmcnt(1)
    v_mfma_f32_16x16x32_bf16 a[24:27], v[92:95], v[24:27], a[24:27]
    ds_read_b128 v[184:187], v4 offset:8192
    s_waitcnt vmcnt(14)
    v_mfma_f32_16x16x32_bf16 a[28:31], v[212:215], v[144:147], a[28:31]
    ds_read_b128 v[188:191], v4 offset:9216
    v_mfma_f32_16x16x32_bf16 a[32:35], v[212:215], v[148:151], a[32:35]
    ds_read_b128 v[32:35], v4 offset:10240
    v_mfma_f32_16x16x32_bf16 a[36:39], v[212:215], v[152:155], a[36:39]
    ds_read_b128 v[36:39], v4 offset:11264
    v_mfma_f32_16x16x32_bf16 a[40:43], v[212:215], v[176:179], a[40:43]
    ds_read_b128 v[156:159], v4 offset:12288
    v_mfma_f32_16x16x32_bf16 a[44:47], v[212:215], v[180:183], a[44:47]
    ds_read_b128 v[52:55], v4 offset:13312
    v_mfma_f32_16x16x32_bf16 a[48:51], v[212:215], v[136:139], a[48:51]
    buffer_load_dwordx4 v[56:59], v254, s[64:67], s55 offen offset:1024 sc1
    v_mfma_f32_16x16x32_bf16 a[52:55], v[212:215], v[24:27], a[52:55]
    s_waitcnt vmcnt(14)
    v_mfma_f32_16x16x32_bf16 a[56:59], v[108:111], v[144:147], a[56:59]
    buffer_load_dwordx4 v[96:99], v254, s[64:67], s55 offen offset:2048 sc1
    v_mfma_f32_16x16x32_bf16 a[60:63], v[108:111], v[148:151], a[60:63]
    v_mfma_f32_16x16x32_bf16 a[64:67], v[108:111], v[152:155], a[64:67]
    v_mfma_f32_16x16x32_bf16 a[68:71], v[108:111], v[176:179], a[68:71]
    v_mfma_f32_16x16x32_bf16 a[72:75], v[108:111], v[180:183], a[72:75]
    v_mfma_f32_16x16x32_bf16 a[76:79], v[108:111], v[136:139], a[76:79]
    v_mfma_f32_16x16x32_bf16 a[80:83], v[108:111], v[24:27], a[80:83]
    s_waitcnt vmcnt(14)
    v_mfma_f32_16x16x32_bf16 a[84:87], v[112:115], v[144:147], a[84:87]
    buffer_load_dwordx4 v[100:103], v254, s[64:67], s55 offen offset:3072 sc1
    v_mfma_f32_16x16x32_bf16 a[88:91], v[112:115], v[148:151], a[88:91]
    v_mfma_f32_16x16x32_bf16 a[92:95], v[112:115], v[152:155], a[92:95]
    v_mfma_f32_16x16x32_bf16 a[96:99], v[112:115], v[176:179], a[96:99]
    v_mfma_f32_16x16x32_bf16 a[100:103], v[112:115], v[180:183], a[100:103]
    v_mfma_f32_16x16x32_bf16 a[104:107], v[112:115], v[136:139], a[104:107]
    v_mfma_f32_16x16x32_bf16 a[108:111], v[112:115], v[24:27], a[108:111]
    s_waitcnt vmcnt(14)
    v_mfma_f32_16x16x32_bf16 a[112:115], v[116:119], v[144:147], a[112:115]
    buffer_load_dwordx4 v[104:107], v1, s[64:67], s55 offen offset:0 sc1
    v_mfma_f32_16x16x32_bf16 a[116:119], v[116:119], v[148:151], a[116:119]
    v_mfma_f32_16x16x32_bf16 a[120:123], v[116:119], v[152:155], a[120:123]
    v_mfma_f32_16x16x32_bf16 a[124:127], v[116:119], v[176:179], a[124:127]
    v_mfma_f32_16x16x32_bf16 a[128:131], v[116:119], v[180:183], a[128:131]
    v_mfma_f32_16x16x32_bf16 a[132:135], v[116:119], v[136:139], a[132:135]
    v_mfma_f32_16x16x32_bf16 a[136:139], v[116:119], v[24:27], a[136:139]
    s_waitcnt vmcnt(14)
    s_waitcnt lgkmcnt(6)
    v_mfma_f32_16x16x32_bf16 a[0:3], v[120:123], v[164:167], a[0:3]
    s_add_u32 s37, s3, 3
    s_and_b32 s37, s37, 3
    s_mul_i32 s52, s37, 20480
    s_add_u32 s53, s52, 5120
    s_add_u32 s54, s52, 10240
    s_add_u32 s55, s52, 15360
    buffer_load_dwordx4 v[196:199], v254, s[64:67], s52 offen offset:0 sc1
    s_waitcnt lgkmcnt(5)
    v_mfma_f32_16x16x32_bf16 a[4:7], v[120:123], v[184:187], a[4:7]
    s_waitcnt lgkmcnt(4)
    v_mfma_f32_16x16x32_bf16 a[8:11], v[120:123], v[188:191], a[8:11]
    s_waitcnt lgkmcnt(3)
    v_mfma_f32_16x16x32_bf16 a[12:15], v[120:123], v[32:35], a[12:15]
    s_waitcnt lgkmcnt(2)
    v_mfma_f32_16x16x32_bf16 a[16:19], v[120:123], v[36:39], a[16:19]
    s_waitcnt lgkmcnt(1)
    v_mfma_f32_16x16x32_bf16 a[20:23], v[120:123], v[156:159], a[20:23]
    ds_read_b128 v[200:203], v4 offset:14336
    s_waitcnt lgkmcnt(1)
    v_mfma_f32_16x16x32_bf16 a[24:27], v[120:123], v[52:55], a[24:27]
    ds_read_b128 v[204:207], v4 offset:15360
    s_waitcnt vmcnt(14)
    v_mfma_f32_16x16x32_bf16 a[28:31], v[172:175], v[164:167], a[28:31]
    ds_read_b128 v[208:211], v4 offset:16384
    v_mfma_f32_16x16x32_bf16 a[32:35], v[172:175], v[184:187], a[32:35]
    ds_read_b128 v[60:63], v4 offset:17408
    v_mfma_f32_16x16x32_bf16 a[36:39], v[172:175], v[188:191], a[36:39]
    ds_read_b128 v[64:67], v4 offset:18432
    v_mfma_f32_16x16x32_bf16 a[40:43], v[172:175], v[32:35], a[40:43]
    ds_read_b128 v[192:195], v4 offset:19456
    v_mfma_f32_16x16x32_bf16 a[44:47], v[172:175], v[36:39], a[44:47]
    ds_read_b128 v[80:83], v4 offset:20480
    v_mfma_f32_16x16x32_bf16 a[48:51], v[172:175], v[156:159], a[48:51]
    buffer_load_dwordx4 v[84:87], v254, s[64:67], s53 offen offset:0 sc1
    v_mfma_f32_16x16x32_bf16 a[52:55], v[172:175], v[52:55], a[52:55]
    s_waitcnt vmcnt(14)
    v_mfma_f32_16x16x32_bf16 a[56:59], v[40:43], v[164:167], a[56:59]
    buffer_load_dwordx4 v[124:127], v254, s[64:67], s54 offen offset:0 sc1
    v_mfma_f32_16x16x32_bf16 a[60:63], v[40:43], v[184:187], a[60:63]
    v_mfma_f32_16x16x32_bf16 a[64:67], v[40:43], v[188:191], a[64:67]
    v_mfma_f32_16x16x32_bf16 a[68:71], v[40:43], v[32:35], a[68:71]
    v_mfma_f32_16x16x32_bf16 a[72:75], v[40:43], v[36:39], a[72:75]
    v_mfma_f32_16x16x32_bf16 a[76:79], v[40:43], v[156:159], a[76:79]
    v_mfma_f32_16x16x32_bf16 a[80:83], v[40:43], v[52:55], a[80:83]
    s_waitcnt vmcnt(14)
    v_mfma_f32_16x16x32_bf16 a[84:87], v[44:47], v[164:167], a[84:87]
    buffer_load_dwordx4 v[128:131], v254, s[64:67], s55 offen offset:0 sc1
    v_mfma_f32_16x16x32_bf16 a[88:91], v[44:47], v[184:187], a[88:91]
    v_mfma_f32_16x16x32_bf16 a[92:95], v[44:47], v[188:191], a[92:95]
    v_mfma_f32_16x16x32_bf16 a[96:99], v[44:47], v[32:35], a[96:99]
    v_mfma_f32_16x16x32_bf16 a[100:103], v[44:47], v[36:39], a[100:103]
    v_mfma_f32_16x16x32_bf16 a[104:107], v[44:47], v[156:159], a[104:107]
    v_mfma_f32_16x16x32_bf16 a[108:111], v[44:47], v[52:55], a[108:111]
    s_waitcnt vmcnt(14)
    v_mfma_f32_16x16x32_bf16 a[112:115], v[48:51], v[164:167], a[112:115]
    buffer_load_dwordx4 v[132:135], v254, s[64:67], s52 offen offset:1024 sc1
    v_mfma_f32_16x16x32_bf16 a[116:119], v[48:51], v[184:187], a[116:119]
    v_mfma_f32_16x16x32_bf16 a[120:123], v[48:51], v[188:191], a[120:123]
    v_mfma_f32_16x16x32_bf16 a[124:127], v[48:51], v[32:35], a[124:127]
    v_mfma_f32_16x16x32_bf16 a[128:131], v[48:51], v[36:39], a[128:131]
    v_mfma_f32_16x16x32_bf16 a[132:135], v[48:51], v[156:159], a[132:135]
    v_mfma_f32_16x16x32_bf16 a[136:139], v[48:51], v[52:55], a[136:139]
    s_waitcnt vmcnt(14)
    s_waitcnt lgkmcnt(6)
    v_mfma_f32_16x16x32_bf16 a[0:3], v[140:143], v[200:203], a[0:3]
    buffer_load_dwordx4 v[216:219], v254, s[64:67], s53 offen offset:1024 sc1
    s_waitcnt lgkmcnt(5)
    v_mfma_f32_16x16x32_bf16 a[4:7], v[140:143], v[204:207], a[4:7]
    s_waitcnt lgkmcnt(4)
    v_mfma_f32_16x16x32_bf16 a[8:11], v[140:143], v[208:211], a[8:11]
    s_waitcnt lgkmcnt(3)
    v_mfma_f32_16x16x32_bf16 a[12:15], v[140:143], v[60:63], a[12:15]
    s_waitcnt lgkmcnt(2)
    v_mfma_f32_16x16x32_bf16 a[16:19], v[140:143], v[64:67], a[16:19]
    s_waitcnt lgkmcnt(1)
    v_mfma_f32_16x16x32_bf16 a[20:23], v[140:143], v[192:195], a[20:23]
    ds_read_b128 v[220:223], v4 offset:21504
    s_waitcnt lgkmcnt(1)
    v_mfma_f32_16x16x32_bf16 a[24:27], v[140:143], v[80:83], a[24:27]
    ds_read_b128 v[224:227], v4 offset:22528
    s_waitcnt vmcnt(14)
    v_mfma_f32_16x16x32_bf16 a[28:31], v[28:31], v[200:203], a[28:31]
    ds_read_b128 v[168:171], v4 offset:23552
    v_mfma_f32_16x16x32_bf16 a[32:35], v[28:31], v[204:207], a[32:35]
    ds_read_b128 v[88:91], v4 offset:24576
    v_mfma_f32_16x16x32_bf16 a[36:39], v[28:31], v[208:211], a[36:39]
    ds_read_b128 v[92:95], v4 offset:25600
    v_mfma_f32_16x16x32_bf16 a[40:43], v[28:31], v[60:63], a[40:43]
    ds_read_b128 v[212:215], v4 offset:26624
    v_mfma_f32_16x16x32_bf16 a[44:47], v[28:31], v[64:67], a[44:47]
    ds_read_b128 v[108:111], v4 offset:27648
    v_mfma_f32_16x16x32_bf16 a[48:51], v[28:31], v[192:195], a[48:51]
    buffer_load_dwordx4 v[112:115], v254, s[64:67], s54 offen offset:1024 sc1
    v_mfma_f32_16x16x32_bf16 a[52:55], v[28:31], v[80:83], a[52:55]
    s_waitcnt vmcnt(14)
    v_mfma_f32_16x16x32_bf16 a[56:59], v[68:71], v[200:203], a[56:59]
    buffer_load_dwordx4 v[144:147], v254, s[64:67], s55 offen offset:1024 sc1
    v_mfma_f32_16x16x32_bf16 a[60:63], v[68:71], v[204:207], a[60:63]
    v_mfma_f32_16x16x32_bf16 a[64:67], v[68:71], v[208:211], a[64:67]
    v_mfma_f32_16x16x32_bf16 a[68:71], v[68:71], v[60:63], a[68:71]
    v_mfma_f32_16x16x32_bf16 a[72:75], v[68:71], v[64:67], a[72:75]
    v_mfma_f32_16x16x32_bf16 a[76:79], v[68:71], v[192:195], a[76:79]
    v_mfma_f32_16x16x32_bf16 a[80:83], v[68:71], v[80:83], a[80:83]
    s_waitcnt vmcnt(14)
    v_mfma_f32_16x16x32_bf16 a[84:87], v[72:75], v[200:203], a[84:87]
    buffer_load_dwordx4 v[148:151], v254, s[64:67], s52 offen offset:2048 sc1
    v_mfma_f32_16x16x32_bf16 a[88:91], v[72:75], v[204:207], a[88:91]
    v_mfma_f32_16x16x32_bf16 a[92:95], v[72:75], v[208:211], a[92:95]
    v_mfma_f32_16x16x32_bf16 a[96:99], v[72:75], v[60:63], a[96:99]
    v_mfma_f32_16x16x32_bf16 a[100:103], v[72:75], v[64:67], a[100:103]
    v_mfma_f32_16x16x32_bf16 a[104:107], v[72:75], v[192:195], a[104:107]
    v_mfma_f32_16x16x32_bf16 a[108:111], v[72:75], v[80:83], a[108:111]
    s_waitcnt vmcnt(14)
    v_mfma_f32_16x16x32_bf16 a[112:115], v[76:79], v[200:203], a[112:115]
    buffer_load_dwordx4 v[152:155], v254, s[64:67], s53 offen offset:2048 sc1
    v_mfma_f32_16x16x32_bf16 a[116:119], v[76:79], v[204:207], a[116:119]
    v_mfma_f32_16x16x32_bf16 a[120:123], v[76:79], v[208:211], a[120:123]
    v_mfma_f32_16x16x32_bf16 a[124:127], v[76:79], v[60:63], a[124:127]
    v_mfma_f32_16x16x32_bf16 a[128:131], v[76:79], v[64:67], a[128:131]
    v_mfma_f32_16x16x32_bf16 a[132:135], v[76:79], v[192:195], a[132:135]
    v_mfma_f32_16x16x32_bf16 a[136:139], v[76:79], v[80:83], a[136:139]
    s_waitcnt vmcnt(14)
    s_waitcnt lgkmcnt(6)
    v_mfma_f32_16x16x32_bf16 a[0:3], v[160:163], v[220:223], a[0:3]
    buffer_load_dwordx4 v[176:179], v254, s[64:67], s54 offen offset:2048 sc1
    s_waitcnt lgkmcnt(5)
    v_mfma_f32_16x16x32_bf16 a[4:7], v[160:163], v[224:227], a[4:7]
    s_waitcnt lgkmcnt(4)
    v_mfma_f32_16x16x32_bf16 a[8:11], v[160:163], v[168:171], a[8:11]
    s_waitcnt lgkmcnt(3)
    v_mfma_f32_16x16x32_bf16 a[12:15], v[160:163], v[88:91], a[12:15]
    s_waitcnt lgkmcnt(2)
    v_mfma_f32_16x16x32_bf16 a[16:19], v[160:163], v[92:95], a[16:19]
    s_waitcnt lgkmcnt(1)
    v_mfma_f32_16x16x32_bf16 a[20:23], v[160:163], v[212:215], a[20:23]
    ds_read_b128 v[180:183], v5 offset:0
    s_waitcnt lgkmcnt(1)
    v_mfma_f32_16x16x32_bf16 a[24:27], v[160:163], v[108:111], a[24:27]
    ds_read_b128 v[136:139], v5 offset:1024
    s_waitcnt vmcnt(14)
    v_mfma_f32_16x16x32_bf16 a[28:31], v[56:59], v[220:223], a[28:31]
    ds_read_b128 v[24:27], v5 offset:2048
    v_mfma_f32_16x16x32_bf16 a[32:35], v[56:59], v[224:227], a[32:35]
    ds_read_b128 v[116:119], v5 offset:3072
    v_mfma_f32_16x16x32_bf16 a[36:39], v[56:59], v[168:171], a[36:39]
    ds_read_b128 v[120:123], v5 offset:4096
    v_mfma_f32_16x16x32_bf16 a[40:43], v[56:59], v[88:91], a[40:43]
    ds_read_b128 v[172:175], v5 offset:5120
    v_mfma_f32_16x16x32_bf16 a[44:47], v[56:59], v[92:95], a[44:47]
    ds_read_b128 v[40:43], v5 offset:6144
    v_mfma_f32_16x16x32_bf16 a[48:51], v[56:59], v[212:215], a[48:51]
    ds_read_b128 v[44:47], v5 offset:7168
    v_mfma_f32_16x16x32_bf16 a[52:55], v[56:59], v[108:111], a[52:55]
    ds_read_b128 v[164:167], v5 offset:8192
    s_waitcnt vmcnt(13)
    v_mfma_f32_16x16x32_bf16 a[56:59], v[96:99], v[220:223], a[56:59]
    ds_read_b128 v[184:187], v5 offset:9216
    v_mfma_f32_16x16x32_bf16 a[60:63], v[96:99], v[224:227], a[60:63]
    ds_read_b128 v[188:191], v5 offset:10240
    v_mfma_f32_16x16x32_bf16 a[64:67], v[96:99], v[168:171], a[64:67]
    ds_read_b128 v[32:35], v5 offset:11264
    v_mfma_f32_16x16x32_bf16 a[68:71], v[96:99], v[88:91], a[68:71]
    ds_read_b128 v[36:39], v5 offset:12288
    v_mfma_f32_16x16x32_bf16 a[72:75], v[96:99], v[92:95], a[72:75]
    ds_read_b128 v[156:159], v5 offset:13312
    v_mfma_f32_16x16x32_bf16 a[76:79], v[96:99], v[212:215], a[76:79]
    buffer_load_dwordx4 v[52:55], v254, s[64:67], s55 offen offset:2048 sc1
    v_mfma_f32_16x16x32_bf16 a[80:83], v[96:99], v[108:111], a[80:83]
    buffer_load_dwordx4 v[48:51], v254, s[64:67], s52 offen offset:3072 sc1
    s_waitcnt vmcnt(14)
    v_mfma_f32_16x16x32_bf16 a[84:87], v[100:103], v[220:223], a[84:87]
    buffer_load_dwordx4 v[140:143], v254, s[64:67], s53 offen offset:3072 sc1
    v_mfma_f32_16x16x32_bf16 a[88:91], v[100:103], v[224:227], a[88:91]
    v_mfma_f32_16x16x32_bf16 a[92:95], v[100:103], v[168:171], a[92:95]
    v_mfma_f32_16x16x32_bf16 a[96:99], v[100:103], v[88:91], a[96:99]
    v_mfma_f32_16x16x32_bf16 a[100:103], v[100:103], v[92:95], a[100:103]
    v_mfma_f32_16x16x32_bf16 a[104:107], v[100:103], v[212:215], a[104:107]
    v_mfma_f32_16x16x32_bf16 a[108:111], v[100:103], v[108:111], a[108:111]
    s_waitcnt vmcnt(14)
    v_mfma_f32_16x16x32_bf16 a[112:115], v[104:107], v[220:223], a[112:115]
    buffer_load_dwordx4 v[28:31], v254, s[64:67], s54 offen offset:3072 sc1
    v_mfma_f32_16x16x32_bf16 a[116:119], v[104:107], v[224:227], a[116:119]
    v_mfma_f32_16x16x32_bf16 a[120:123], v[104:107], v[168:171], a[120:123]
    v_mfma_f32_16x16x32_bf16 a[124:127], v[104:107], v[88:91], a[124:127]
    v_mfma_f32_16x16x32_bf16 a[128:131], v[104:107], v[92:95], a[128:131]
    v_mfma_f32_16x16x32_bf16 a[132:135], v[104:107], v[212:215], a[132:135]
    v_mfma_f32_16x16x32_bf16 a[136:139], v[104:107], v[108:111], a[136:139]
    s_waitcnt vmcnt(14)
    s_waitcnt lgkmcnt(13)
    v_mfma_f32_16x16x32_bf16 a[0:3], v[196:199], v[180:183], a[0:3]
    ds_read_b128 v[68:71], v5 offset:14336
    s_waitcnt lgkmcnt(13)
    v_mfma_f32_16x16x32_bf16 a[4:7], v[196:199], v[136:139], a[4:7]
    ds_read_b128 v[72:75], v5 offset:15360
    s_waitcnt lgkmcnt(13)
    v_mfma_f32_16x16x32_bf16 a[8:11], v[196:199], v[24:27], a[8:11]
    ds_read_b128 v[200:203], v5 offset:16384
    s_waitcnt lgkmcnt(13)
    v_mfma_f32_16x16x32_bf16 a[12:15], v[196:199], v[116:119], a[12:15]
    ds_read_b128 v[204:207], v5 offset:17408
    s_waitcnt lgkmcnt(13)
    v_mfma_f32_16x16x32_bf16 a[16:19], v[196:199], v[120:123], a[16:19]
    ds_read_b128 v[208:211], v5 offset:18432
    s_waitcnt lgkmcnt(13)
    v_mfma_f32_16x16x32_bf16 a[20:23], v[196:199], v[172:175], a[20:23]
    ds_read_b128 v[60:63], v5 offset:19456
    s_waitcnt lgkmcnt(13)
    v_mfma_f32_16x16x32_bf16 a[24:27], v[196:199], v[40:43], a[24:27]
    ds_read_b128 v[64:67], v5 offset:20480
    s_waitcnt vmcnt(13)
    s_waitcnt lgkmcnt(13)
    v_mfma_f32_16x16x32_bf16 a[0:3], v[84:87], v[44:47], a[0:3]
    ds_read_b128 v[192:195], v5 offset:21504
    s_waitcnt lgkmcnt(13)
    v_mfma_f32_16x16x32_bf16 a[4:7], v[84:87], v[164:167], a[4:7]
    ds_read_b128 v[80:83], v5 offset:22528
    s_waitcnt lgkmcnt(13)
    v_mfma_f32_16x16x32_bf16 a[8:11], v[84:87], v[184:187], a[8:11]
    ds_read_b128 v[76:79], v5 offset:23552
    s_waitcnt lgkmcnt(13)
    v_mfma_f32_16x16x32_bf16 a[12:15], v[84:87], v[188:191], a[12:15]
    ds_read_b128 v[160:163], v5 offset:24576
    s_waitcnt lgkmcnt(13)
    v_mfma_f32_16x16x32_bf16 a[16:19], v[84:87], v[32:35], a[16:19]
    ds_read_b128 v[56:59], v5 offset:25600
    s_waitcnt lgkmcnt(13)
    v_mfma_f32_16x16x32_bf16 a[20:23], v[84:87], v[36:39], a[20:23]
    ds_read_b128 v[96:99], v5 offset:26624
    s_waitcnt lgkmcnt(13)
    v_mfma_f32_16x16x32_bf16 a[24:27], v[84:87], v[156:159], a[24:27]
    ds_read_b128 v[100:103], v5 offset:27648
    s_waitcnt vmcnt(12)
    s_waitcnt lgkmcnt(13)
    v_mfma_f32_16x16x32_bf16 a[0:3], v[124:127], v[68:71], a[0:3]
    buffer_load_dwordx4 v[220:223], v254, s[64:67], s55 offen offset:3072 sc1
    s_waitcnt lgkmcnt(12)
    v_mfma_f32_16x16x32_bf16 a[4:7], v[124:127], v[72:75], a[4:7]
    buffer_load_dwordx4 v[224:227], v1, s[64:67], s52 offen offset:0 sc1
    s_waitcnt lgkmcnt(11)
    v_mfma_f32_16x16x32_bf16 a[8:11], v[124:127], v[200:203], a[8:11]
    buffer_load_dwordx4 v[168:171], v1, s[64:67], s53 offen offset:0 sc1
    s_waitcnt lgkmcnt(10)
    v_mfma_f32_16x16x32_bf16 a[12:15], v[124:127], v[204:207], a[12:15]
    s_waitcnt lgkmcnt(9)
    v_mfma_f32_16x16x32_bf16 a[16:19], v[124:127], v[208:211], a[16:19]
    s_waitcnt lgkmcnt(8)
    v_mfma_f32_16x16x32_bf16 a[20:23], v[124:127], v[60:63], a[20:23]
    s_waitcnt lgkmcnt(7)
    v_mfma_f32_16x16x32_bf16 a[24:27], v[124:127], v[64:67], a[24:27]
    s_waitcnt vmcnt(14)
    s_waitcnt lgkmcnt(6)
    v_mfma_f32_16x16x32_bf16 a[0:3], v[128:131], v[192:195], a[0:3]
    buffer_load_dwordx4 v[88:91], v1, s[64:67], s54 offen offset:0 sc1
    s_waitcnt lgkmcnt(5)
    v_mfma_f32_16x16x32_bf16 a[4:7], v[128:131], v[80:83], a[4:7]
    s_waitcnt lgkmcnt(4)
    v_mfma_f32_16x16x32_bf16 a[8:11], v[128:131], v[76:79], a[8:11]
    s_waitcnt lgkmcnt(3)
    v_mfma_f32_16x16x32_bf16 a[12:15], v[128:131], v[160:163], a[12:15]
    s_waitcnt lgkmcnt(2)
    v_mfma_f32_16x16x32_bf16 a[16:19], v[128:131], v[56:59], a[16:19]
    s_waitcnt lgkmcnt(1)
    v_mfma_f32_16x16x32_bf16 a[20:23], v[128:131], v[96:99], a[20:23]
    s_waitcnt lgkmcnt(0)
    v_mfma_f32_16x16x32_bf16 a[24:27], v[128:131], v[100:103], a[24:27]
    s_waitcnt vmcnt(14)
    v_mfma_f32_16x16x32_bf16 a[28:31], v[132:135], v[180:183], a[28:31]
    buffer_load_dwordx4 v[92:95], v1, s[64:67], s55 offen offset:0 sc1
    v_accvgpr_read_b32 v18, a0
    v_mfma_f32_16x16x32_bf16 a[32:35], v[132:135], v[136:139], a[32:35]
    v_accvgpr_read_b32 v19, a1
    v_cvt_pk_bf16_f32 v6, v18, v19
    v_mfma_f32_16x16x32_bf16 a[36:39], v[132:135], v[24:27], a[36:39]
    v_accvgpr_read_b32 v20, a2
    v_accvgpr_read_b32 v21, a3
    v_mfma_f32_16x16x32_bf16 a[40:43], v[132:135], v[116:119], a[40:43]
    v_cvt_pk_bf16_f32 v7, v20, v21
    v_accvgpr_read_b32 v18, a4
    v_mfma_f32_16x16x32_bf16 a[44:47], v[132:135], v[120:123], a[44:47]
    s_add_u32 s37, s3, 1
    s_and_b32 s37, s37, 3
    s_mul_i32 s52, s37, 20480
    s_add_u32 s52, s52, 655360
    s_add_u32 s53, s52, 5120
    s_add_u32 s54, s52, 10240
    s_add_u32 s55, s52, 15360
    buffer_load_dwordx4 a[0:3], v254, s[64:67], s52 offen offset:0 sc1
    v_accvgpr_read_b32 v19, a5
    v_mfma_f32_16x16x32_bf16 a[48:51], v[132:135], v[172:175], a[48:51]
    v_cvt_pk_bf16_f32 v8, v18, v19
    v_accvgpr_read_b32 v20, a6
    v_mfma_f32_16x16x32_bf16 a[52:55], v[132:135], v[40:43], a[52:55]
    v_accvgpr_read_b32 v21, a7
    v_cvt_pk_bf16_f32 v9, v20, v21
    s_waitcnt vmcnt(15)
    v_mfma_f32_16x16x32_bf16 a[28:31], v[216:219], v[44:47], a[28:31]
    s_mov_b32 s40, 0
    buffer_store_dwordx4 v[6:9], v254, s[20:23], s40 offen sc1
    v_mfma_f32_16x16x32_bf16 a[32:35], v[216:219], v[164:167], a[32:35]
    buffer_load_dwordx4 a[4:7], v254, s[64:67], s52 offen offset:1024 sc1
    v_accvgpr_read_b32 v18, a8
    v_mfma_f32_16x16x32_bf16 a[36:39], v[216:219], v[184:187], a[36:39]
    v_accvgpr_read_b32 v19, a9
    v_cvt_pk_bf16_f32 v10, v18, v19
    v_mfma_f32_16x16x32_bf16 a[40:43], v[216:219], v[188:191], a[40:43]
    v_accvgpr_read_b32 v20, a10
    v_accvgpr_read_b32 v21, a11
    v_mfma_f32_16x16x32_bf16 a[44:47], v[216:219], v[32:35], a[44:47]
    v_cvt_pk_bf16_f32 v11, v20, v21
    v_accvgpr_read_b32 v18, a12
    v_mfma_f32_16x16x32_bf16 a[48:51], v[216:219], v[36:39], a[48:51]
    buffer_load_dwordx4 a[8:11], v254, s[64:67], s52 offen offset:2048 sc1
    v_accvgpr_read_b32 v19, a13
    v_mfma_f32_16x16x32_bf16 a[52:55], v[216:219], v[156:159], a[52:55]
    v_cvt_pk_bf16_f32 v12, v18, v19
    v_accvgpr_read_b32 v20, a14
    s_waitcnt vmcnt(17)
    v_mfma_f32_16x16x32_bf16 a[28:31], v[112:115], v[68:71], a[28:31]
    v_accvgpr_read_b32 v21, a15
    v_cvt_pk_bf16_f32 v13, v20, v21
    v_mfma_f32_16x16x32_bf16 a[32:35], v[112:115], v[72:75], a[32:35]
    s_mov_b32 s40, 1024
    buffer_store_dwordx4 v[10:13], v254, s[20:23], s40 offen sc1
    v_mfma_f32_16x16x32_bf16 a[36:39], v[112:115], v[200:203], a[36:39]
    buffer_load_dwordx4 a[12:15], v254, s[64:67], s52 offen offset:3072 sc1
    v_accvgpr_read_b32 v18, a16
    v_mfma_f32_16x16x32_bf16 a[40:43], v[112:115], v[204:207], a[40:43]
    v_accvgpr_read_b32 v19, a17
    v_cvt_pk_bf16_f32 v14, v18, v19
    v_mfma_f32_16x16x32_bf16 a[44:47], v[112:115], v[208:211], a[44:47]
    v_accvgpr_read_b32 v20, a18
    v_accvgpr_read_b32 v21, a19
    v_mfma_f32_16x16x32_bf16 a[48:51], v[112:115], v[60:63], a[48:51]
    v_cvt_pk_bf16_f32 v15, v20, v21
    v_accvgpr_read_b32 v18, a20
    v_mfma_f32_16x16x32_bf16 a[52:55], v[112:115], v[64:67], a[52:55]
    buffer_load_dwordx4 a[16:19], v1, s[64:67], s52 offen offset:0 sc1
    v_accvgpr_read_b32 v19, a21
    s_waitcnt vmcnt(19)
    v_mfma_f32_16x16x32_bf16 a[28:31], v[144:147], v[192:195], a[28:31]
    v_cvt_pk_bf16_f32 v16, v18, v19
    v_accvgpr_read_b32 v20, a22
    v_mfma_f32_16x16x32_bf16 a[32:35], v[144:147], v[80:83], a[32:35]
    v_accvgpr_read_b32 v21, a23
    v_cvt_pk_bf16_f32 v17, v20, v21
    v_mfma_f32_16x16x32_bf16 a[36:39], v[144:147], v[76:79], a[36:39]
    s_mov_b32 s40, 2048
    buffer_store_dwordx4 v[14:17], v254, s[20:23], s40 offen sc1
    v_mfma_f32_16x16x32_bf16 a[40:43], v[144:147], v[160:163], a[40:43]
    buffer_load_dwordx4 a[20:23], v254, s[64:67], s53 offen offset:0 sc1
    v_mfma_f32_16x16x32_bf16 a[44:47], v[144:147], v[56:59], a[44:47]
    v_mfma_f32_16x16x32_bf16 a[48:51], v[144:147], v[96:99], a[48:51]
    v_mfma_f32_16x16x32_bf16 a[52:55], v[144:147], v[100:103], a[52:55]
    v_accvgpr_read_b32 v18, a24
    v_accvgpr_read_b32 v19, a25
    s_waitcnt vmcnt(20)
    v_mfma_f32_16x16x32_bf16 a[56:59], v[148:151], v[180:183], a[56:59]
    v_cvt_pk_bf16_f32 v6, v18, v19
    v_accvgpr_read_b32 v20, a26
    v_mfma_f32_16x16x32_bf16 a[60:63], v[148:151], v[136:139], a[60:63]
    v_accvgpr_read_b32 v21, a27
    v_cvt_pk_bf16_f32 v7, v20, v21
    v_mfma_f32_16x16x32_bf16 a[64:67], v[148:151], v[24:27], a[64:67]
    v_accvgpr_read_b32 v18, a28
    v_accvgpr_read_b32 v19, a29
    v_mfma_f32_16x16x32_bf16 a[68:71], v[148:151], v[116:119], a[68:71]
    buffer_load_dwordx4 a[24:27], v254, s[64:67], s53 offen offset:1024 sc1
    v_cvt_pk_bf16_f32 v8, v18, v19
    v_mfma_f32_16x16x32_bf16 a[72:75], v[148:151], v[120:123], a[72:75]
    v_accvgpr_read_b32 v20, a30
    v_accvgpr_read_b32 v21, a31
    v_mfma_f32_16x16x32_bf16 a[76:79], v[148:151], v[172:175], a[76:79]
    v_cvt_pk_bf16_f32 v9, v20, v21
    s_mov_b32 s40, 3072
    v_mfma_f32_16x16x32_bf16 a[80:83], v[148:151], v[40:43], a[80:83]
    buffer_load_dwordx4 a[28:31], v254, s[64:67], s53 offen offset:2048 sc1
    buffer_store_dwordx4 v[6:9], v254, s[20:23], s40 offen sc1
    s_waitcnt vmcnt(22)
    v_mfma_f32_16x16x32_bf16 a[56:59], v[152:155], v[44:47], a[56:59]
    v_accvgpr_read_b32 v18, a32
    v_accvgpr_read_b32 v19, a33
    v_mfma_f32_16x16x32_bf16 a[60:63], v[152:155], v[164:167], a[60:63]
    v_cvt_pk_bf16_f32 v10, v18, v19
    v_accvgpr_read_b32 v20, a34
    v_mfma_f32_16x16x32_bf16 a[64:67], v[152:155], v[184:187], a[64:67]
    v_accvgpr_read_b32 v21, a35
    v_cvt_pk_bf16_f32 v11, v20, v21
    v_mfma_f32_16x16x32_bf16 a[68:71], v[152:155], v[188:191], a[68:71]
    v_accvgpr_read_b32 v18, a36
    v_accvgpr_read_b32 v19, a37
    v_mfma_f32_16x16x32_bf16 a[72:75], v[152:155], v[32:35], a[72:75]
    buffer_load_dwordx4 a[32:35], v254, s[64:67], s53 offen offset:3072 sc1
    v_cvt_pk_bf16_f32 v12, v18, v19
    v_mfma_f32_16x16x32_bf16 a[76:79], v[152:155], v[36:39], a[76:79]
    v_accvgpr_read_b32 v20, a38
    v_accvgpr_read_b32 v21, a39
    v_mfma_f32_16x16x32_bf16 a[80:83], v[152:155], v[156:159], a[80:83]
    v_cvt_pk_bf16_f32 v13, v20, v21
    s_mov_b32 s40, 4096
    s_waitcnt vmcnt(22)
    v_mfma_f32_16x16x32_bf16 a[56:59], v[176:179], v[68:71], a[56:59]
    buffer_load_dwordx4 a[36:39], v1, s[64:67], s53 offen offset:0 sc1
    buffer_store_dwordx4 v[10:13], v254, s[20:23], s40 offen sc1
    v_mfma_f32_16x16x32_bf16 a[60:63], v[176:179], v[72:75], a[60:63]
    v_accvgpr_read_b32 v18, a40
    v_accvgpr_read_b32 v19, a41
    v_mfma_f32_16x16x32_bf16 a[64:67], v[176:179], v[200:203], a[64:67]
    v_cvt_pk_bf16_f32 v14, v18, v19
    v_accvgpr_read_b32 v20, a42
    v_mfma_f32_16x16x32_bf16 a[68:71], v[176:179], v[204:207], a[68:71]
    v_accvgpr_read_b32 v21, a43
    v_cvt_pk_bf16_f32 v15, v20, v21
    v_mfma_f32_16x16x32_bf16 a[72:75], v[176:179], v[208:211], a[72:75]
    v_accvgpr_read_b32 v18, a44
    v_accvgpr_read_b32 v19, a45
    v_mfma_f32_16x16x32_bf16 a[76:79], v[176:179], v[60:63], a[76:79]
    buffer_load_dwordx4 a[40:43], v254, s[64:67], s54 offen offset:0 sc1
    v_cvt_pk_bf16_f32 v16, v18, v19
    v_mfma_f32_16x16x32_bf16 a[80:83], v[176:179], v[64:67], a[80:83]
    v_accvgpr_read_b32 v20, a46
    v_accvgpr_read_b32 v21, a47
    s_waitcnt vmcnt(24)
    v_mfma_f32_16x16x32_bf16 a[56:59], v[52:55], v[192:195], a[56:59]
    v_cvt_pk_bf16_f32 v17, v20, v21
    s_mov_b32 s40, 5120
    v_mfma_f32_16x16x32_bf16 a[60:63], v[52:55], v[80:83], a[60:63]
    buffer_load_dwordx4 a[44:47], v254, s[64:67], s54 offen offset:1024 sc1
    buffer_store_dwordx4 v[14:17], v254, s[20:23], s40 offen sc1
    v_mfma_f32_16x16x32_bf16 a[64:67], v[52:55], v[76:79], a[64:67]
    v_accvgpr_read_b32 v18, a48
    v_accvgpr_read_b32 v19, a49
    v_mfma_f32_16x16x32_bf16 a[68:71], v[52:55], v[160:163], a[68:71]
    v_cvt_pk_bf16_f32 v6, v18, v19
    v_accvgpr_read_b32 v20, a50
    v_mfma_f32_16x16x32_bf16 a[72:75], v[52:55], v[56:59], a[72:75]
    v_accvgpr_read_b32 v21, a51
    v_cvt_pk_bf16_f32 v7, v20, v21
    v_mfma_f32_16x16x32_bf16 a[76:79], v[52:55], v[96:99], a[76:79]
    v_accvgpr_read_b32 v18, a52
    v_accvgpr_read_b32 v19, a53
    v_mfma_f32_16x16x32_bf16 a[80:83], v[52:55], v[100:103], a[80:83]
    buffer_load_dwordx4 a[48:51], v254, s[64:67], s54 offen offset:2048 sc1
    v_cvt_pk_bf16_f32 v8, v18, v19
    s_waitcnt vmcnt(26)
    v_mfma_f32_16x16x32_bf16 a[84:87], v[48:51], v[180:183], a[84:87]
    v_accvgpr_read_b32 v20, a54
    v_accvgpr_read_b32 v21, a55
    v_mfma_f32_16x16x32_bf16 a[88:91], v[48:51], v[136:139], a[88:91]
    v_cvt_pk_bf16_f32 v9, v20, v21
    s_mov_b32 s40, 6144
    v_mfma_f32_16x16x32_bf16 a[92:95], v[48:51], v[24:27], a[92:95]
    buffer_load_dwordx4 a[52:55], v254, s[64:67], s54 offen offset:3072 sc1
    buffer_store_dwordx4 v[6:9], v254, s[20:23], s40 offen sc1
    v_mfma_f32_16x16x32_bf16 a[96:99], v[48:51], v[116:119], a[96:99]
    v_accvgpr_read_b32 v18, a56
    v_accvgpr_read_b32 v19, a57
    v_mfma_f32_16x16x32_bf16 a[100:103], v[48:51], v[120:123], a[100:103]
    v_cvt_pk_bf16_f32 v10, v18, v19
    v_accvgpr_read_b32 v20, a58
    v_mfma_f32_16x16x32_bf16 a[104:107], v[48:51], v[172:175], a[104:107]
    v_accvgpr_read_b32 v21, a59
    v_cvt_pk_bf16_f32 v11, v20, v21
    v_mfma_f32_16x16x32_bf16 a[108:111], v[48:51], v[40:43], a[108:111]
    v_accvgpr_read_b32 v18, a60
    v_accvgpr_read_b32 v19, a61
    s_waitcnt vmcnt(27)
    v_mfma_f32_16x16x32_bf16 a[84:87], v[140:143], v[44:47], a[84:87]
    buffer_load_dwordx4 a[56:59], v1, s[64:67], s54 offen offset:0 sc1
    v_cvt_pk_bf16_f32 v12, v18, v19
    v_mfma_f32_16x16x32_bf16 a[88:91], v[140:143], v[164:167], a[88:91]
    v_accvgpr_read_b32 v20, a62
    v_accvgpr_read_b32 v21, a63
    v_mfma_f32_16x16x32_bf16 a[92:95], v[140:143], v[184:187], a[92:95]
    v_cvt_pk_bf16_f32 v13, v20, v21
    s_mov_b32 s40, 7168
    v_mfma_f32_16x16x32_bf16 a[96:99], v[140:143], v[188:191], a[96:99]
    buffer_load_dwordx4 a[60:63], v254, s[64:67], s55 offen offset:0 sc1
    buffer_store_dwordx4 v[10:13], v254, s[20:23], s40 offen sc1
    v_mfma_f32_16x16x32_bf16 a[100:103], v[140:143], v[32:35], a[100:103]
    v_accvgpr_read_b32 v18, a64
    v_accvgpr_read_b32 v19, a65
    v_mfma_f32_16x16x32_bf16 a[104:107], v[140:143], v[36:39], a[104:107]
    v_cvt_pk_bf16_f32 v14, v18, v19
    v_accvgpr_read_b32 v20, a66
    v_mfma_f32_16x16x32_bf16 a[108:111], v[140:143], v[156:159], a[108:111]
    v_accvgpr_read_b32 v21, a67
    v_cvt_pk_bf16_f32 v15, v20, v21
    s_waitcnt vmcnt(29)
    v_mfma_f32_16x16x32_bf16 a[84:87], v[28:31], v[68:71], a[84:87]
    v_accvgpr_read_b32 v18, a68
    v_accvgpr_read_b32 v19, a69
    v_mfma_f32_16x16x32_bf16 a[88:91], v[28:31], v[72:75], a[88:91]
    buffer_load_dwordx4 a[64:67], v254, s[64:67], s55 offen offset:1024 sc1
    v_cvt_pk_bf16_f32 v16, v18, v19
    v_mfma_f32_16x16x32_bf16 a[92:95], v[28:31], v[200:203], a[92:95]
    v_accvgpr_read_b32 v20, a70
    v_accvgpr_read_b32 v21, a71
    v_mfma_f32_16x16x32_bf16 a[96:99], v[28:31], v[204:207], a[96:99]
    v_cvt_pk_bf16_f32 v17, v20, v21
    s_mov_b32 s40, 8192
    v_mfma_f32_16x16x32_bf16 a[100:103], v[28:31], v[208:211], a[100:103]
    buffer_load_dwordx4 a[68:71], v254, s[64:67], s55 offen offset:2048 sc1
    buffer_store_dwordx4 v[14:17], v254, s[20:23], s40 offen sc1
    v_mfma_f32_16x16x32_bf16 a[104:107], v[28:31], v[60:63], a[104:107]
    v_accvgpr_read_b32 v18, a72
    v_accvgpr_read_b32 v19, a73
    v_mfma_f32_16x16x32_bf16 a[108:111], v[28:31], v[64:67], a[108:111]
    v_cvt_pk_bf16_f32 v6, v18, v19
    v_accvgpr_read_b32 v20, a74
    s_waitcnt vmcnt(31)
    v_mfma_f32_16x16x32_bf16 a[84:87], v[220:223], v[192:195], a[84:87]
    v_accvgpr_read_b32 v21, a75
    v_cvt_pk_bf16_f32 v7, v20, v21
    v_mfma_f32_16x16x32_bf16 a[88:91], v[220:223], v[80:83], a[88:91]
    v_accvgpr_read_b32 v18, a76
    v_accvgpr_read_b32 v19, a77
    v_mfma_f32_16x16x32_bf16 a[92:95], v[220:223], v[76:79], a[92:95]
    buffer_load_dwordx4 a[72:75], v254, s[64:67], s55 offen offset:3072 sc1
    v_cvt_pk_bf16_f32 v8, v18, v19
    v_mfma_f32_16x16x32_bf16 a[96:99], v[220:223], v[160:163], a[96:99]
    v_accvgpr_read_b32 v20, a78
    v_accvgpr_read_b32 v21, a79
    v_mfma_f32_16x16x32_bf16 a[100:103], v[220:223], v[56:59], a[100:103]
    v_cvt_pk_bf16_f32 v9, v20, v21
    s_mov_b32 s40, 9216
    v_mfma_f32_16x16x32_bf16 a[104:107], v[220:223], v[96:99], a[104:107]
    ds_read_b128 v[212:215], v3 offset:0
    buffer_store_dwordx4 v[6:9], v254, s[20:23], s40 offen sc1
    v_mfma_f32_16x16x32_bf16 a[108:111], v[220:223], v[100:103], a[108:111]
    ds_read_b128 v[108:111], v3 offset:1024
    v_accvgpr_read_b32 v18, a80
    s_waitcnt vmcnt(32)
    v_mfma_f32_16x16x32_bf16 a[112:115], v[224:227], v[180:183], a[112:115]
    ds_read_b128 v[104:107], v3 offset:2048
    v_accvgpr_read_b32 v19, a81
    v_mfma_f32_16x16x32_bf16 a[116:119], v[224:227], v[136:139], a[116:119]
    ds_read_b128 v[196:199], v3 offset:3072
    v_cvt_pk_bf16_f32 v10, v18, v19
    v_mfma_f32_16x16x32_bf16 a[120:123], v[224:227], v[24:27], a[120:123]
    ds_read_b128 v[84:87], v3 offset:4096
    v_accvgpr_read_b32 v20, a82
    v_mfma_f32_16x16x32_bf16 a[124:127], v[224:227], v[116:119], a[124:127]
    ds_read_b128 v[124:127], v3 offset:5120
    v_accvgpr_read_b32 v21, a83
    v_mfma_f32_16x16x32_bf16 a[128:131], v[224:227], v[120:123], a[128:131]
    ds_read_b128 v[128:131], v3 offset:6144
    v_cvt_pk_bf16_f32 v11, v20, v21
    v_mfma_f32_16x16x32_bf16 a[132:135], v[224:227], v[172:175], a[132:135]
    buffer_load_dwordx4 a[76:79], v1, s[64:67], s55 offen offset:0 sc1
    v_accvgpr_read_b32 v18, a84
    v_mfma_f32_16x16x32_bf16 a[136:139], v[224:227], v[40:43], a[136:139]
    s_add_u32 s37, s3, 2
    s_and_b32 s37, s37, 3
    s_mul_i32 s52, s37, 20480
    s_add_u32 s52, s52, 655360
    s_add_u32 s53, s52, 5120
    s_add_u32 s54, s52, 10240
    s_add_u32 s55, s52, 15360
    buffer_load_dwordx4 a[80:83], v254, s[64:67], s52 offen offset:0 sc1
    v_accvgpr_read_b32 v19, a85
    s_waitcnt vmcnt(33)
    v_mfma_f32_16x16x32_bf16 a[112:115], v[168:171], v[44:47], a[112:115]
    v_cvt_pk_bf16_f32 v12, v18, v19
    v_accvgpr_read_b32 v20, a86
    v_mfma_f32_16x16x32_bf16 a[116:119], v[168:171], v[164:167], a[116:119]
    v_accvgpr_read_b32 v21, a87
    v_cvt_pk_bf16_f32 v13, v20, v21
    v_mfma_f32_16x16x32_bf16 a[120:123], v[168:171], v[184:187], a[120:123]
    s_mov_b32 s40, 10240
    buffer_store_dwordx4 v[10:13], v254, s[20:23], s40 offen sc1
    v_mfma_f32_16x16x32_bf16 a[124:127], v[168:171], v[188:191], a[124:127]
    buffer_load_dwordx4 a[84:87], v254, s[64:67], s52 offen offset:1024 sc1
    v_accvgpr_read_b32 v18, a88
    v_mfma_f32_16x16x32_bf16 a[128:131], v[168:171], v[32:35], a[128:131]
    v_accvgpr_read_b32 v19, a89
    v_cvt_pk_bf16_f32 v14, v18, v19
    v_mfma_f32_16x16x32_bf16 a[132:135], v[168:171], v[36:39], a[132:135]
    v_accvgpr_read_b32 v20, a90
    v_accvgpr_read_b32 v21, a91
    v_mfma_f32_16x16x32_bf16 a[136:139], v[168:171], v[156:159], a[136:139]
    v_cvt_pk_bf16_f32 v15, v20, v21
    v_accvgpr_read_b32 v18, a92
    s_waitcnt vmcnt(34)
    v_mfma_f32_16x16x32_bf16 a[112:115], v[88:91], v[68:71], a[112:115]
    buffer_load_dwordx4 a[88:91], v254, s[64:67], s52 offen offset:2048 sc1
    v_accvgpr_read_b32 v19, a93
    v_mfma_f32_16x16x32_bf16 a[116:119], v[88:91], v[72:75], a[116:119]
    v_cvt_pk_bf16_f32 v16, v18, v19
    v_accvgpr_read_b32 v20, a94
    v_mfma_f32_16x16x32_bf16 a[120:123], v[88:91], v[200:203], a[120:123]
    v_accvgpr_read_b32 v21, a95
    v_cvt_pk_bf16_f32 v17, v20, v21
    v_mfma_f32_16x16x32_bf16 a[124:127], v[88:91], v[204:207], a[124:127]
    s_mov_b32 s40, 11264
    buffer_store_dwordx4 v[14:17], v254, s[20:23], s40 offen sc1
    v_mfma_f32_16x16x32_bf16 a[128:131], v[88:91], v[208:211], a[128:131]
    buffer_load_dwordx4 a[92:95], v254, s[64:67], s52 offen offset:3072 sc1
    v_accvgpr_read_b32 v18, a96
    v_mfma_f32_16x16x32_bf16 a[132:135], v[88:91], v[60:63], a[132:135]
    v_accvgpr_read_b32 v19, a97
    v_cvt_pk_bf16_f32 v6, v18, v19
    v_mfma_f32_16x16x32_bf16 a[136:139], v[88:91], v[64:67], a[136:139]
    v_accvgpr_read_b32 v20, a98
    v_accvgpr_read_b32 v21, a99
    s_waitcnt vmcnt(36)
    v_mfma_f32_16x16x32_bf16 a[112:115], v[92:95], v[192:195], a[112:115]
    v_cvt_pk_bf16_f32 v7, v20, v21
    v_accvgpr_read_b32 v18, a100
    v_mfma_f32_16x16x32_bf16 a[116:119], v[92:95], v[80:83], a[116:119]
    buffer_load_dwordx4 a[96:99], v1, s[64:67], s52 offen offset:0 sc1
    v_accvgpr_read_b32 v19, a101
    v_mfma_f32_16x16x32_bf16 a[120:123], v[92:95], v[76:79], a[120:123]
    v_cvt_pk_bf16_f32 v8, v18, v19
    v_accvgpr_read_b32 v20, a102
    v_mfma_f32_16x16x32_bf16 a[124:127], v[92:95], v[160:163], a[124:127]
    v_accvgpr_read_b32 v21, a103
    v_cvt_pk_bf16_f32 v9, v20, v21
    v_mfma_f32_16x16x32_bf16 a[128:131], v[92:95], v[56:59], a[128:131]
    s_mov_b32 s40, 12288
    buffer_store_dwordx4 v[6:9], v254, s[20:23], s40 offen sc1
    v_mfma_f32_16x16x32_bf16 a[132:135], v[92:95], v[96:99], a[132:135]
    buffer_load_dwordx4 a[100:103], v254, s[64:67], s53 offen offset:0 sc1
    v_accvgpr_read_b32 v18, a104
    v_mfma_f32_16x16x32_bf16 a[136:139], v[92:95], v[100:103], a[136:139]
    v_accvgpr_read_b32 v19, a105
    v_cvt_pk_bf16_f32 v10, v18, v19
    s_waitcnt vmcnt(38)
    s_waitcnt lgkmcnt(6)
    v_mfma_f32_16x16x32_bf16 a[140:143], a[0:3], v[212:215], a[140:143]
    v_accvgpr_read_b32 v20, a106
    v_accvgpr_read_b32 v21, a107
    s_waitcnt lgkmcnt(5)
    v_mfma_f32_16x16x32_bf16 a[144:147], a[0:3], v[108:111], a[144:147]
    v_cvt_pk_bf16_f32 v11, v20, v21
    v_accvgpr_read_b32 v18, a108
    s_waitcnt lgkmcnt(4)
    v_mfma_f32_16x16x32_bf16 a[148:151], a[0:3], v[104:107], a[148:151]
    buffer_load_dwordx4 a[104:107], v254, s[64:67], s53 offen offset:1024 sc1
    v_accvgpr_read_b32 v19, a109
    s_waitcnt lgkmcnt(3)
    v_mfma_f32_16x16x32_bf16 a[152:155], a[0:3], v[196:199], a[152:155]
    v_cvt_pk_bf16_f32 v12, v18, v19
    v_accvgpr_read_b32 v20, a110
    s_waitcnt lgkmcnt(2)
    v_mfma_f32_16x16x32_bf16 a[156:159], a[0:3], v[84:87], a[156:159]
    v_accvgpr_read_b32 v21, a111
    v_cvt_pk_bf16_f32 v13, v20, v21
    s_waitcnt lgkmcnt(1)
    v_mfma_f32_16x16x32_bf16 a[160:163], a[0:3], v[124:127], a[160:163]
    ds_read_b128 v[132:135], v3 offset:7168
    s_mov_b32 s40, 13312
    s_waitcnt lgkmcnt(1)
    v_mfma_f32_16x16x32_bf16 a[164:167], a[0:3], v[128:131], a[164:167]
    ds_read_b128 v[216:219], v3 offset:8192
    buffer_store_dwordx4 v[10:13], v254, s[20:23], s40 offen sc1
    s_waitcnt vmcnt(38)
    v_mfma_f32_16x16x32_bf16 a[168:171], a[4:7], v[212:215], a[168:171]
    ds_read_b128 v[112:115], v3 offset:9216
    v_accvgpr_read_b32 v18, a112
    v_mfma_f32_16x16x32_bf16 a[172:175], a[4:7], v[108:111], a[172:175]
    ds_read_b128 v[144:147], v3 offset:10240
    v_accvgpr_read_b32 v19, a113
    v_mfma_f32_16x16x32_bf16 a[176:179], a[4:7], v[104:107], a[176:179]
    ds_read_b128 v[148:151], v3 offset:11264
    v_cvt_pk_bf16_f32 v14, v18, v19
    v_mfma_f32_16x16x32_bf16 a[180:183], a[4:7], v[196:199], a[180:183]
    ds_read_b128 v[152:155], v3 offset:12288
    v_accvgpr_read_b32 v20, a114
    v_mfma_f32_16x16x32_bf16 a[184:187], a[4:7], v[84:87], a[184:187]
    ds_read_b128 v[176:179], v3 offset:13312
    v_accvgpr_read_b32 v21, a115
    v_mfma_f32_16x16x32_bf16 a[188:191], a[4:7], v[124:127], a[188:191]
    buffer_load_dwordx4 a[108:111], v254, s[64:67], s53 offen offset:2048 sc1
    v_cvt_pk_bf16_f32 v15, v20, v21
    v_mfma_f32_16x16x32_bf16 a[192:195], a[4:7], v[128:131], a[192:195]
    buffer_load_dwordx4 a[0:3], v254, s[64:67], s53 offen offset:3072 sc1
    v_accvgpr_read_b32 v18, a116
    s_waitcnt vmcnt(39)
    v_mfma_f32_16x16x32_bf16 a[196:199], a[8:11], v[212:215], a[196:199]
    buffer_load_dwordx4 a[112:115], v1, s[64:67], s53 offen offset:0 sc1
    v_accvgpr_read_b32 v19, a117
    v_mfma_f32_16x16x32_bf16 a[200:203], a[8:11], v[108:111], a[200:203]
    v_cvt_pk_bf16_f32 v16, v18, v19
    v_accvgpr_read_b32 v20, a118
    v_mfma_f32_16x16x32_bf16 a[204:207], a[8:11], v[104:107], a[204:207]
    v_accvgpr_read_b32 v21, a119
    v_cvt_pk_bf16_f32 v17, v20, v21
    v_mfma_f32_16x16x32_bf16 a[208:211], a[8:11], v[196:199], a[208:211]
    s_mov_b32 s40, 14336
    buffer_store_dwordx4 v[14:17], v254, s[20:23], s40 offen sc1
    v_mfma_f32_16x16x32_bf16 a[212:215], a[8:11], v[84:87], a[212:215]
    v_accvgpr_read_b32 v18, a120
    v_accvgpr_read_b32 v19, a121
    v_mfma_f32_16x16x32_bf16 a[216:219], a[8:11], v[124:127], a[216:219]
    v_cvt_pk_bf16_f32 v6, v18, v19
    v_accvgpr_read_b32 v20, a122
    v_mfma_f32_16x16x32_bf16 a[220:223], a[8:11], v[128:131], a[220:223]
    v_accvgpr_read_b32 v21, a123
    v_cvt_pk_bf16_f32 v7, v20, v21
    s_waitcnt vmcnt(39)
    v_mfma_f32_16x16x32_bf16 a[224:227], a[12:15], v[212:215], a[224:227]
    buffer_load_dwordx4 a[4:7], v254, s[64:67], s54 offen offset:0 sc1
    v_accvgpr_read_b32 v18, a124
    v_mfma_f32_16x16x32_bf16 a[228:231], a[12:15], v[108:111], a[228:231]
    v_accvgpr_read_b32 v19, a125
    v_cvt_pk_bf16_f32 v8, v18, v19
    v_mfma_f32_16x16x32_bf16 a[232:235], a[12:15], v[104:107], a[232:235]
    v_accvgpr_read_b32 v20, a126
    v_accvgpr_read_b32 v21, a127
    v_mfma_f32_16x16x32_bf16 a[236:239], a[12:15], v[196:199], a[236:239]
    v_cvt_pk_bf16_f32 v9, v20, v21
    s_mov_b32 s40, 15360
    v_mfma_f32_16x16x32_bf16 a[240:243], a[12:15], v[84:87], a[240:243]
    buffer_store_dwordx4 v[6:9], v254, s[20:23], s40 offen sc1
    v_accvgpr_read_b32 v18, a128
    v_mfma_f32_16x16x32_bf16 a[244:247], a[12:15], v[124:127], a[244:247]
    v_accvgpr_read_b32 v19, a129
    v_cvt_pk_bf16_f32 v10, v18, v19
    v_mfma_f32_16x16x32_bf16 a[248:251], a[12:15], v[128:131], a[248:251]
    v_accvgpr_read_b32 v20, a130
    v_accvgpr_read_b32 v21, a131
    s_waitcnt vmcnt(40)
    v_mfma_f32_16x16x32_bf16 a[252:255], a[16:19], v[212:215], a[252:255]
    v_cvt_pk_bf16_f32 v11, v20, v21
    v_accvgpr_read_b32 v18, a132
    v_mfma_f32_16x16x32_bf16 v[228:231], a[16:19], v[108:111], v[228:231]
    v_accvgpr_read_b32 v19, a133
    v_cvt_pk_bf16_f32 v12, v18, v19
    v_mfma_f32_16x16x32_bf16 v[232:235], a[16:19], v[104:107], v[232:235]
    v_accvgpr_read_b32 v20, a134
    v_accvgpr_read_b32 v21, a135
    v_mfma_f32_16x16x32_bf16 v[236:239], a[16:19], v[196:199], v[236:239]
    v_cvt_pk_bf16_f32 v13, v20, v21
    s_mov_b32 s40, 16384
    v_mfma_f32_16x16x32_bf16 v[240:243], a[16:19], v[84:87], v[240:243]
    buffer_store_dwordx4 v[10:13], v254, s[20:23], s40 offen sc1
    v_accvgpr_read_b32 v18, a136
    v_mfma_f32_16x16x32_bf16 v[244:247], a[16:19], v[124:127], v[244:247]
    v_accvgpr_read_b32 v19, a137
    v_cvt_pk_bf16_f32 v14, v18, v19
    v_mfma_f32_16x16x32_bf16 v[248:251], a[16:19], v[128:131], v[248:251]
    v_accvgpr_read_b32 v20, a138
    v_accvgpr_read_b32 v21, a139
    s_waitcnt vmcnt(39)
    s_waitcnt lgkmcnt(6)
    v_mfma_f32_16x16x32_bf16 a[140:143], a[20:23], v[132:135], a[140:143]
    buffer_load_dwordx4 a[116:119], v254, s[64:67], s54 offen offset:1024 sc1
    v_cvt_pk_bf16_f32 v15, v20, v21
    s_waitcnt lgkmcnt(5)
    v_mfma_f32_16x16x32_bf16 a[144:147], a[20:23], v[216:219], a[144:147]
    s_mov_b32 s40, 17408
    buffer_store_dwordx2 v[14:15], v22, s[20:23], s40 offen sc1
    s_waitcnt lgkmcnt(4)
    v_mfma_f32_16x16x32_bf16 a[148:151], a[20:23], v[112:115], a[148:151]
    s_waitcnt lgkmcnt(3)
    v_mfma_f32_16x16x32_bf16 a[152:155], a[20:23], v[144:147], a[152:155]
    s_waitcnt lgkmcnt(2)
    v_mfma_f32_16x16x32_bf16 a[156:159], a[20:23], v[148:151], a[156:159]
    s_waitcnt lgkmcnt(1)
    v_mfma_f32_16x16x32_bf16 a[160:163], a[20:23], v[152:155], a[160:163]
    ds_read_b128 v[52:55], v3 offset:14336
    s_waitcnt lgkmcnt(1)
    v_mfma_f32_16x16x32_bf16 a[164:167], a[20:23], v[176:179], a[164:167]
    ds_read_b128 v[48:51], v3 offset:15360
    s_waitcnt vmcnt(40)
    v_mfma_f32_16x16x32_bf16 a[168:171], a[24:27], v[132:135], a[168:171]
    ds_read_b128 v[140:143], v3 offset:16384
    v_mfma_f32_16x16x32_bf16 a[172:175], a[24:27], v[216:219], a[172:175]
    ds_read_b128 v[28:31], v3 offset:17408
    v_mfma_f32_16x16x32_bf16 a[176:179], a[24:27], v[112:115], a[176:179]
    ds_read_b128 v[220:223], v3 offset:18432
    v_mfma_f32_16x16x32_bf16 a[180:183], a[24:27], v[144:147], a[180:183]
    ds_read_b128 v[180:183], v3 offset:19456
    v_mfma_f32_16x16x32_bf16 a[184:187], a[24:27], v[148:151], a[184:187]
    ds_read_b128 v[136:139], v3 offset:20480
    v_mfma_f32_16x16x32_bf16 a[188:191], a[24:27], v[152:155], a[188:191]
    v_mfma_f32_16x16x32_bf16 a[192:195], a[24:27], v[176:179], a[192:195]
    s_waitcnt vmcnt(39)
    v_mfma_f32_16x16x32_bf16 a[196:199], a[28:31], v[132:135], a[196:199]
    buffer_load_dwordx4 a[8:11], v254, s[64:67], s54 offen offset:2048 sc1
    v_mfma_f32_16x16x32_bf16 a[200:203], a[28:31], v[216:219], a[200:203]
    v_mfma_f32_16x16x32_bf16 a[204:207], a[28:31], v[112:115], a[204:207]
    v_mfma_f32_16x16x32_bf16 a[208:211], a[28:31], v[144:147], a[208:211]
    v_mfma_f32_16x16x32_bf16 a[212:215], a[28:31], v[148:151], a[212:215]
    v_mfma_f32_16x16x32_bf16 a[216:219], a[28:31], v[152:155], a[216:219]
    v_mfma_f32_16x16x32_bf16 a[220:223], a[28:31], v[176:179], a[220:223]
    s_waitcnt vmcnt(38)
    v_mfma_f32_16x16x32_bf16 a[224:227], a[32:35], v[132:135], a[224:227]
    buffer_load_dwordx4 a[120:123], v254, s[64:67], s54 offen offset:3072 sc1
    v_mfma_f32_16x16x32_bf16 a[228:231], a[32:35], v[216:219], a[228:231]
    buffer_load_dwordx4 a[124:127], v1, s[64:67], s54 offen offset:0 sc1
    v_mfma_f32_16x16x32_bf16 a[232:235], a[32:35], v[112:115], a[232:235]
    v_mfma_f32_16x16x32_bf16 a[236:239], a[32:35], v[144:147], a[236:239]
    v_mfma_f32_16x16x32_bf16 a[240:243], a[32:35], v[148:151], a[240:243]
    v_mfma_f32_16x16x32_bf16 a[244:247], a[32:35], v[152:155], a[244:247]
    v_mfma_f32_16x16x32_bf16 a[248:251], a[32:35], v[176:179], a[248:251]
    s_waitcnt vmcnt(39)
    v_mfma_f32_16x16x32_bf16 a[252:255], a[36:39], v[132:135], a[252:255]
    buffer_load_dwordx4 a[12:15], v254, s[64:67], s55 offen offset:0 sc1
    v_mfma_f32_16x16x32_bf16 v[228:231], a[36:39], v[216:219], v[228:231]
    v_mfma_f32_16x16x32_bf16 v[232:235], a[36:39], v[112:115], v[232:235]
    v_mfma_f32_16x16x32_bf16 v[236:239], a[36:39], v[144:147], v[236:239]
    v_mfma_f32_16x16x32_bf16 v[240:243], a[36:39], v[148:151], v[240:243]
    v_mfma_f32_16x16x32_bf16 v[244:247], a[36:39], v[152:155], v[244:247]
    v_mfma_f32_16x16x32_bf16 v[248:251], a[36:39], v[176:179], v[248:251]
    s_waitcnt vmcnt(38)
    s_waitcnt lgkmcnt(6)
    v_mfma_f32_16x16x32_bf16 a[140:143], a[40:43], v[52:55], a[140:143]
    buffer_load_dwordx4 a[128:131], v254, s[64:67], s55 offen offset:1024 sc1
    s_waitcnt lgkmcnt(5)
    v_mfma_f32_16x16x32_bf16 a[144:147], a[40:43], v[48:51], a[144:147]
    buffer_load_dwordx4 a[132:135], v254, s[64:67], s55 offen offset:2048 sc1
    s_waitcnt lgkmcnt(4)
    v_mfma_f32_16x16x32_bf16 a[148:151], a[40:43], v[140:143], a[148:151]
    s_waitcnt lgkmcnt(3)
    v_mfma_f32_16x16x32_bf16 a[152:155], a[40:43], v[28:31], a[152:155]
    s_waitcnt lgkmcnt(2)
    v_mfma_f32_16x16x32_bf16 a[156:159], a[40:43], v[220:223], a[156:159]
    s_waitcnt lgkmcnt(1)
    v_mfma_f32_16x16x32_bf16 a[160:163], a[40:43], v[180:183], a[160:163]
    ds_read_b128 v[24:27], v3 offset:21504
    s_waitcnt lgkmcnt(1)
    v_mfma_f32_16x16x32_bf16 a[164:167], a[40:43], v[136:139], a[164:167]
    ds_read_b128 v[116:119], v3 offset:22528
    s_waitcnt vmcnt(39)
    v_mfma_f32_16x16x32_bf16 a[168:171], a[44:47], v[52:55], a[168:171]
    ds_read_b128 v[120:123], v3 offset:23552
    v_mfma_f32_16x16x32_bf16 a[172:175], a[44:47], v[48:51], a[172:175]
    ds_read_b128 v[172:175], v3 offset:24576
    v_mfma_f32_16x16x32_bf16 a[176:179], a[44:47], v[140:143], a[176:179]
    ds_read_b128 v[40:43], v3 offset:25600
    v_mfma_f32_16x16x32_bf16 a[180:183], a[44:47], v[28:31], a[180:183]
    ds_read_b128 v[224:227], v3 offset:26624
    v_mfma_f32_16x16x32_bf16 a[184:187], a[44:47], v[220:223], a[184:187]
    ds_read_b128 v[44:47], v3 offset:27648
    v_mfma_f32_16x16x32_bf16 a[188:191], a[44:47], v[180:183], a[188:191]
    buffer_load_dwordx4 a[16:19], v254, s[64:67], s55 offen offset:3072 sc1
    v_mfma_f32_16x16x32_bf16 a[192:195], a[44:47], v[136:139], a[192:195]
    s_waitcnt vmcnt(38)
    v_mfma_f32_16x16x32_bf16 a[196:199], a[48:51], v[52:55], a[196:199]
    buffer_load_dwordx4 a[136:139], v1, s[64:67], s55 offen offset:0 sc1
    v_mfma_f32_16x16x32_bf16 a[200:203], a[48:51], v[48:51], a[200:203]
    s_add_u32 s37, s3, 3
    s_and_b32 s37, s37, 3
    s_mul_i32 s52, s37, 20480
    s_add_u32 s52, s52, 655360
    s_add_u32 s53, s52, 5120
    s_add_u32 s54, s52, 10240
    s_add_u32 s55, s52, 15360
    buffer_load_dwordx4 a[20:23], v254, s[64:67], s52 offen offset:0 sc1
    v_mfma_f32_16x16x32_bf16 a[204:207], a[48:51], v[140:143], a[204:207]
    v_mfma_f32_16x16x32_bf16 a[208:211], a[48:51], v[28:31], a[208:211]
    v_mfma_f32_16x16x32_bf16 a[212:215], a[48:51], v[220:223], a[212:215]
    v_mfma_f32_16x16x32_bf16 a[216:219], a[48:51], v[180:183], a[216:219]
    v_mfma_f32_16x16x32_bf16 a[220:223], a[48:51], v[136:139], a[220:223]
    s_waitcnt vmcnt(39)
    v_mfma_f32_16x16x32_bf16 a[224:227], a[52:55], v[52:55], a[224:227]
    buffer_load_dwordx4 a[24:27], v254, s[64:67], s53 offen offset:0 sc1
    v_mfma_f32_16x16x32_bf16 a[228:231], a[52:55], v[48:51], a[228:231]
    v_mfma_f32_16x16x32_bf16 a[232:235], a[52:55], v[140:143], a[232:235]
    v_mfma_f32_16x16x32_bf16 a[236:239], a[52:55], v[28:31], a[236:239]
    v_mfma_f32_16x16x32_bf16 a[240:243], a[52:55], v[220:223], a[240:243]
    v_mfma_f32_16x16x32_bf16 a[244:247], a[52:55], v[180:183], a[244:247]
    v_mfma_f32_16x16x32_bf16 a[248:251], a[52:55], v[136:139], a[248:251]
    s_waitcnt vmcnt(38)
    v_mfma_f32_16x16x32_bf16 a[252:255], a[56:59], v[52:55], a[252:255]
    buffer_load_dwordx4 a[28:31], v254, s[64:67], s54 offen offset:0 sc1
    v_mfma_f32_16x16x32_bf16 v[228:231], a[56:59], v[48:51], v[228:231]
    buffer_load_dwordx4 a[32:35], v254, s[64:67], s55 offen offset:0 sc1
    v_mfma_f32_16x16x32_bf16 v[232:235], a[56:59], v[140:143], v[232:235]
    v_mfma_f32_16x16x32_bf16 v[236:239], a[56:59], v[28:31], v[236:239]
    v_mfma_f32_16x16x32_bf16 v[240:243], a[56:59], v[220:223], v[240:243]
    v_mfma_f32_16x16x32_bf16 v[244:247], a[56:59], v[180:183], v[244:247]
    v_mfma_f32_16x16x32_bf16 v[248:251], a[56:59], v[136:139], v[248:251]
    s_waitcnt vmcnt(39)
    s_waitcnt lgkmcnt(6)
    v_mfma_f32_16x16x32_bf16 a[140:143], a[60:63], v[24:27], a[140:143]
    buffer_load_dwordx4 a[36:39], v254, s[64:67], s52 offen offset:1024 sc1
    s_waitcnt lgkmcnt(5)
    v_mfma_f32_16x16x32_bf16 a[144:147], a[60:63], v[116:119], a[144:147]
    s_waitcnt lgkmcnt(4)
    v_mfma_f32_16x16x32_bf16 a[148:151], a[60:63], v[120:123], a[148:151]
    s_waitcnt lgkmcnt(3)
    v_mfma_f32_16x16x32_bf16 a[152:155], a[60:63], v[172:175], a[152:155]
    s_waitcnt lgkmcnt(2)
    v_mfma_f32_16x16x32_bf16 a[156:159], a[60:63], v[40:43], a[156:159]
    s_waitcnt lgkmcnt(1)
    v_mfma_f32_16x16x32_bf16 a[160:163], a[60:63], v[224:227], a[160:163]
    ds_read_b128 v[164:167], v4 offset:0
    s_waitcnt lgkmcnt(1)
    v_mfma_f32_16x16x32_bf16 a[164:167], a[60:63], v[44:47], a[164:167]
    ds_read_b128 v[184:187], v4 offset:1024
    s_waitcnt vmcnt(38)
    v_mfma_f32_16x16x32_bf16 a[168:171], a[64:67], v[24:27], a[168:171]
    ds_read_b128 v[188:191], v4 offset:2048
    v_mfma_f32_16x16x32_bf16 a[172:175], a[64:67], v[116:119], a[172:175]
    ds_read_b128 v[32:35], v4 offset:3072
    v_mfma_f32_16x16x32_bf16 a[176:179], a[64:67], v[120:123], a[176:179]
    ds_read_b128 v[36:39], v4 offset:4096
    v_mfma_f32_16x16x32_bf16 a[180:183], a[64:67], v[172:175], a[180:183]
    ds_read_b128 v[156:159], v4 offset:5120
    v_mfma_f32_16x16x32_bf16 a[184:187], a[64:67], v[40:43], a[184:187]
    ds_read_b128 v[168:171], v4 offset:6144
    v_mfma_f32_16x16x32_bf16 a[188:191], a[64:67], v[224:227], a[188:191]
    buffer_load_dwordx4 a[40:43], v254, s[64:67], s53 offen offset:1024 sc1
    v_mfma_f32_16x16x32_bf16 a[192:195], a[64:67], v[44:47], a[192:195]
    buffer_load_dwordx4 a[44:47], v254, s[64:67], s54 offen offset:1024 sc1
    s_waitcnt vmcnt(39)
    v_mfma_f32_16x16x32_bf16 a[196:199], a[68:71], v[24:27], a[196:199]
    buffer_load_dwordx4 a[48:51], v254, s[64:67], s55 offen offset:1024 sc1
    v_mfma_f32_16x16x32_bf16 a[200:203], a[68:71], v[116:119], a[200:203]
    v_mfma_f32_16x16x32_bf16 a[204:207], a[68:71], v[120:123], a[204:207]
    v_mfma_f32_16x16x32_bf16 a[208:211], a[68:71], v[172:175], a[208:211]
    v_mfma_f32_16x16x32_bf16 a[212:215], a[68:71], v[40:43], a[212:215]
    v_mfma_f32_16x16x32_bf16 a[216:219], a[68:71], v[224:227], a[216:219]
    v_mfma_f32_16x16x32_bf16 a[220:223], a[68:71], v[44:47], a[220:223]
    s_waitcnt vmcnt(38)
    v_mfma_f32_16x16x32_bf16 a[224:227], a[72:75], v[24:27], a[224:227]
    buffer_load_dwordx4 a[52:55], v254, s[64:67], s52 offen offset:2048 sc1
    v_mfma_f32_16x16x32_bf16 a[228:231], a[72:75], v[116:119], a[228:231]
    buffer_load_dwordx4 a[56:59], v254, s[64:67], s53 offen offset:2048 sc1
    v_mfma_f32_16x16x32_bf16 a[232:235], a[72:75], v[120:123], a[232:235]
    v_mfma_f32_16x16x32_bf16 a[236:239], a[72:75], v[172:175], a[236:239]
    v_mfma_f32_16x16x32_bf16 a[240:243], a[72:75], v[40:43], a[240:243]
    v_mfma_f32_16x16x32_bf16 a[244:247], a[72:75], v[224:227], a[244:247]
    v_mfma_f32_16x16x32_bf16 a[248:251], a[72:75], v[44:47], a[248:251]
    s_waitcnt vmcnt(38)
    v_mfma_f32_16x16x32_bf16 a[252:255], a[76:79], v[24:27], a[252:255]
    buffer_load_dwordx4 a[60:63], v254, s[64:67], s54 offen offset:2048 sc1
    v_mfma_f32_16x16x32_bf16 v[228:231], a[76:79], v[116:119], v[228:231]
    buffer_load_dwordx4 a[64:67], v254, s[64:67], s55 offen offset:2048 sc1
    v_mfma_f32_16x16x32_bf16 v[232:235], a[76:79], v[120:123], v[232:235]
    v_mfma_f32_16x16x32_bf16 v[236:239], a[76:79], v[172:175], v[236:239]
    v_mfma_f32_16x16x32_bf16 v[240:243], a[76:79], v[40:43], v[240:243]
    v_mfma_f32_16x16x32_bf16 v[244:247], a[76:79], v[224:227], v[244:247]
    v_mfma_f32_16x16x32_bf16 v[248:251], a[76:79], v[44:47], v[248:251]
    s_waitcnt vmcnt(39)
    s_waitcnt lgkmcnt(6)
    v_mfma_f32_16x16x32_bf16 a[140:143], a[80:83], v[164:167], a[140:143]
    buffer_load_dwordx4 a[68:71], v254, s[64:67], s52 offen offset:3072 sc1
    s_waitcnt lgkmcnt(5)
    v_mfma_f32_16x16x32_bf16 a[144:147], a[80:83], v[184:187], a[144:147]
    s_waitcnt lgkmcnt(4)
    v_mfma_f32_16x16x32_bf16 a[148:151], a[80:83], v[188:191], a[148:151]
    s_waitcnt lgkmcnt(3)
    v_mfma_f32_16x16x32_bf16 a[152:155], a[80:83], v[32:35], a[152:155]
    s_waitcnt lgkmcnt(2)
    v_mfma_f32_16x16x32_bf16 a[156:159], a[80:83], v[36:39], a[156:159]
    s_waitcnt lgkmcnt(1)
    v_mfma_f32_16x16x32_bf16 a[160:163], a[80:83], v[156:159], a[160:163]
    ds_read_b128 v[68:71], v4 offset:7168
    s_waitcnt lgkmcnt(1)
    v_mfma_f32_16x16x32_bf16 a[164:167], a[80:83], v[168:171], a[164:167]
    ds_read_b128 v[72:75], v4 offset:8192
    s_waitcnt vmcnt(38)
    v_mfma_f32_16x16x32_bf16 a[168:171], a[84:87], v[164:167], a[168:171]
    ds_read_b128 v[200:203], v4 offset:9216
    v_mfma_f32_16x16x32_bf16 a[172:175], a[84:87], v[184:187], a[172:175]
    ds_read_b128 v[204:207], v4 offset:10240
    v_mfma_f32_16x16x32_bf16 a[176:179], a[84:87], v[188:191], a[176:179]
    ds_read_b128 v[208:211], v4 offset:11264
    v_mfma_f32_16x16x32_bf16 a[180:183], a[84:87], v[32:35], a[180:183]
    ds_read_b128 v[60:63], v4 offset:12288
    v_mfma_f32_16x16x32_bf16 a[184:187], a[84:87], v[36:39], a[184:187]
    ds_read_b128 v[64:67], v4 offset:13312
    v_mfma_f32_16x16x32_bf16 a[188:191], a[84:87], v[156:159], a[188:191]
    buffer_load_dwordx4 a[72:75], v254, s[64:67], s53 offen offset:3072 sc1
    v_mfma_f32_16x16x32_bf16 a[192:195], a[84:87], v[168:171], a[192:195]
    buffer_load_dwordx4 a[76:79], v254, s[64:67], s54 offen offset:3072 sc1
    s_waitcnt vmcnt(39)
    v_mfma_f32_16x16x32_bf16 a[196:199], a[88:91], v[164:167], a[196:199]
    buffer_load_dwordx4 a[80:83], v254, s[64:67], s55 offen offset:3072 sc1
    v_mfma_f32_16x16x32_bf16 a[200:203], a[88:91], v[184:187], a[200:203]
    v_mfma_f32_16x16x32_bf16 a[204:207], a[88:91], v[188:191], a[204:207]
    v_mfma_f32_16x16x32_bf16 a[208:211], a[88:91], v[32:35], a[208:211]
    v_mfma_f32_16x16x32_bf16 a[212:215], a[88:91], v[36:39], a[212:215]
    v_mfma_f32_16x16x32_bf16 a[216:219], a[88:91], v[156:159], a[216:219]
    v_mfma_f32_16x16x32_bf16 a[220:223], a[88:91], v[168:171], a[220:223]
    s_waitcnt vmcnt(38)
    v_mfma_f32_16x16x32_bf16 a[224:227], a[92:95], v[164:167], a[224:227]
    buffer_load_dwordx4 a[84:87], v1, s[64:67], s52 offen offset:0 sc1
    v_mfma_f32_16x16x32_bf16 a[228:231], a[92:95], v[184:187], a[228:231]
    buffer_load_dwordx4 a[88:91], v1, s[64:67], s53 offen offset:0 sc1
    v_mfma_f32_16x16x32_bf16 a[232:235], a[92:95], v[188:191], a[232:235]
    v_mfma_f32_16x16x32_bf16 a[236:239], a[92:95], v[32:35], a[236:239]
    v_mfma_f32_16x16x32_bf16 a[240:243], a[92:95], v[36:39], a[240:243]
    v_mfma_f32_16x16x32_bf16 a[244:247], a[92:95], v[156:159], a[244:247]
    v_mfma_f32_16x16x32_bf16 a[248:251], a[92:95], v[168:171], a[248:251]
    s_waitcnt vmcnt(39)
    v_mfma_f32_16x16x32_bf16 a[252:255], a[96:99], v[164:167], a[252:255]
    buffer_load_dwordx4 a[92:95], v1, s[64:67], s54 offen offset:0 sc1
    v_mfma_f32_16x16x32_bf16 v[228:231], a[96:99], v[184:187], v[228:231]
    v_mfma_f32_16x16x32_bf16 v[232:235], a[96:99], v[188:191], v[232:235]
    v_mfma_f32_16x16x32_bf16 v[236:239], a[96:99], v[32:35], v[236:239]
    v_mfma_f32_16x16x32_bf16 v[240:243], a[96:99], v[36:39], v[240:243]
    v_mfma_f32_16x16x32_bf16 v[244:247], a[96:99], v[156:159], v[244:247]
    v_mfma_f32_16x16x32_bf16 v[248:251], a[96:99], v[168:171], v[248:251]
    s_waitcnt vmcnt(38)
    s_waitcnt lgkmcnt(6)
    v_mfma_f32_16x16x32_bf16 a[140:143], a[100:103], v[68:71], a[140:143]
    buffer_load_dwordx4 a[96:99], v1, s[64:67], s55 offen offset:0 sc1
    s_waitcnt lgkmcnt(5)
    v_mfma_f32_16x16x32_bf16 a[144:147], a[100:103], v[72:75], a[144:147]
    s_waitcnt lgkmcnt(4)
    v_mfma_f32_16x16x32_bf16 a[148:151], a[100:103], v[200:203], a[148:151]
    s_waitcnt lgkmcnt(3)
    v_mfma_f32_16x16x32_bf16 a[152:155], a[100:103], v[204:207], a[152:155]
    s_waitcnt lgkmcnt(2)
    v_mfma_f32_16x16x32_bf16 a[156:159], a[100:103], v[208:211], a[156:159]
    s_waitcnt lgkmcnt(1)
    v_mfma_f32_16x16x32_bf16 a[160:163], a[100:103], v[60:63], a[160:163]
    ds_read_b128 v[88:91], v4 offset:14336
    s_waitcnt lgkmcnt(1)
    v_mfma_f32_16x16x32_bf16 a[164:167], a[100:103], v[64:67], a[164:167]
    ds_read_b128 v[192:195], v4 offset:15360
    s_waitcnt vmcnt(38)
    v_mfma_f32_16x16x32_bf16 a[168:171], a[104:107], v[68:71], a[168:171]
    ds_read_b128 v[80:83], v4 offset:16384
    v_mfma_f32_16x16x32_bf16 a[172:175], a[104:107], v[72:75], a[172:175]
    ds_read_b128 v[76:79], v4 offset:17408
    v_mfma_f32_16x16x32_bf16 a[176:179], a[104:107], v[200:203], a[176:179]
    ds_read_b128 v[160:163], v4 offset:18432
    v_mfma_f32_16x16x32_bf16 a[180:183], a[104:107], v[204:207], a[180:183]
    ds_read_b128 v[56:59], v4 offset:19456
    v_mfma_f32_16x16x32_bf16 a[184:187], a[104:107], v[208:211], a[184:187]
    ds_read_b128 v[96:99], v4 offset:20480
    v_mfma_f32_16x16x32_bf16 a[188:191], a[104:107], v[60:63], a[188:191]
    v_mfma_f32_16x16x32_bf16 a[192:195], a[104:107], v[64:67], a[192:195]
    s_waitcnt vmcnt(36)
    v_mfma_f32_16x16x32_bf16 a[196:199], a[108:111], v[68:71], a[196:199]
    v_mfma_f32_16x16x32_bf16 a[200:203], a[108:111], v[72:75], a[200:203]
    v_mfma_f32_16x16x32_bf16 a[204:207], a[108:111], v[200:203], a[204:207]
    v_mfma_f32_16x16x32_bf16 a[208:211], a[108:111], v[204:207], a[208:211]
    v_mfma_f32_16x16x32_bf16 a[212:215], a[108:111], v[208:211], a[212:215]
    v_mfma_f32_16x16x32_bf16 a[216:219], a[108:111], v[60:63], a[216:219]
    v_mfma_f32_16x16x32_bf16 a[220:223], a[108:111], v[64:67], a[220:223]
    s_waitcnt vmcnt(35)
    v_mfma_f32_16x16x32_bf16 a[224:227], a[0:3], v[68:71], a[224:227]
    v_mfma_f32_16x16x32_bf16 a[228:231], a[0:3], v[72:75], a[228:231]
    v_mfma_f32_16x16x32_bf16 a[232:235], a[0:3], v[200:203], a[232:235]
    v_mfma_f32_16x16x32_bf16 a[236:239], a[0:3], v[204:207], a[236:239]
    v_mfma_f32_16x16x32_bf16 a[240:243], a[0:3], v[208:211], a[240:243]
    v_mfma_f32_16x16x32_bf16 a[244:247], a[0:3], v[60:63], a[244:247]
    v_mfma_f32_16x16x32_bf16 a[248:251], a[0:3], v[64:67], a[248:251]
    s_waitcnt vmcnt(34)
    v_mfma_f32_16x16x32_bf16 a[252:255], a[112:115], v[68:71], a[252:255]
    v_mfma_f32_16x16x32_bf16 v[228:231], a[112:115], v[72:75], v[228:231]
    v_mfma_f32_16x16x32_bf16 v[232:235], a[112:115], v[200:203], v[232:235]
    v_mfma_f32_16x16x32_bf16 v[236:239], a[112:115], v[204:207], v[236:239]
    v_mfma_f32_16x16x32_bf16 v[240:243], a[112:115], v[208:211], v[240:243]
    v_mfma_f32_16x16x32_bf16 v[244:247], a[112:115], v[60:63], v[244:247]
    v_mfma_f32_16x16x32_bf16 v[248:251], a[112:115], v[64:67], v[248:251]
    s_waitcnt vmcnt(32)
    s_waitcnt lgkmcnt(6)
    v_mfma_f32_16x16x32_bf16 a[140:143], a[4:7], v[88:91], a[140:143]
    s_waitcnt lgkmcnt(5)
    v_mfma_f32_16x16x32_bf16 a[144:147], a[4:7], v[192:195], a[144:147]
    s_waitcnt lgkmcnt(4)
    v_mfma_f32_16x16x32_bf16 a[148:151], a[4:7], v[80:83], a[148:151]
    s_waitcnt lgkmcnt(3)
    v_mfma_f32_16x16x32_bf16 a[152:155], a[4:7], v[76:79], a[152:155]
    s_waitcnt lgkmcnt(2)
    v_mfma_f32_16x16x32_bf16 a[156:159], a[4:7], v[160:163], a[156:159]
    s_waitcnt lgkmcnt(1)
    v_mfma_f32_16x16x32_bf16 a[160:163], a[4:7], v[56:59], a[160:163]
    ds_read_b128 v[100:103], v4 offset:21504
    s_waitcnt lgkmcnt(1)
    v_mfma_f32_16x16x32_bf16 a[164:167], a[4:7], v[96:99], a[164:167]
    ds_read_b128 v[92:95], v4 offset:22528
    s_waitcnt vmcnt(29)
    v_mfma_f32_16x16x32_bf16 a[168:171], a[116:119], v[88:91], a[168:171]
    ds_read_b128 v[212:215], v4 offset:23552
    v_mfma_f32_16x16x32_bf16 a[172:175], a[116:119], v[192:195], a[172:175]
    ds_read_b128 v[108:111], v4 offset:24576
    v_mfma_f32_16x16x32_bf16 a[176:179], a[116:119], v[80:83], a[176:179]
    ds_read_b128 v[104:107], v4 offset:25600
    v_mfma_f32_16x16x32_bf16 a[180:183], a[116:119], v[76:79], a[180:183]
    ds_read_b128 v[196:199], v4 offset:26624
    v_mfma_f32_16x16x32_bf16 a[184:187], a[116:119], v[160:163], a[184:187]
    ds_read_b128 v[84:87], v4 offset:27648
    v_mfma_f32_16x16x32_bf16 a[188:191], a[116:119], v[56:59], a[188:191]
    v_mfma_f32_16x16x32_bf16 a[192:195], a[116:119], v[96:99], a[192:195]
    s_waitcnt vmcnt(27)
    v_mfma_f32_16x16x32_bf16 a[196:199], a[8:11], v[88:91], a[196:199]
    v_mfma_f32_16x16x32_bf16 a[200:203], a[8:11], v[192:195], a[200:203]
    v_mfma_f32_16x16x32_bf16 a[204:207], a[8:11], v[80:83], a[204:207]
    v_mfma_f32_16x16x32_bf16 a[208:211], a[8:11], v[76:79], a[208:211]
    v_mfma_f32_16x16x32_bf16 a[212:215], a[8:11], v[160:163], a[212:215]
    v_mfma_f32_16x16x32_bf16 a[216:219], a[8:11], v[56:59], a[216:219]
    v_mfma_f32_16x16x32_bf16 a[220:223], a[8:11], v[96:99], a[220:223]
    s_waitcnt vmcnt(26)
    v_mfma_f32_16x16x32_bf16 a[224:227], a[120:123], v[88:91], a[224:227]
    v_mfma_f32_16x16x32_bf16 a[228:231], a[120:123], v[192:195], a[228:231]
    v_mfma_f32_16x16x32_bf16 a[232:235], a[120:123], v[80:83], a[232:235]
    v_mfma_f32_16x16x32_bf16 a[236:239], a[120:123], v[76:79], a[236:239]
    v_mfma_f32_16x16x32_bf16 a[240:243], a[120:123], v[160:163], a[240:243]
    v_mfma_f32_16x16x32_bf16 a[244:247], a[120:123], v[56:59], a[244:247]
    v_mfma_f32_16x16x32_bf16 a[248:251], a[120:123], v[96:99], a[248:251]
    v_mov_b32 v253, 1
    buffer_store_dword v253, v23, s[68:71], 0 offen offset:0 sc1
    s_waitcnt vmcnt(26)
    v_mfma_f32_16x16x32_bf16 a[252:255], a[124:127], v[88:91], a[252:255]
    v_mfma_f32_16x16x32_bf16 v[228:231], a[124:127], v[192:195], v[228:231]
    v_mfma_f32_16x16x32_bf16 v[232:235], a[124:127], v[80:83], v[232:235]
    v_mfma_f32_16x16x32_bf16 v[236:239], a[124:127], v[76:79], v[236:239]
    v_mfma_f32_16x16x32_bf16 v[240:243], a[124:127], v[160:163], v[240:243]
    v_mfma_f32_16x16x32_bf16 v[244:247], a[124:127], v[56:59], v[244:247]
    v_mfma_f32_16x16x32_bf16 v[248:251], a[124:127], v[96:99], v[248:251]
    s_waitcnt vmcnt(25)
    s_waitcnt lgkmcnt(6)
    v_mfma_f32_16x16x32_bf16 a[140:143], a[12:15], v[100:103], a[140:143]
    s_waitcnt lgkmcnt(5)
    v_mfma_f32_16x16x32_bf16 a[144:147], a[12:15], v[92:95], a[144:147]
    s_waitcnt lgkmcnt(4)
    v_mfma_f32_16x16x32_bf16 a[148:151], a[12:15], v[212:215], a[148:151]
    s_waitcnt lgkmcnt(3)
    v_mfma_f32_16x16x32_bf16 a[152:155], a[12:15], v[108:111], a[152:155]
    s_waitcnt lgkmcnt(2)
    v_mfma_f32_16x16x32_bf16 a[156:159], a[12:15], v[104:107], a[156:159]
    s_waitcnt lgkmcnt(1)
    v_mfma_f32_16x16x32_bf16 a[160:163], a[12:15], v[196:199], a[160:163]
    ds_read_b128 v[124:127], v5 offset:0
    s_waitcnt lgkmcnt(1)
    v_mfma_f32_16x16x32_bf16 a[164:167], a[12:15], v[84:87], a[164:167]
    ds_read_b128 v[128:131], v5 offset:1024
    s_waitcnt vmcnt(24)
    v_mfma_f32_16x16x32_bf16 a[168:171], a[128:131], v[100:103], a[168:171]
    ds_read_b128 v[132:135], v5 offset:2048
    v_mfma_f32_16x16x32_bf16 a[172:175], a[128:131], v[92:95], a[172:175]
    ds_read_b128 v[216:219], v5 offset:3072
    v_mfma_f32_16x16x32_bf16 a[176:179], a[128:131], v[212:215], a[176:179]
    ds_read_b128 v[112:115], v5 offset:4096
    v_mfma_f32_16x16x32_bf16 a[180:183], a[128:131], v[108:111], a[180:183]
    ds_read_b128 v[144:147], v5 offset:5120
    v_mfma_f32_16x16x32_bf16 a[184:187], a[128:131], v[104:107], a[184:187]
    ds_read_b128 v[148:151], v5 offset:6144
    v_mfma_f32_16x16x32_bf16 a[188:191], a[128:131], v[196:199], a[188:191]
    ds_read_b128 v[152:155], v5 offset:7168
    v_mfma_f32_16x16x32_bf16 a[192:195], a[128:131], v[84:87], a[192:195]
    ds_read_b128 v[176:179], v5 offset:8192
    s_waitcnt vmcnt(23)
    v_mfma_f32_16x16x32_bf16 a[196:199], a[132:135], v[100:103], a[196:199]
    ds_read_b128 v[52:55], v5 offset:9216
    v_mfma_f32_16x16x32_bf16 a[200:203], a[132:135], v[92:95], a[200:203]
    ds_read_b128 v[48:51], v5 offset:10240
    v_mfma_f32_16x16x32_bf16 a[204:207], a[132:135], v[212:215], a[204:207]
    ds_read_b128 v[140:143], v5 offset:11264
    v_mfma_f32_16x16x32_bf16 a[208:211], a[132:135], v[108:111], a[208:211]
    ds_read_b128 v[28:31], v5 offset:12288
    v_mfma_f32_16x16x32_bf16 a[212:215], a[132:135], v[104:107], a[212:215]
    ds_read_b128 v[220:223], v5 offset:13312
    v_mfma_f32_16x16x32_bf16 a[216:219], a[132:135], v[196:199], a[216:219]
    v_mfma_f32_16x16x32_bf16 a[220:223], a[132:135], v[84:87], a[220:223]
    s_waitcnt vmcnt(22)
    v_mfma_f32_16x16x32_bf16 a[224:227], a[16:19], v[100:103], a[224:227]
    v_mfma_f32_16x16x32_bf16 a[228:231], a[16:19], v[92:95], a[228:231]
    v_mfma_f32_16x16x32_bf16 a[232:235], a[16:19], v[212:215], a[232:235]
    v_mfma_f32_16x16x32_bf16 a[236:239], a[16:19], v[108:111], a[236:239]
    v_mfma_f32_16x16x32_bf16 a[240:243], a[16:19], v[104:107], a[240:243]
    v_mfma_f32_16x16x32_bf16 a[244:247], a[16:19], v[196:199], a[244:247]
    v_mfma_f32_16x16x32_bf16 a[248:251], a[16:19], v[84:87], a[248:251]
    s_waitcnt vmcnt(21)
    v_mfma_f32_16x16x32_bf16 a[252:255], a[136:139], v[100:103], a[252:255]
    v_mfma_f32_16x16x32_bf16 v[228:231], a[136:139], v[92:95], v[228:231]
    v_mfma_f32_16x16x32_bf16 v[232:235], a[136:139], v[212:215], v[232:235]
    v_mfma_f32_16x16x32_bf16 v[236:239], a[136:139], v[108:111], v[236:239]
    v_mfma_f32_16x16x32_bf16 v[240:243], a[136:139], v[104:107], v[240:243]
    v_mfma_f32_16x16x32_bf16 v[244:247], a[136:139], v[196:199], v[244:247]
    v_mfma_f32_16x16x32_bf16 v[248:251], a[136:139], v[84:87], v[248:251]
    s_waitcnt vmcnt(20)
    s_waitcnt lgkmcnt(13)
    v_mfma_f32_16x16x32_bf16 a[140:143], a[20:23], v[124:127], a[140:143]
    ds_read_b128 v[180:183], v5 offset:14336
    s_waitcnt lgkmcnt(13)
    v_mfma_f32_16x16x32_bf16 a[144:147], a[20:23], v[128:131], a[144:147]
    ds_read_b128 v[136:139], v5 offset:15360
    s_waitcnt lgkmcnt(13)
    v_mfma_f32_16x16x32_bf16 a[148:151], a[20:23], v[132:135], a[148:151]
    ds_read_b128 v[24:27], v5 offset:16384
    s_waitcnt lgkmcnt(13)
    v_mfma_f32_16x16x32_bf16 a[152:155], a[20:23], v[216:219], a[152:155]
    ds_read_b128 v[116:119], v5 offset:17408
    s_waitcnt lgkmcnt(13)
    v_mfma_f32_16x16x32_bf16 a[156:159], a[20:23], v[112:115], a[156:159]
    ds_read_b128 v[120:123], v5 offset:18432
    s_waitcnt lgkmcnt(13)
    v_mfma_f32_16x16x32_bf16 a[160:163], a[20:23], v[144:147], a[160:163]
    ds_read_b128 v[172:175], v5 offset:19456
    s_waitcnt lgkmcnt(13)
    v_mfma_f32_16x16x32_bf16 a[164:167], a[20:23], v[148:151], a[164:167]
    ds_read_b128 v[40:43], v5 offset:20480
    s_waitcnt vmcnt(19)
    s_waitcnt lgkmcnt(13)
    v_mfma_f32_16x16x32_bf16 a[140:143], a[24:27], v[152:155], a[140:143]
    ds_read_b128 v[224:227], v5 offset:21504
    s_waitcnt lgkmcnt(13)
    v_mfma_f32_16x16x32_bf16 a[144:147], a[24:27], v[176:179], a[144:147]
    ds_read_b128 v[44:47], v5 offset:22528
    s_waitcnt lgkmcnt(13)
    v_mfma_f32_16x16x32_bf16 a[148:151], a[24:27], v[52:55], a[148:151]
    ds_read_b128 v[164:167], v5 offset:23552
    s_waitcnt lgkmcnt(13)
    v_mfma_f32_16x16x32_bf16 a[152:155], a[24:27], v[48:51], a[152:155]
    ds_read_b128 v[184:187], v5 offset:24576
    s_waitcnt lgkmcnt(13)
    v_mfma_f32_16x16x32_bf16 a[156:159], a[24:27], v[140:143], a[156:159]
    ds_read_b128 v[188:191], v5 offset:25600
    s_waitcnt lgkmcnt(13)
    v_mfma_f32_16x16x32_bf16 a[160:163], a[24:27], v[28:31], a[160:163]
    ds_read_b128 v[32:35], v5 offset:26624
    s_waitcnt lgkmcnt(13)
    v_mfma_f32_16x16x32_bf16 a[164:167], a[24:27], v[220:223], a[164:167]
    ds_read_b128 v[36:39], v5 offset:27648
    s_waitcnt vmcnt(18)
    s_waitcnt lgkmcnt(13)
    v_mfma_f32_16x16x32_bf16 a[140:143], a[28:31], v[180:183], a[140:143]
    s_waitcnt lgkmcnt(12)
    v_mfma_f32_16x16x32_bf16 a[144:147], a[28:31], v[136:139], a[144:147]
    s_waitcnt lgkmcnt(11)
    v_mfma_f32_16x16x32_bf16 a[148:151], a[28:31], v[24:27], a[148:151]
    s_waitcnt lgkmcnt(10)
    v_mfma_f32_16x16x32_bf16 a[152:155], a[28:31], v[116:119], a[152:155]
    s_waitcnt lgkmcnt(9)
    v_mfma_f32_16x16x32_bf16 a[156:159], a[28:31], v[120:123], a[156:159]
    s_waitcnt lgkmcnt(8)
    v_mfma_f32_16x16x32_bf16 a[160:163], a[28:31], v[172:175], a[160:163]
    s_waitcnt lgkmcnt(7)
    v_mfma_f32_16x16x32_bf16 a[164:167], a[28:31], v[40:43], a[164:167]
    s_waitcnt vmcnt(17)
    s_waitcnt lgkmcnt(6)
    v_mfma_f32_16x16x32_bf16 a[140:143], a[32:35], v[224:227], a[140:143]
    s_waitcnt lgkmcnt(5)
    v_mfma_f32_16x16x32_bf16 a[144:147], a[32:35], v[44:47], a[144:147]
    s_waitcnt lgkmcnt(4)
    v_mfma_f32_16x16x32_bf16 a[148:151], a[32:35], v[164:167], a[148:151]
    s_waitcnt lgkmcnt(3)
    v_mfma_f32_16x16x32_bf16 a[152:155], a[32:35], v[184:187], a[152:155]
    s_waitcnt lgkmcnt(2)
    v_mfma_f32_16x16x32_bf16 a[156:159], a[32:35], v[188:191], a[156:159]
    s_waitcnt lgkmcnt(1)
    v_mfma_f32_16x16x32_bf16 a[160:163], a[32:35], v[32:35], a[160:163]
    s_waitcnt lgkmcnt(0)
    v_mfma_f32_16x16x32_bf16 a[164:167], a[32:35], v[36:39], a[164:167]
    s_waitcnt vmcnt(16)
    v_mfma_f32_16x16x32_bf16 a[168:171], a[36:39], v[124:127], a[168:171]
    v_accvgpr_read_b32 v18, a140
    v_accvgpr_read_b32 v19, a141
    v_mfma_f32_16x16x32_bf16 a[172:175], a[36:39], v[128:131], a[172:175]
    v_cvt_pk_bf16_f32 v6, v18, v19
    v_accvgpr_read_b32 v20, a142
    v_mfma_f32_16x16x32_bf16 a[176:179], a[36:39], v[132:135], a[176:179]
    v_accvgpr_read_b32 v21, a143
    v_cvt_pk_bf16_f32 v7, v20, v21
    v_mfma_f32_16x16x32_bf16 a[180:183], a[36:39], v[216:219], a[180:183]
    v_accvgpr_read_b32 v18, a144
    v_accvgpr_read_b32 v19, a145
    v_mfma_f32_16x16x32_bf16 a[184:187], a[36:39], v[112:115], a[184:187]
    v_cvt_pk_bf16_f32 v8, v18, v19
    v_accvgpr_read_b32 v20, a146
    v_mfma_f32_16x16x32_bf16 a[188:191], a[36:39], v[144:147], a[188:191]
    v_accvgpr_read_b32 v21, a147
    v_cvt_pk_bf16_f32 v9, v20, v21
    v_mfma_f32_16x16x32_bf16 a[192:195], a[36:39], v[148:151], a[192:195]
    s_mov_b32 s40, 143360
    buffer_store_dwordx4 v[6:9], v254, s[20:23], s40 offen sc1
    s_waitcnt vmcnt(16)
    v_mfma_f32_16x16x32_bf16 a[168:171], a[40:43], v[152:155], a[168:171]
    v_accvgpr_read_b32 v18, a148
    v_accvgpr_read_b32 v19, a149
    v_mfma_f32_16x16x32_bf16 a[172:175], a[40:43], v[176:179], a[172:175]
    v_cvt_pk_bf16_f32 v10, v18, v19
    v_accvgpr_read_b32 v20, a150
    v_mfma_f32_16x16x32_bf16 a[176:179], a[40:43], v[52:55], a[176:179]
    v_accvgpr_read_b32 v21, a151
    v_cvt_pk_bf16_f32 v11, v20, v21
    v_mfma_f32_16x16x32_bf16 a[180:183], a[40:43], v[48:51], a[180:183]
    v_accvgpr_read_b32 v18, a152
    v_accvgpr_read_b32 v19, a153
    v_mfma_f32_16x16x32_bf16 a[184:187], a[40:43], v[140:143], a[184:187]
    v_cvt_pk_bf16_f32 v12, v18, v19
    v_accvgpr_read_b32 v20, a154
    v_mfma_f32_16x16x32_bf16 a[188:191], a[40:43], v[28:31], a[188:191]
    v_accvgpr_read_b32 v21, a155
    v_cvt_pk_bf16_f32 v13, v20, v21
    v_mfma_f32_16x16x32_bf16 a[192:195], a[40:43], v[220:223], a[192:195]
    s_mov_b32 s40, 144384
    buffer_store_dwordx4 v[10:13], v254, s[20:23], s40 offen sc1
    s_waitcnt vmcnt(16)
    v_mfma_f32_16x16x32_bf16 a[168:171], a[44:47], v[180:183], a[168:171]
    v_accvgpr_read_b32 v18, a156
    v_accvgpr_read_b32 v19, a157
    v_mfma_f32_16x16x32_bf16 a[172:175], a[44:47], v[136:139], a[172:175]
    v_cvt_pk_bf16_f32 v14, v18, v19
    v_accvgpr_read_b32 v20, a158
    v_mfma_f32_16x16x32_bf16 a[176:179], a[44:47], v[24:27], a[176:179]
    v_accvgpr_read_b32 v21, a159
    v_cvt_pk_bf16_f32 v15, v20, v21
    v_mfma_f32_16x16x32_bf16 a[180:183], a[44:47], v[116:119], a[180:183]
    v_accvgpr_read_b32 v18, a160
    v_accvgpr_read_b32 v19, a161
    v_mfma_f32_16x16x32_bf16 a[184:187], a[44:47], v[120:123], a[184:187]
    v_cvt_pk_bf16_f32 v16, v18, v19
    v_accvgpr_read_b32 v20, a162
    v_mfma_f32_16x16x32_bf16 a[188:191], a[44:47], v[172:175], a[188:191]
    v_accvgpr_read_b32 v21, a163
    v_cvt_pk_bf16_f32 v17, v20, v21
    v_mfma_f32_16x16x32_bf16 a[192:195], a[44:47], v[40:43], a[192:195]
    s_mov_b32 s40, 145408
    buffer_store_dwordx4 v[14:17], v254, s[20:23], s40 offen sc1
    s_waitcnt vmcnt(16)
    v_mfma_f32_16x16x32_bf16 a[168:171], a[48:51], v[224:227], a[168:171]
    v_mfma_f32_16x16x32_bf16 a[172:175], a[48:51], v[44:47], a[172:175]
    v_mfma_f32_16x16x32_bf16 a[176:179], a[48:51], v[164:167], a[176:179]
    v_mfma_f32_16x16x32_bf16 a[180:183], a[48:51], v[184:187], a[180:183]
    v_mfma_f32_16x16x32_bf16 a[184:187], a[48:51], v[188:191], a[184:187]
    v_mfma_f32_16x16x32_bf16 a[188:191], a[48:51], v[32:35], a[188:191]
    v_mfma_f32_16x16x32_bf16 a[192:195], a[48:51], v[36:39], a[192:195]
    v_accvgpr_read_b32 v18, a164
    v_accvgpr_read_b32 v19, a165
    s_waitcnt vmcnt(15)
    v_mfma_f32_16x16x32_bf16 a[196:199], a[52:55], v[124:127], a[196:199]
    v_cvt_pk_bf16_f32 v6, v18, v19
    v_accvgpr_read_b32 v20, a166
    v_mfma_f32_16x16x32_bf16 a[200:203], a[52:55], v[128:131], a[200:203]
    v_accvgpr_read_b32 v21, a167
    v_cvt_pk_bf16_f32 v7, v20, v21
    v_mfma_f32_16x16x32_bf16 a[204:207], a[52:55], v[132:135], a[204:207]
    v_accvgpr_read_b32 v18, a168
    v_accvgpr_read_b32 v19, a169
    v_mfma_f32_16x16x32_bf16 a[208:211], a[52:55], v[216:219], a[208:211]
    v_cvt_pk_bf16_f32 v8, v18, v19
    v_accvgpr_read_b32 v20, a170
    v_mfma_f32_16x16x32_bf16 a[212:215], a[52:55], v[112:115], a[212:215]
    v_accvgpr_read_b32 v21, a171
    v_cvt_pk_bf16_f32 v9, v20, v21
    v_mfma_f32_16x16x32_bf16 a[216:219], a[52:55], v[144:147], a[216:219]
    s_mov_b32 s40, 146432
    buffer_store_dwordx4 v[6:9], v254, s[20:23], s40 offen sc1
    v_mfma_f32_16x16x32_bf16 a[220:223], a[52:55], v[148:151], a[220:223]
    v_accvgpr_read_b32 v18, a172
    v_accvgpr_read_b32 v19, a173
    s_waitcnt vmcnt(15)
    v_mfma_f32_16x16x32_bf16 a[196:199], a[56:59], v[152:155], a[196:199]
    v_cvt_pk_bf16_f32 v10, v18, v19
    v_accvgpr_read_b32 v20, a174
    v_mfma_f32_16x16x32_bf16 a[200:203], a[56:59], v[176:179], a[200:203]
    v_accvgpr_read_b32 v21, a175
    v_cvt_pk_bf16_f32 v11, v20, v21
    v_mfma_f32_16x16x32_bf16 a[204:207], a[56:59], v[52:55], a[204:207]
    v_accvgpr_read_b32 v18, a176
    v_accvgpr_read_b32 v19, a177
    v_mfma_f32_16x16x32_bf16 a[208:211], a[56:59], v[48:51], a[208:211]
    v_cvt_pk_bf16_f32 v12, v18, v19
    v_accvgpr_read_b32 v20, a178
    v_mfma_f32_16x16x32_bf16 a[212:215], a[56:59], v[140:143], a[212:215]
    v_accvgpr_read_b32 v21, a179
    v_cvt_pk_bf16_f32 v13, v20, v21
    v_mfma_f32_16x16x32_bf16 a[216:219], a[56:59], v[28:31], a[216:219]
    s_mov_b32 s40, 147456
    buffer_store_dwordx4 v[10:13], v254, s[20:23], s40 offen sc1
    v_mfma_f32_16x16x32_bf16 a[220:223], a[56:59], v[220:223], a[220:223]
    v_accvgpr_read_b32 v18, a180
    v_accvgpr_read_b32 v19, a181
    s_waitcnt vmcnt(15)
    v_mfma_f32_16x16x32_bf16 a[196:199], a[60:63], v[180:183], a[196:199]
    v_cvt_pk_bf16_f32 v14, v18, v19
    v_accvgpr_read_b32 v20, a182
    v_mfma_f32_16x16x32_bf16 a[200:203], a[60:63], v[136:139], a[200:203]
    v_accvgpr_read_b32 v21, a183
    v_cvt_pk_bf16_f32 v15, v20, v21
    v_mfma_f32_16x16x32_bf16 a[204:207], a[60:63], v[24:27], a[204:207]
    v_accvgpr_read_b32 v18, a184
    v_accvgpr_read_b32 v19, a185
    v_mfma_f32_16x16x32_bf16 a[208:211], a[60:63], v[116:119], a[208:211]
    v_cvt_pk_bf16_f32 v16, v18, v19
    v_accvgpr_read_b32 v20, a186
    v_mfma_f32_16x16x32_bf16 a[212:215], a[60:63], v[120:123], a[212:215]
    v_accvgpr_read_b32 v21, a187
    v_cvt_pk_bf16_f32 v17, v20, v21
    v_mfma_f32_16x16x32_bf16 a[216:219], a[60:63], v[172:175], a[216:219]
    s_mov_b32 s40, 148480
    buffer_store_dwordx4 v[14:17], v254, s[20:23], s40 offen sc1
    v_mfma_f32_16x16x32_bf16 a[220:223], a[60:63], v[40:43], a[220:223]
    v_accvgpr_read_b32 v18, a188
    v_accvgpr_read_b32 v19, a189
    s_waitcnt vmcnt(15)
    v_mfma_f32_16x16x32_bf16 a[196:199], a[64:67], v[224:227], a[196:199]
    v_cvt_pk_bf16_f32 v6, v18, v19
    v_accvgpr_read_b32 v20, a190
    v_mfma_f32_16x16x32_bf16 a[200:203], a[64:67], v[44:47], a[200:203]
    v_accvgpr_read_b32 v21, a191
    v_cvt_pk_bf16_f32 v7, v20, v21
    v_mfma_f32_16x16x32_bf16 a[204:207], a[64:67], v[164:167], a[204:207]
    v_accvgpr_read_b32 v18, a192
    v_accvgpr_read_b32 v19, a193
    v_mfma_f32_16x16x32_bf16 a[208:211], a[64:67], v[184:187], a[208:211]
    v_cvt_pk_bf16_f32 v8, v18, v19
    v_accvgpr_read_b32 v20, a194
    v_mfma_f32_16x16x32_bf16 a[212:215], a[64:67], v[188:191], a[212:215]
    v_accvgpr_read_b32 v21, a195
    v_cvt_pk_bf16_f32 v9, v20, v21
    v_mfma_f32_16x16x32_bf16 a[216:219], a[64:67], v[32:35], a[216:219]
    s_mov_b32 s40, 149504
    buffer_store_dwordx4 v[6:9], v254, s[20:23], s40 offen sc1
    v_mfma_f32_16x16x32_bf16 a[220:223], a[64:67], v[36:39], a[220:223]
    s_waitcnt vmcnt(15)
    v_mfma_f32_16x16x32_bf16 a[224:227], a[68:71], v[124:127], a[224:227]
    v_accvgpr_read_b32 v18, a196
    v_accvgpr_read_b32 v19, a197
    v_mfma_f32_16x16x32_bf16 a[228:231], a[68:71], v[128:131], a[228:231]
    v_cvt_pk_bf16_f32 v10, v18, v19
    v_accvgpr_read_b32 v20, a198
    v_mfma_f32_16x16x32_bf16 a[232:235], a[68:71], v[132:135], a[232:235]
    v_accvgpr_read_b32 v21, a199
    v_cvt_pk_bf16_f32 v11, v20, v21
    v_mfma_f32_16x16x32_bf16 a[236:239], a[68:71], v[216:219], a[236:239]
    v_accvgpr_read_b32 v18, a200
    v_accvgpr_read_b32 v19, a201
    v_mfma_f32_16x16x32_bf16 a[240:243], a[68:71], v[112:115], a[240:243]
    v_cvt_pk_bf16_f32 v12, v18, v19
    v_accvgpr_read_b32 v20, a202
    v_mfma_f32_16x16x32_bf16 a[244:247], a[68:71], v[144:147], a[244:247]
    v_accvgpr_read_b32 v21, a203
    v_cvt_pk_bf16_f32 v13, v20, v21
    v_mfma_f32_16x16x32_bf16 a[248:251], a[68:71], v[148:151], a[248:251]
    s_mov_b32 s40, 150528
    buffer_store_dwordx4 v[10:13], v254, s[20:23], s40 offen sc1
    s_waitcnt vmcnt(15)
    v_mfma_f32_16x16x32_bf16 a[224:227], a[72:75], v[152:155], a[224:227]
    v_accvgpr_read_b32 v18, a204
    v_accvgpr_read_b32 v19, a205
    v_mfma_f32_16x16x32_bf16 a[228:231], a[72:75], v[176:179], a[228:231]
    v_cvt_pk_bf16_f32 v14, v18, v19
    v_accvgpr_read_b32 v20, a206
    v_mfma_f32_16x16x32_bf16 a[232:235], a[72:75], v[52:55], a[232:235]
    v_accvgpr_read_b32 v21, a207
    v_cvt_pk_bf16_f32 v15, v20, v21
    v_mfma_f32_16x16x32_bf16 a[236:239], a[72:75], v[48:51], a[236:239]
    v_accvgpr_read_b32 v18, a208
    v_accvgpr_read_b32 v19, a209
    v_mfma_f32_16x16x32_bf16 a[240:243], a[72:75], v[140:143], a[240:243]
    v_cvt_pk_bf16_f32 v16, v18, v19
    v_accvgpr_read_b32 v20, a210
    v_mfma_f32_16x16x32_bf16 a[244:247], a[72:75], v[28:31], a[244:247]
    v_accvgpr_read_b32 v21, a211
    v_cvt_pk_bf16_f32 v17, v20, v21
    v_mfma_f32_16x16x32_bf16 a[248:251], a[72:75], v[220:223], a[248:251]
    s_mov_b32 s40, 151552
    buffer_store_dwordx4 v[14:17], v254, s[20:23], s40 offen sc1
    s_waitcnt vmcnt(15)
    v_mfma_f32_16x16x32_bf16 a[224:227], a[76:79], v[180:183], a[224:227]
    v_accvgpr_read_b32 v18, a212
    v_accvgpr_read_b32 v19, a213
    v_mfma_f32_16x16x32_bf16 a[228:231], a[76:79], v[136:139], a[228:231]
    v_cvt_pk_bf16_f32 v6, v18, v19
    v_accvgpr_read_b32 v20, a214
    v_mfma_f32_16x16x32_bf16 a[232:235], a[76:79], v[24:27], a[232:235]
    v_accvgpr_read_b32 v21, a215
    v_cvt_pk_bf16_f32 v7, v20, v21
    v_mfma_f32_16x16x32_bf16 a[236:239], a[76:79], v[116:119], a[236:239]
    v_accvgpr_read_b32 v18, a216
    v_accvgpr_read_b32 v19, a217
    v_mfma_f32_16x16x32_bf16 a[240:243], a[76:79], v[120:123], a[240:243]
    v_cvt_pk_bf16_f32 v8, v18, v19
    v_accvgpr_read_b32 v20, a218
    v_mfma_f32_16x16x32_bf16 a[244:247], a[76:79], v[172:175], a[244:247]
    v_accvgpr_read_b32 v21, a219
    v_cvt_pk_bf16_f32 v9, v20, v21
    v_mfma_f32_16x16x32_bf16 a[248:251], a[76:79], v[40:43], a[248:251]
    s_mov_b32 s40, 152576
    buffer_store_dwordx4 v[6:9], v254, s[20:23], s40 offen sc1
    s_waitcnt vmcnt(15)
    v_mfma_f32_16x16x32_bf16 a[224:227], a[80:83], v[224:227], a[224:227]
    v_mfma_f32_16x16x32_bf16 a[228:231], a[80:83], v[44:47], a[228:231]
    v_mfma_f32_16x16x32_bf16 a[232:235], a[80:83], v[164:167], a[232:235]
    v_mfma_f32_16x16x32_bf16 a[236:239], a[80:83], v[184:187], a[236:239]
    v_mfma_f32_16x16x32_bf16 a[240:243], a[80:83], v[188:191], a[240:243]
    v_mfma_f32_16x16x32_bf16 a[244:247], a[80:83], v[32:35], a[244:247]
    v_mfma_f32_16x16x32_bf16 a[248:251], a[80:83], v[36:39], a[248:251]
    v_accvgpr_read_b32 v18, a220
    v_accvgpr_read_b32 v19, a221
    s_waitcnt vmcnt(14)
    v_mfma_f32_16x16x32_bf16 a[252:255], a[84:87], v[124:127], a[252:255]
    v_cvt_pk_bf16_f32 v10, v18, v19
    v_accvgpr_read_b32 v20, a222
    v_mfma_f32_16x16x32_bf16 v[228:231], a[84:87], v[128:131], v[228:231]
    v_accvgpr_read_b32 v21, a223
    v_cvt_pk_bf16_f32 v11, v20, v21
    v_mfma_f32_16x16x32_bf16 v[232:235], a[84:87], v[132:135], v[232:235]
    v_accvgpr_read_b32 v18, a224
    v_accvgpr_read_b32 v19, a225
    v_mfma_f32_16x16x32_bf16 v[236:239], a[84:87], v[216:219], v[236:239]
    v_cvt_pk_bf16_f32 v12, v18, v19
    v_accvgpr_read_b32 v20, a226
    v_mfma_f32_16x16x32_bf16 v[240:243], a[84:87], v[112:115], v[240:243]
    v_accvgpr_read_b32 v21, a227
    v_cvt_pk_bf16_f32 v13, v20, v21
    v_mfma_f32_16x16x32_bf16 v[244:247], a[84:87], v[144:147], v[244:247]
    s_mov_b32 s40, 153600
    buffer_store_dwordx4 v[10:13], v254, s[20:23], s40 offen sc1
    v_mfma_f32_16x16x32_bf16 v[248:251], a[84:87], v[148:151], v[248:251]
    v_accvgpr_read_b32 v18, a228
    v_accvgpr_read_b32 v19, a229
    s_waitcnt vmcnt(14)
    v_mfma_f32_16x16x32_bf16 a[252:255], a[88:91], v[152:155], a[252:255]
    v_cvt_pk_bf16_f32 v14, v18, v19
    v_accvgpr_read_b32 v20, a230
    v_mfma_f32_16x16x32_bf16 v[228:231], a[88:91], v[176:179], v[228:231]
    v_accvgpr_read_b32 v21, a231
    v_cvt_pk_bf16_f32 v15, v20, v21
    v_mfma_f32_16x16x32_bf16 v[232:235], a[88:91], v[52:55], v[232:235]
    v_accvgpr_read_b32 v18, a232
    v_accvgpr_read_b32 v19, a233
    v_mfma_f32_16x16x32_bf16 v[236:239], a[88:91], v[48:51], v[236:239]
    v_cvt_pk_bf16_f32 v16, v18, v19
    v_accvgpr_read_b32 v20, a234
    v_mfma_f32_16x16x32_bf16 v[240:243], a[88:91], v[140:143], v[240:243]
    v_accvgpr_read_b32 v21, a235
    v_cvt_pk_bf16_f32 v17, v20, v21
    v_mfma_f32_16x16x32_bf16 v[244:247], a[88:91], v[28:31], v[244:247]
    s_mov_b32 s40, 154624
    buffer_store_dwordx4 v[14:17], v254, s[20:23], s40 offen sc1
    v_mfma_f32_16x16x32_bf16 v[248:251], a[88:91], v[220:223], v[248:251]
    v_accvgpr_read_b32 v18, a236
    v_accvgpr_read_b32 v19, a237
    s_waitcnt vmcnt(14)
    v_mfma_f32_16x16x32_bf16 a[252:255], a[92:95], v[180:183], a[252:255]
    v_cvt_pk_bf16_f32 v6, v18, v19
    v_accvgpr_read_b32 v20, a238
    v_mfma_f32_16x16x32_bf16 v[228:231], a[92:95], v[136:139], v[228:231]
    v_accvgpr_read_b32 v21, a239
    v_cvt_pk_bf16_f32 v7, v20, v21
    v_mfma_f32_16x16x32_bf16 v[232:235], a[92:95], v[24:27], v[232:235]
    v_accvgpr_read_b32 v18, a240
    v_accvgpr_read_b32 v19, a241
    v_mfma_f32_16x16x32_bf16 v[236:239], a[92:95], v[116:119], v[236:239]
    v_cvt_pk_bf16_f32 v8, v18, v19
    v_accvgpr_read_b32 v20, a242
    v_mfma_f32_16x16x32_bf16 v[240:243], a[92:95], v[120:123], v[240:243]
    v_accvgpr_read_b32 v21, a243
    v_cvt_pk_bf16_f32 v9, v20, v21
    v_mfma_f32_16x16x32_bf16 v[244:247], a[92:95], v[172:175], v[244:247]
    s_mov_b32 s40, 155648
    buffer_store_dwordx4 v[6:9], v254, s[20:23], s40 offen sc1
    v_mfma_f32_16x16x32_bf16 v[248:251], a[92:95], v[40:43], v[248:251]
    v_accvgpr_read_b32 v18, a244
    v_accvgpr_read_b32 v19, a245
    s_waitcnt vmcnt(14)
    v_mfma_f32_16x16x32_bf16 a[252:255], a[96:99], v[224:227], a[252:255]
    v_cvt_pk_bf16_f32 v10, v18, v19
    v_accvgpr_read_b32 v20, a246
    v_mfma_f32_16x16x32_bf16 v[228:231], a[96:99], v[44:47], v[228:231]
    v_accvgpr_read_b32 v21, a247
    v_cvt_pk_bf16_f32 v11, v20, v21
    v_mfma_f32_16x16x32_bf16 v[232:235], a[96:99], v[164:167], v[232:235]
    v_accvgpr_read_b32 v18, a248
    v_accvgpr_read_b32 v19, a249
    v_mfma_f32_16x16x32_bf16 v[236:239], a[96:99], v[184:187], v[236:239]
    v_cvt_pk_bf16_f32 v12, v18, v19
    v_accvgpr_read_b32 v20, a250
    v_mfma_f32_16x16x32_bf16 v[240:243], a[96:99], v[188:191], v[240:243]
    v_accvgpr_read_b32 v21, a251
    v_cvt_pk_bf16_f32 v13, v20, v21
    v_mfma_f32_16x16x32_bf16 v[244:247], a[96:99], v[32:35], v[244:247]
    s_mov_b32 s40, 156672
    buffer_store_dwordx4 v[10:13], v254, s[20:23], s40 offen sc1
    v_mfma_f32_16x16x32_bf16 v[248:251], a[96:99], v[36:39], v[248:251]
    v_accvgpr_read_b32 v18, a252
    v_accvgpr_read_b32 v19, a253
    v_cvt_pk_bf16_f32 v14, v18, v19
    v_accvgpr_read_b32 v20, a254
    v_accvgpr_read_b32 v21, a255
    v_cvt_pk_bf16_f32 v15, v20, v21
    v_cvt_pk_bf16_f32 v16, v228, v229
    v_cvt_pk_bf16_f32 v17, v230, v231
    s_mov_b32 s40, 157696
    buffer_store_dwordx4 v[14:17], v254, s[20:23], s40 offen sc1
    v_cvt_pk_bf16_f32 v6, v232, v233
    v_cvt_pk_bf16_f32 v7, v234, v235
    v_cvt_pk_bf16_f32 v8, v236, v237
    v_cvt_pk_bf16_f32 v9, v238, v239
    s_mov_b32 s40, 158720
    buffer_store_dwordx4 v[6:9], v254, s[20:23], s40 offen sc1
    v_cvt_pk_bf16_f32 v10, v240, v241
    v_cvt_pk_bf16_f32 v11, v242, v243
    v_cvt_pk_bf16_f32 v12, v244, v245
    v_cvt_pk_bf16_f32 v13, v246, v247
    s_mov_b32 s40, 159744
    buffer_store_dwordx4 v[10:13], v254, s[20:23], s40 offen sc1
    v_cvt_pk_bf16_f32 v14, v248, v249
    v_cvt_pk_bf16_f32 v15, v250, v251
    s_mov_b32 s40, 160768
    buffer_store_dwordx2 v[14:15], v22, s[20:23], s40 offen sc1
    s_and_b32 s56, s97, 6
    s_and_b32 s57, s97, 1
    s_mul_i32 s57, s57, 9
    s_add_u32 s57, s57, s3
    s_lshl_b32 s32, s96, 3
    s_add_u32 s32, s32, s56
    s_lshl_b32 s39, s32, 5
    s_mul_i32 s32, s32, 143360
    s_add_u32 s64, s94, s32
    s_addc_u32 s65, s95, 0
    s_mov_b32 s66, 286720
    s_mov_b32 s67, 0x20000
    s_mul_i32 s37, s56, 160
    s_mul_i32 s32, s96, 143360
    s_add_u32 s32, s32, s37
    s_add_u32 s72, s90, s32
    s_addc_u32 s73, s91, 0
    s_sub_u32 s74, 143360, s37
    s_mov_b32 s75, 0x20000
    v_and_b32 v2, 15, v0
    v_lshrrev_b32 v3, 4, v0
    v_mul_u32_u24 v2, 1280, v2
    v_lshl_add_u32 v2, v3, 3, v2
    v_and_b32 v3, 7, v0
    v_lshlrev_b32 v3, 2, v3
    s_lshl_b32 s32, s57, 10
    v_add_u32 v4, s32, v254
    s_bitcmp1_b32 s97, 0
    s_cselect_b32 s37, 3, 4
    v_lshlrev_b32 v5, s37, v0
    v_add_u32 v5, s32, v5
    s_mov_b32 s58, 0xffff0000
    s_mov_b32 s48, 0
L_pollp0:
    buffer_load_dword v1, v3, s[68:71], s39 offen sc1
    s_waitcnt vmcnt(0)
    v_mov_b32 v18, 1
    buffer_store_dword v18, v23, s[68:71], 0 offen offset:32 sc1
    v_cmp_ne_u32 vcc, 1, v1
    s_nop 0
    s_cbranch_vccz L_pollp0_done
    s_sleep 1
    s_add_u32 s48, s48, 1
    s_cmp_lt_u32 s48, 200000
    s_cbranch_scc1 L_pollp0
L_pollp0_done:
    s_mov_b32 s37, 0
    buffer_load_dwordx4 v[24:27], v4, s[64:67], s37 offen sc1
    s_mov_b32 s37, 17920
    buffer_load_dwordx4 v[28:31], v4, s[64:67], s37 offen sc1
    s_mov_b32 s37, 35840
    buffer_load_dwordx4 v[32:35], v4, s[64:67], s37 offen sc1
    s_mov_b32 s37, 53760
    buffer_load_dwordx4 v[36:39], v4, s[64:67], s37 offen sc1
    s_mov_b32 s37, 71680
    buffer_load_dwordx4 v[40:43], v4, s[64:67], s37 offen sc1
    s_mov_b32 s37, 89600
    buffer_load_dwordx4 v[44:47], v4, s[64:67], s37 offen sc1
    s_mov_b32 s37, 107520
    buffer_load_dwordx4 v[48:51], v4, s[64:67], s37 offen sc1
    s_mov_b32 s37, 125440
    buffer_load_dwordx4 v[52:55], v4, s[64:67], s37 offen sc1
    s_mov_b32 s37, 4096
    buffer_load_dwordx4 v[56:59], v4, s[64:67], s37 offen sc1
    s_mov_b32 s37, 22016
    buffer_load_dwordx4 v[60:63], v4, s[64:67], s37 offen sc1
    s_mov_b32 s37, 39936
    buffer_load_dwordx4 v[64:67], v4, s[64:67], s37 offen sc1
    s_mov_b32 s37, 57856
    buffer_load_dwordx4 v[68:71], v4, s[64:67], s37 offen sc1
    s_mov_b32 s37, 75776
    buffer_load_dwordx4 v[72:75], v4, s[64:67], s37 offen sc1
    s_mov_b32 s37, 93696
    buffer_load_dwordx4 v[76:79], v4, s[64:67], s37 offen sc1
    s_mov_b32 s37, 111616
    buffer_load_dwordx4 v[80:83], v4, s[64:67], s37 offen sc1
    s_mov_b32 s37, 129536
    buffer_load_dwordx4 v[84:87], v4, s[64:67], s37 offen sc1
    s_mov_b32 s37, 8192
    buffer_load_dwordx4 v[88:91], v5, s[64:67], s37 offen sc1
    s_mov_b32 s37, 26112
    buffer_load_dwordx4 v[92:95], v5, s[64:67], s37 offen sc1
    s_mov_b32 s37, 44032
    buffer_load_dwordx4 v[96:99], v5, s[64:67], s37 offen sc1
    s_mov_b32 s37, 61952
    buffer_load_dwordx4 v[100:103], v5, s[64:67], s37 offen sc1
    s_mov_b32 s37, 79872
    buffer_load_dwordx4 v[104:107], v5, s[64:67], s37 offen sc1
    s_mov_b32 s37, 97792
    buffer_load_dwordx4 v[108:111], v5, s[64:67], s37 offen sc1
    s_mov_b32 s37, 115712
    buffer_load_dwordx4 v[112:115], v5, s[64:67], s37 offen sc1
    s_mov_b32 s37, 133632
    buffer_load_dwordx4 v[116:119], v5, s[64:67], s37 offen sc1
    s_waitcnt vmcnt(16)
    v_lshlrev_b32 v196, 16, v24
    v_and_b32 v197, s58, v24
    v_lshlrev_b32 v198, 16, v25
    v_and_b32 v199, s58, v25
    v_lshlrev_b32 v200, 16, v26
    v_and_b32 v201, s58, v26
    v_lshlrev_b32 v202, 16, v27
    v_and_b32 v203, s58, v27
    v_lshlrev_b32 v204, 16, v28
    v_and_b32 v205, s58, v28
    v_pk_add_f32 v[196:197], v[196:197], v[204:205]
    v_lshlrev_b32 v206, 16, v29
    v_and_b32 v207, s58, v29
    v_pk_add_f32 v[198:199], v[198:199], v[206:207]
    v_lshlrev_b32 v204, 16, v30
    v_and_b32 v205, s58, v30
    v_pk_add_f32 v[200:201], v[200:201], v[204:205]
    v_lshlrev_b32 v206, 16, v31
    v_and_b32 v207, s58, v31
    v_pk_add_f32 v[202:203], v[202:203], v[206:207]
    v_lshlrev_b32 v204, 16, v32
    v_and_b32 v205, s58, v32
    v_pk_add_f32 v[196:197], v[196:197], v[204:205]
    v_lshlrev_b32 v206, 16, v33
    v_and_b32 v207, s58, v33
    v_pk_add_f32 v[198:199], v[198:199], v[206:207]
    v_lshlrev_b32 v204, 16, v34
    v_and_b32 v205, s58, v34
    v_pk_add_f32 v[200:201], v[200:201], v[204:205]
    v_lshlrev_b32 v206, 16, v35
    v_and_b32 v207, s58, v35
    v_pk_add_f32 v[202:203], v[202:203], v[206:207]
    v_lshlrev_b32 v204, 16, v36
    v_and_b32 v205, s58, v36
    v_pk_add_f32 v[196:197], v[196:197], v[204:205]
    v_lshlrev_b32 v206, 16, v37
    v_and_b32 v207, s58, v37
    v_pk_add_f32 v[198:199], v[198:199], v[206:207]
    v_lshlrev_b32 v204, 16, v38
    v_and_b32 v205, s58, v38
    v_pk_add_f32 v[200:201], v[200:201], v[204:205]
    v_lshlrev_b32 v206, 16, v39
    v_and_b32 v207, s58, v39
    v_pk_add_f32 v[202:203], v[202:203], v[206:207]
    v_lshlrev_b32 v204, 16, v40
    v_and_b32 v205, s58, v40
    v_pk_add_f32 v[196:197], v[196:197], v[204:205]
    v_lshlrev_b32 v206, 16, v41
    v_and_b32 v207, s58, v41
    v_pk_add_f32 v[198:199], v[198:199], v[206:207]
    v_lshlrev_b32 v204, 16, v42
    v_and_b32 v205, s58, v42
    v_pk_add_f32 v[200:201], v[200:201], v[204:205]
    v_lshlrev_b32 v206, 16, v43
    v_and_b32 v207, s58, v43
    v_pk_add_f32 v[202:203], v[202:203], v[206:207]
    v_lshlrev_b32 v204, 16, v44
    v_and_b32 v205, s58, v44
    v_pk_add_f32 v[196:197], v[196:197], v[204:205]
    v_lshlrev_b32 v206, 16, v45
    v_and_b32 v207, s58, v45
    v_pk_add_f32 v[198:199], v[198:199], v[206:207]
    v_lshlrev_b32 v204, 16, v46
    v_and_b32 v205, s58, v46
    v_pk_add_f32 v[200:201], v[200:201], v[204:205]
    v_lshlrev_b32 v206, 16, v47
    v_and_b32 v207, s58, v47
    v_pk_add_f32 v[202:203], v[202:203], v[206:207]
    v_lshlrev_b32 v204, 16, v48
    v_and_b32 v205, s58, v48
    v_pk_add_f32 v[196:197], v[196:197], v[204:205]
    v_lshlrev_b32 v206, 16, v49
    v_and_b32 v207, s58, v49
    v_pk_add_f32 v[198:199], v[198:199], v[206:207]
    v_lshlrev_b32 v204, 16, v50
    v_and_b32 v205, s58, v50
    v_pk_add_f32 v[200:201], v[200:201], v[204:205]
    v_lshlrev_b32 v206, 16, v51
    v_and_b32 v207, s58, v51
    v_pk_add_f32 v[202:203], v[202:203], v[206:207]
    v_lshlrev_b32 v204, 16, v52
    v_and_b32 v205, s58, v52
    v_pk_add_f32 v[196:197], v[196:197], v[204:205]
    v_lshlrev_b32 v206, 16, v53
    v_and_b32 v207, s58, v53
    v_pk_add_f32 v[198:199], v[198:199], v[206:207]
    v_lshlrev_b32 v204, 16, v54
    v_and_b32 v205, s58, v54
    v_pk_add_f32 v[200:201], v[200:201], v[204:205]
    v_lshlrev_b32 v206, 16, v55
    v_and_b32 v207, s58, v55
    v_pk_add_f32 v[202:203], v[202:203], v[206:207]
    v_cvt_pk_bf16_f32 v212, v196, v197
    v_cvt_pk_bf16_f32 v213, v198, v199
    v_cvt_pk_bf16_f32 v214, v200, v201
    v_cvt_pk_bf16_f32 v215, v202, v203
    s_lshl_b32 s32, s57, 1
    s_add_u32 s32, s32, 0
    s_mul_i32 s37, s32, 37
    s_lshr_b32 s37, s37, 8
    s_mul_i32 s40, s37, 7
    s_sub_u32 s40, s32, s40
    s_mul_i32 s40, s40, 20480
    s_lshl_b32 s37, s37, 5
    s_add_u32 s40, s40, s37
    buffer_store_dwordx2 v[212:213], v2, s[72:75], s40 offen offset:0
    s_lshl_b32 s32, s57, 1
    s_add_u32 s32, s32, 1
    s_mul_i32 s37, s32, 37
    s_lshr_b32 s37, s37, 8
    s_mul_i32 s40, s37, 7
    s_sub_u32 s40, s32, s40
    s_mul_i32 s40, s40, 20480
    s_lshl_b32 s37, s37, 5
    s_add_u32 s40, s40, s37
    buffer_store_dwordx2 v[214:215], v2, s[72:75], s40 offen offset:0
    s_waitcnt vmcnt(10)
    v_lshlrev_b32 v196, 16, v56
    v_and_b32 v197, s58, v56
    v_lshlrev_b32 v198, 16, v57
    v_and_b32 v199, s58, v57
    v_lshlrev_b32 v200, 16, v58
    v_and_b32 v201, s58, v58
    v_lshlrev_b32 v202, 16, v59
    v_and_b32 v203, s58, v59
    v_lshlrev_b32 v204, 16, v60
    v_and_b32 v205, s58, v60
    v_pk_add_f32 v[196:197], v[196:197], v[204:205]
    v_lshlrev_b32 v206, 16, v61
    v_and_b32 v207, s58, v61
    v_pk_add_f32 v[198:199], v[198:199], v[206:207]
    v_lshlrev_b32 v204, 16, v62
    v_and_b32 v205, s58, v62
    v_pk_add_f32 v[200:201], v[200:201], v[204:205]
    v_lshlrev_b32 v206, 16, v63
    v_and_b32 v207, s58, v63
    v_pk_add_f32 v[202:203], v[202:203], v[206:207]
    v_lshlrev_b32 v204, 16, v64
    v_and_b32 v205, s58, v64
    v_pk_add_f32 v[196:197], v[196:197], v[204:205]
    v_lshlrev_b32 v206, 16, v65
    v_and_b32 v207, s58, v65
    v_pk_add_f32 v[198:199], v[198:199], v[206:207]
    v_lshlrev_b32 v204, 16, v66
    v_and_b32 v205, s58, v66
    v_pk_add_f32 v[200:201], v[200:201], v[204:205]
    v_lshlrev_b32 v206, 16, v67
    v_and_b32 v207, s58, v67
    v_pk_add_f32 v[202:203], v[202:203], v[206:207]
    v_lshlrev_b32 v204, 16, v68
    v_and_b32 v205, s58, v68
    v_pk_add_f32 v[196:197], v[196:197], v[204:205]
    v_lshlrev_b32 v206, 16, v69
    v_and_b32 v207, s58, v69
    v_pk_add_f32 v[198:199], v[198:199], v[206:207]
    v_lshlrev_b32 v204, 16, v70
    v_and_b32 v205, s58, v70
    v_pk_add_f32 v[200:201], v[200:201], v[204:205]
    v_lshlrev_b32 v206, 16, v71
    v_and_b32 v207, s58, v71
    v_pk_add_f32 v[202:203], v[202:203], v[206:207]
    v_lshlrev_b32 v204, 16, v72
    v_and_b32 v205, s58, v72
    v_pk_add_f32 v[196:197], v[196:197], v[204:205]
    v_lshlrev_b32 v206, 16, v73
    v_and_b32 v207, s58, v73
    v_pk_add_f32 v[198:199], v[198:199], v[206:207]
    v_lshlrev_b32 v204, 16, v74
    v_and_b32 v205, s58, v74
    v_pk_add_f32 v[200:201], v[200:201], v[204:205]
    v_lshlrev_b32 v206, 16, v75
    v_and_b32 v207, s58, v75
    v_pk_add_f32 v[202:203], v[202:203], v[206:207]
    v_lshlrev_b32 v204, 16, v76
    v_and_b32 v205, s58, v76
    v_pk_add_f32 v[196:197], v[196:197], v[204:205]
    v_lshlrev_b32 v206, 16, v77
    v_and_b32 v207, s58, v77
    v_pk_add_f32 v[198:199], v[198:199], v[206:207]
    v_lshlrev_b32 v204, 16, v78
    v_and_b32 v205, s58, v78
    v_pk_add_f32 v[200:201], v[200:201], v[204:205]
    v_lshlrev_b32 v206, 16, v79
    v_and_b32 v207, s58, v79
    v_pk_add_f32 v[202:203], v[202:203], v[206:207]
    v_lshlrev_b32 v204, 16, v80
    v_and_b32 v205, s58, v80
    v_pk_add_f32 v[196:197], v[196:197], v[204:205]
    v_lshlrev_b32 v206, 16, v81
    v_and_b32 v207, s58, v81
    v_pk_add_f32 v[198:199], v[198:199], v[206:207]
    v_lshlrev_b32 v204, 16, v82
    v_and_b32 v205, s58, v82
    v_pk_add_f32 v[200:201], v[200:201], v[204:205]
    v_lshlrev_b32 v206, 16, v83
    v_and_b32 v207, s58, v83
    v_pk_add_f32 v[202:203], v[202:203], v[206:207]
    v_lshlrev_b32 v204, 16, v84
    v_and_b32 v205, s58, v84
    v_pk_add_f32 v[196:197], v[196:197], v[204:205]
    v_lshlrev_b32 v206, 16, v85
    v_and_b32 v207, s58, v85
    v_pk_add_f32 v[198:199], v[198:199], v[206:207]
    v_lshlrev_b32 v204, 16, v86
    v_and_b32 v205, s58, v86
    v_pk_add_f32 v[200:201], v[200:201], v[204:205]
    v_lshlrev_b32 v206, 16, v87
    v_and_b32 v207, s58, v87
    v_pk_add_f32 v[202:203], v[202:203], v[206:207]
    v_cvt_pk_bf16_f32 v216, v196, v197
    v_cvt_pk_bf16_f32 v217, v198, v199
    v_cvt_pk_bf16_f32 v218, v200, v201
    v_cvt_pk_bf16_f32 v219, v202, v203
    s_lshl_b32 s32, s57, 1
    s_add_u32 s32, s32, 8
    s_mul_i32 s37, s32, 37
    s_lshr_b32 s37, s37, 8
    s_mul_i32 s40, s37, 7
    s_sub_u32 s40, s32, s40
    s_mul_i32 s40, s40, 20480
    s_lshl_b32 s37, s37, 5
    s_add_u32 s40, s40, s37
    buffer_store_dwordx2 v[216:217], v2, s[72:75], s40 offen offset:0
    s_lshl_b32 s32, s57, 1
    s_add_u32 s32, s32, 9
    s_mul_i32 s37, s32, 37
    s_lshr_b32 s37, s37, 8
    s_mul_i32 s40, s37, 7
    s_sub_u32 s40, s32, s40
    s_mul_i32 s40, s40, 20480
    s_lshl_b32 s37, s37, 5
    s_add_u32 s40, s40, s37
    buffer_store_dwordx2 v[218:219], v2, s[72:75], s40 offen offset:0
    s_cmp_lg_u32 s3, 0
    s_cbranch_scc1 L_red0_done
    s_waitcnt vmcnt(4)
    v_lshlrev_b32 v196, 16, v88
    v_and_b32 v197, s58, v88
    v_lshlrev_b32 v198, 16, v89
    v_and_b32 v199, s58, v89
    v_lshlrev_b32 v200, 16, v90
    v_and_b32 v201, s58, v90
    v_lshlrev_b32 v202, 16, v91
    v_and_b32 v203, s58, v91
    v_lshlrev_b32 v204, 16, v92
    v_and_b32 v205, s58, v92
    v_pk_add_f32 v[196:197], v[196:197], v[204:205]
    v_lshlrev_b32 v206, 16, v93
    v_and_b32 v207, s58, v93
    v_pk_add_f32 v[198:199], v[198:199], v[206:207]
    v_lshlrev_b32 v204, 16, v94
    v_and_b32 v205, s58, v94
    v_pk_add_f32 v[200:201], v[200:201], v[204:205]
    v_lshlrev_b32 v206, 16, v95
    v_and_b32 v207, s58, v95
    v_pk_add_f32 v[202:203], v[202:203], v[206:207]
    v_lshlrev_b32 v204, 16, v96
    v_and_b32 v205, s58, v96
    v_pk_add_f32 v[196:197], v[196:197], v[204:205]
    v_lshlrev_b32 v206, 16, v97
    v_and_b32 v207, s58, v97
    v_pk_add_f32 v[198:199], v[198:199], v[206:207]
    v_lshlrev_b32 v204, 16, v98
    v_and_b32 v205, s58, v98
    v_pk_add_f32 v[200:201], v[200:201], v[204:205]
    v_lshlrev_b32 v206, 16, v99
    v_and_b32 v207, s58, v99
    v_pk_add_f32 v[202:203], v[202:203], v[206:207]
    v_lshlrev_b32 v204, 16, v100
    v_and_b32 v205, s58, v100
    v_pk_add_f32 v[196:197], v[196:197], v[204:205]
    v_lshlrev_b32 v206, 16, v101
    v_and_b32 v207, s58, v101
    v_pk_add_f32 v[198:199], v[198:199], v[206:207]
    v_lshlrev_b32 v204, 16, v102
    v_and_b32 v205, s58, v102
    v_pk_add_f32 v[200:201], v[200:201], v[204:205]
    v_lshlrev_b32 v206, 16, v103
    v_and_b32 v207, s58, v103
    v_pk_add_f32 v[202:203], v[202:203], v[206:207]
    v_lshlrev_b32 v204, 16, v104
    v_and_b32 v205, s58, v104
    v_pk_add_f32 v[196:197], v[196:197], v[204:205]
    v_lshlrev_b32 v206, 16, v105
    v_and_b32 v207, s58, v105
    v_pk_add_f32 v[198:199], v[198:199], v[206:207]
    v_lshlrev_b32 v204, 16, v106
    v_and_b32 v205, s58, v106
    v_pk_add_f32 v[200:201], v[200:201], v[204:205]
    v_lshlrev_b32 v206, 16, v107
    v_and_b32 v207, s58, v107
    v_pk_add_f32 v[202:203], v[202:203], v[206:207]
    v_lshlrev_b32 v204, 16, v108
    v_and_b32 v205, s58, v108
    v_pk_add_f32 v[196:197], v[196:197], v[204:205]
    v_lshlrev_b32 v206, 16, v109
    v_and_b32 v207, s58, v109
    v_pk_add_f32 v[198:199], v[198:199], v[206:207]
    v_lshlrev_b32 v204, 16, v110
    v_and_b32 v205, s58, v110
    v_pk_add_f32 v[200:201], v[200:201], v[204:205]
    v_lshlrev_b32 v206, 16, v111
    v_and_b32 v207, s58, v111
    v_pk_add_f32 v[202:203], v[202:203], v[206:207]
    v_lshlrev_b32 v204, 16, v112
    v_and_b32 v205, s58, v112
    v_pk_add_f32 v[196:197], v[196:197], v[204:205]
    v_lshlrev_b32 v206, 16, v113
    v_and_b32 v207, s58, v113
    v_pk_add_f32 v[198:199], v[198:199], v[206:207]
    v_lshlrev_b32 v204, 16, v114
    v_and_b32 v205, s58, v114
    v_pk_add_f32 v[200:201], v[200:201], v[204:205]
    v_lshlrev_b32 v206, 16, v115
    v_and_b32 v207, s58, v115
    v_pk_add_f32 v[202:203], v[202:203], v[206:207]
    v_lshlrev_b32 v204, 16, v116
    v_and_b32 v205, s58, v116
    v_pk_add_f32 v[196:197], v[196:197], v[204:205]
    v_lshlrev_b32 v206, 16, v117
    v_and_b32 v207, s58, v117
    v_pk_add_f32 v[198:199], v[198:199], v[206:207]
    v_lshlrev_b32 v204, 16, v118
    v_and_b32 v205, s58, v118
    v_pk_add_f32 v[200:201], v[200:201], v[204:205]
    v_lshlrev_b32 v206, 16, v119
    v_and_b32 v207, s58, v119
    v_pk_add_f32 v[202:203], v[202:203], v[206:207]
    v_cvt_pk_bf16_f32 v220, v196, v197
    v_cvt_pk_bf16_f32 v221, v198, v199
    v_cvt_pk_bf16_f32 v222, v200, v201
    v_cvt_pk_bf16_f32 v223, v202, v203
    s_lshl_b32 s32, s57, 1
    s_add_u32 s32, s32, 16
    s_mul_i32 s37, s32, 37
    s_lshr_b32 s37, s37, 8
    s_mul_i32 s40, s37, 7
    s_sub_u32 s40, s32, s40
    s_mul_i32 s40, s40, 20480
    s_lshl_b32 s37, s37, 5
    s_add_u32 s40, s40, s37
    buffer_store_dwordx2 v[220:221], v2, s[72:75], s40 offen offset:0
    s_lshl_b32 s32, s57, 1
    s_add_u32 s32, s32, 17
    s_mul_i32 s37, s32, 37
    s_lshr_b32 s37, s37, 8
    s_mul_i32 s40, s37, 7
    s_sub_u32 s40, s32, s40
    s_mul_i32 s40, s40, 20480
    s_lshl_b32 s37, s37, 5
    s_add_u32 s40, s40, s37
    s_bitcmp1_b32 s97, 0
    s_cbranch_scc1 L_red0_done
    buffer_store_dwordx2 v[222:223], v2, s[72:75], s40 offen offset:0
L_red0_done:
    s_mov_b32 s48, 0
L_pollp1:
    buffer_load_dword v1, v3, s[68:71], s39 offen offset:32 sc1
    s_waitcnt vmcnt(0)
    v_cmp_ne_u32 vcc, 1, v1
    s_nop 0
    s_cbranch_vccz L_pollp1_done
    s_sleep 1
    s_add_u32 s48, s48, 1
    s_cmp_lt_u32 s48, 200000
    s_cbranch_scc1 L_pollp1
L_pollp1_done:
    s_mov_b32 s37, 143360
    buffer_load_dwordx4 v[24:27], v4, s[64:67], s37 offen sc1
    s_mov_b32 s37, 161280
    buffer_load_dwordx4 v[28:31], v4, s[64:67], s37 offen sc1
    s_mov_b32 s37, 179200
    buffer_load_dwordx4 v[32:35], v4, s[64:67], s37 offen sc1
    s_mov_b32 s37, 197120
    buffer_load_dwordx4 v[36:39], v4, s[64:67], s37 offen sc1
    s_mov_b32 s37, 215040
    buffer_load_dwordx4 v[40:43], v4, s[64:67], s37 offen sc1
    s_mov_b32 s37, 232960
    buffer_load_dwordx4 v[44:47], v4, s[64:67], s37 offen sc1
    s_mov_b32 s37, 250880
    buffer_load_dwordx4 v[48:51], v4, s[64:67], s37 offen sc1
    s_mov_b32 s37, 268800
    buffer_load_dwordx4 v[52:55], v4, s[64:67], s37 offen sc1
    s_mov_b32 s37, 147456
    buffer_load_dwordx4 v[56:59], v4, s[64:67], s37 offen sc1
    s_mov_b32 s37, 165376
    buffer_load_dwordx4 v[60:63], v4, s[64:67], s37 offen sc1
    s_mov_b32 s37, 183296
    buffer_load_dwordx4 v[64:67], v4, s[64:67], s37 offen sc1
    s_mov_b32 s37, 201216
    buffer_load_dwordx4 v[68:71], v4, s[64:67], s37 offen sc1
    s_mov_b32 s37, 219136
    buffer_load_dwordx4 v[72:75], v4, s[64:67], s37 offen sc1
    s_mov_b32 s37, 237056
    buffer_load_dwordx4 v[76:79], v4, s[64:67], s37 offen sc1
    s_mov_b32 s37, 254976
    buffer_load_dwordx4 v[80:83], v4, s[64:67], s37 offen sc1
    s_mov_b32 s37, 272896
    buffer_load_dwordx4 v[84:87], v4, s[64:67], s37 offen sc1
    s_mov_b32 s37, 151552
    buffer_load_dwordx4 v[88:91], v5, s[64:67], s37 offen sc1
    s_mov_b32 s37, 169472
    buffer_load_dwordx4 v[92:95], v5, s[64:67], s37 offen sc1
    s_mov_b32 s37, 187392
    buffer_load_dwordx4 v[96:99], v5, s[64:67], s37 offen sc1
    s_mov_b32 s37, 205312
    buffer_load_dwordx4 v[100:103], v5, s[64:67], s37 offen sc1
    s_mov_b32 s37, 223232
    buffer_load_dwordx4 v[104:107], v5, s[64:67], s37 offen sc1
    s_mov_b32 s37, 241152
    buffer_load_dwordx4 v[108:111], v5, s[64:67], s37 offen sc1
    s_mov_b32 s37, 259072
    buffer_load_dwordx4 v[112:115], v5, s[64:67], s37 offen sc1
    s_mov_b32 s37, 276992
    buffer_load_dwordx4 v[116:119], v5, s[64:67], s37 offen sc1
    s_waitcnt vmcnt(16)
    v_lshlrev_b32 v196, 16, v24
    v_and_b32 v197, s58, v24
    v_lshlrev_b32 v198, 16, v25
    v_and_b32 v199, s58, v25
    v_lshlrev_b32 v200, 16, v26
    v_and_b32 v201, s58, v26
    v_lshlrev_b32 v202, 16, v27
    v_and_b32 v203, s58, v27
    v_lshlrev_b32 v204, 16, v28
    v_and_b32 v205, s58, v28
    v_pk_add_f32 v[196:197], v[196:197], v[204:205]
    v_lshlrev_b32 v206, 16, v29
    v_and_b32 v207, s58, v29
    v_pk_add_f32 v[198:199], v[198:199], v[206:207]
    v_lshlrev_b32 v204, 16, v30
    v_and_b32 v205, s58, v30
    v_pk_add_f32 v[200:201], v[200:201], v[204:205]
    v_lshlrev_b32 v206, 16, v31
    v_and_b32 v207, s58, v31
    v_pk_add_f32 v[202:203], v[202:203], v[206:207]
    v_lshlrev_b32 v204, 16, v32
    v_and_b32 v205, s58, v32
    v_pk_add_f32 v[196:197], v[196:197], v[204:205]
    v_lshlrev_b32 v206, 16, v33
    v_and_b32 v207, s58, v33
    v_pk_add_f32 v[198:199], v[198:199], v[206:207]
    v_lshlrev_b32 v204, 16, v34
    v_and_b32 v205, s58, v34
    v_pk_add_f32 v[200:201], v[200:201], v[204:205]
    v_lshlrev_b32 v206, 16, v35
    v_and_b32 v207, s58, v35
    v_pk_add_f32 v[202:203], v[202:203], v[206:207]
    v_lshlrev_b32 v204, 16, v36
    v_and_b32 v205, s58, v36
    v_pk_add_f32 v[196:197], v[196:197], v[204:205]
    v_lshlrev_b32 v206, 16, v37
    v_and_b32 v207, s58, v37
    v_pk_add_f32 v[198:199], v[198:199], v[206:207]
    v_lshlrev_b32 v204, 16, v38
    v_and_b32 v205, s58, v38
    v_pk_add_f32 v[200:201], v[200:201], v[204:205]
    v_lshlrev_b32 v206, 16, v39
    v_and_b32 v207, s58, v39
    v_pk_add_f32 v[202:203], v[202:203], v[206:207]
    v_lshlrev_b32 v204, 16, v40
    v_and_b32 v205, s58, v40
    v_pk_add_f32 v[196:197], v[196:197], v[204:205]
    v_lshlrev_b32 v206, 16, v41
    v_and_b32 v207, s58, v41
    v_pk_add_f32 v[198:199], v[198:199], v[206:207]
    v_lshlrev_b32 v204, 16, v42
    v_and_b32 v205, s58, v42
    v_pk_add_f32 v[200:201], v[200:201], v[204:205]
    v_lshlrev_b32 v206, 16, v43
    v_and_b32 v207, s58, v43
    v_pk_add_f32 v[202:203], v[202:203], v[206:207]
    v_lshlrev_b32 v204, 16, v44
    v_and_b32 v205, s58, v44
    v_pk_add_f32 v[196:197], v[196:197], v[204:205]
    v_lshlrev_b32 v206, 16, v45
    v_and_b32 v207, s58, v45
    v_pk_add_f32 v[198:199], v[198:199], v[206:207]
    v_lshlrev_b32 v204, 16, v46
    v_and_b32 v205, s58, v46
    v_pk_add_f32 v[200:201], v[200:201], v[204:205]
    v_lshlrev_b32 v206, 16, v47
    v_and_b32 v207, s58, v47
    v_pk_add_f32 v[202:203], v[202:203], v[206:207]
    v_lshlrev_b32 v204, 16, v48
    v_and_b32 v205, s58, v48
    v_pk_add_f32 v[196:197], v[196:197], v[204:205]
    v_lshlrev_b32 v206, 16, v49
    v_and_b32 v207, s58, v49
    v_pk_add_f32 v[198:199], v[198:199], v[206:207]
    v_lshlrev_b32 v204, 16, v50
    v_and_b32 v205, s58, v50
    v_pk_add_f32 v[200:201], v[200:201], v[204:205]
    v_lshlrev_b32 v206, 16, v51
    v_and_b32 v207, s58, v51
    v_pk_add_f32 v[202:203], v[202:203], v[206:207]
    v_lshlrev_b32 v204, 16, v52
    v_and_b32 v205, s58, v52
    v_pk_add_f32 v[196:197], v[196:197], v[204:205]
    v_lshlrev_b32 v206, 16, v53
    v_and_b32 v207, s58, v53
    v_pk_add_f32 v[198:199], v[198:199], v[206:207]
    v_lshlrev_b32 v204, 16, v54
    v_and_b32 v205, s58, v54
    v_pk_add_f32 v[200:201], v[200:201], v[204:205]
    v_lshlrev_b32 v206, 16, v55
    v_and_b32 v207, s58, v55
    v_pk_add_f32 v[202:203], v[202:203], v[206:207]
    v_cvt_pk_bf16_f32 v212, v196, v197
    v_cvt_pk_bf16_f32 v213, v198, v199
    v_cvt_pk_bf16_f32 v214, v200, v201
    v_cvt_pk_bf16_f32 v215, v202, v203
    s_lshl_b32 s32, s57, 1
    s_add_u32 s32, s32, 0
    s_mul_i32 s37, s32, 37
    s_lshr_b32 s37, s37, 8
    s_mul_i32 s40, s37, 7
    s_sub_u32 s40, s32, s40
    s_mul_i32 s40, s40, 20480
    s_lshl_b32 s37, s37, 5
    s_add_u32 s40, s40, s37
    buffer_store_dwordx2 v[212:213], v2, s[72:75], s40 offen offset:160
    s_lshl_b32 s32, s57, 1
    s_add_u32 s32, s32, 1
    s_mul_i32 s37, s32, 37
    s_lshr_b32 s37, s37, 8
    s_mul_i32 s40, s37, 7
    s_sub_u32 s40, s32, s40
    s_mul_i32 s40, s40, 20480
    s_lshl_b32 s37, s37, 5
    s_add_u32 s40, s40, s37
    buffer_store_dwordx2 v[214:215], v2, s[72:75], s40 offen offset:160
    s_waitcnt vmcnt(10)
    v_lshlrev_b32 v196, 16, v56
    v_and_b32 v197, s58, v56
    v_lshlrev_b32 v198, 16, v57
    v_and_b32 v199, s58, v57
    v_lshlrev_b32 v200, 16, v58
    v_and_b32 v201, s58, v58
    v_lshlrev_b32 v202, 16, v59
    v_and_b32 v203, s58, v59
    v_lshlrev_b32 v204, 16, v60
    v_and_b32 v205, s58, v60
    v_pk_add_f32 v[196:197], v[196:197], v[204:205]
    v_lshlrev_b32 v206, 16, v61
    v_and_b32 v207, s58, v61
    v_pk_add_f32 v[198:199], v[198:199], v[206:207]
    v_lshlrev_b32 v204, 16, v62
    v_and_b32 v205, s58, v62
    v_pk_add_f32 v[200:201], v[200:201], v[204:205]
    v_lshlrev_b32 v206, 16, v63
    v_and_b32 v207, s58, v63
    v_pk_add_f32 v[202:203], v[202:203], v[206:207]
    v_lshlrev_b32 v204, 16, v64
    v_and_b32 v205, s58, v64
    v_pk_add_f32 v[196:197], v[196:197], v[204:205]
    v_lshlrev_b32 v206, 16, v65
    v_and_b32 v207, s58, v65
    v_pk_add_f32 v[198:199], v[198:199], v[206:207]
    v_lshlrev_b32 v204, 16, v66
    v_and_b32 v205, s58, v66
    v_pk_add_f32 v[200:201], v[200:201], v[204:205]
    v_lshlrev_b32 v206, 16, v67
    v_and_b32 v207, s58, v67
    v_pk_add_f32 v[202:203], v[202:203], v[206:207]
    v_lshlrev_b32 v204, 16, v68
    v_and_b32 v205, s58, v68
    v_pk_add_f32 v[196:197], v[196:197], v[204:205]
    v_lshlrev_b32 v206, 16, v69
    v_and_b32 v207, s58, v69
    v_pk_add_f32 v[198:199], v[198:199], v[206:207]
    v_lshlrev_b32 v204, 16, v70
    v_and_b32 v205, s58, v70
    v_pk_add_f32 v[200:201], v[200:201], v[204:205]
    v_lshlrev_b32 v206, 16, v71
    v_and_b32 v207, s58, v71
    v_pk_add_f32 v[202:203], v[202:203], v[206:207]
    v_lshlrev_b32 v204, 16, v72
    v_and_b32 v205, s58, v72
    v_pk_add_f32 v[196:197], v[196:197], v[204:205]
    v_lshlrev_b32 v206, 16, v73
    v_and_b32 v207, s58, v73
    v_pk_add_f32 v[198:199], v[198:199], v[206:207]
    v_lshlrev_b32 v204, 16, v74
    v_and_b32 v205, s58, v74
    v_pk_add_f32 v[200:201], v[200:201], v[204:205]
    v_lshlrev_b32 v206, 16, v75
    v_and_b32 v207, s58, v75
    v_pk_add_f32 v[202:203], v[202:203], v[206:207]
    v_lshlrev_b32 v204, 16, v76
    v_and_b32 v205, s58, v76
    v_pk_add_f32 v[196:197], v[196:197], v[204:205]
    v_lshlrev_b32 v206, 16, v77
    v_and_b32 v207, s58, v77
    v_pk_add_f32 v[198:199], v[198:199], v[206:207]
    v_lshlrev_b32 v204, 16, v78
    v_and_b32 v205, s58, v78
    v_pk_add_f32 v[200:201], v[200:201], v[204:205]
    v_lshlrev_b32 v206, 16, v79
    v_and_b32 v207, s58, v79
    v_pk_add_f32 v[202:203], v[202:203], v[206:207]
    v_lshlrev_b32 v204, 16, v80
    v_and_b32 v205, s58, v80
    v_pk_add_f32 v[196:197], v[196:197], v[204:205]
    v_lshlrev_b32 v206, 16, v81
    v_and_b32 v207, s58, v81
    v_pk_add_f32 v[198:199], v[198:199], v[206:207]
    v_lshlrev_b32 v204, 16, v82
    v_and_b32 v205, s58, v82
    v_pk_add_f32 v[200:201], v[200:201], v[204:205]
    v_lshlrev_b32 v206, 16, v83
    v_and_b32 v207, s58, v83
    v_pk_add_f32 v[202:203], v[202:203], v[206:207]
    v_lshlrev_b32 v204, 16, v84
    v_and_b32 v205, s58, v84
    v_pk_add_f32 v[196:197], v[196:197], v[204:205]
    v_lshlrev_b32 v206, 16, v85
    v_and_b32 v207, s58, v85
    v_pk_add_f32 v[198:199], v[198:199], v[206:207]
    v_lshlrev_b32 v204, 16, v86
    v_and_b32 v205, s58, v86
    v_pk_add_f32 v[200:201], v[200:201], v[204:205]
    v_lshlrev_b32 v206, 16, v87
    v_and_b32 v207, s58, v87
    v_pk_add_f32 v[202:203], v[202:203], v[206:207]
    v_cvt_pk_bf16_f32 v216, v196, v197
    v_cvt_pk_bf16_f32 v217, v198, v199
    v_cvt_pk_bf16_f32 v218, v200, v201
    v_cvt_pk_bf16_f32 v219, v202, v203
    s_lshl_b32 s32, s57, 1
    s_add_u32 s32, s32, 8
    s_mul_i32 s37, s32, 37
    s_lshr_b32 s37, s37, 8
    s_mul_i32 s40, s37, 7
    s_sub_u32 s40, s32, s40
    s_mul_i32 s40, s40, 20480
    s_lshl_b32 s37, s37, 5
    s_add_u32 s40, s40, s37
    buffer_store_dwordx2 v[216:217], v2, s[72:75], s40 offen offset:160
    s_lshl_b32 s32, s57, 1
    s_add_u32 s32, s32, 9
    s_mul_i32 s37, s32, 37
    s_lshr_b32 s37, s37, 8
    s_mul_i32 s40, s37, 7
    s_sub_u32 s40, s32, s40
    s_mul_i32 s40, s40, 20480
    s_lshl_b32 s37, s37, 5
    s_add_u32 s40, s40, s37
    buffer_store_dwordx2 v[218:219], v2, s[72:75], s40 offen offset:160
    s_cmp_lg_u32 s3, 0
    s_cbranch_scc1 L_red1_done
    s_waitcnt vmcnt(4)
    v_lshlrev_b32 v196, 16, v88
    v_and_b32 v197, s58, v88
    v_lshlrev_b32 v198, 16, v89
    v_and_b32 v199, s58, v89
    v_lshlrev_b32 v200, 16, v90
    v_and_b32 v201, s58, v90
    v_lshlrev_b32 v202, 16, v91
    v_and_b32 v203, s58, v91
    v_lshlrev_b32 v204, 16, v92
    v_and_b32 v205, s58, v92
    v_pk_add_f32 v[196:197], v[196:197], v[204:205]
    v_lshlrev_b32 v206, 16, v93
    v_and_b32 v207, s58, v93
    v_pk_add_f32 v[198:199], v[198:199], v[206:207]
    v_lshlrev_b32 v204, 16, v94
    v_and_b32 v205, s58, v94
    v_pk_add_f32 v[200:201], v[200:201], v[204:205]
    v_lshlrev_b32 v206, 16, v95
    v_and_b32 v207, s58, v95
    v_pk_add_f32 v[202:203], v[202:203], v[206:207]
    v_lshlrev_b32 v204, 16, v96
    v_and_b32 v205, s58, v96
    v_pk_add_f32 v[196:197], v[196:197], v[204:205]
    v_lshlrev_b32 v206, 16, v97
    v_and_b32 v207, s58, v97
    v_pk_add_f32 v[198:199], v[198:199], v[206:207]
    v_lshlrev_b32 v204, 16, v98
    v_and_b32 v205, s58, v98
    v_pk_add_f32 v[200:201], v[200:201], v[204:205]
    v_lshlrev_b32 v206, 16, v99
    v_and_b32 v207, s58, v99
    v_pk_add_f32 v[202:203], v[202:203], v[206:207]
    v_lshlrev_b32 v204, 16, v100
    v_and_b32 v205, s58, v100
    v_pk_add_f32 v[196:197], v[196:197], v[204:205]
    v_lshlrev_b32 v206, 16, v101
    v_and_b32 v207, s58, v101
    v_pk_add_f32 v[198:199], v[198:199], v[206:207]
    v_lshlrev_b32 v204, 16, v102
    v_and_b32 v205, s58, v102
    v_pk_add_f32 v[200:201], v[200:201], v[204:205]
    v_lshlrev_b32 v206, 16, v103
    v_and_b32 v207, s58, v103
    v_pk_add_f32 v[202:203], v[202:203], v[206:207]
    v_lshlrev_b32 v204, 16, v104
    v_and_b32 v205, s58, v104
    v_pk_add_f32 v[196:197], v[196:197], v[204:205]
    v_lshlrev_b32 v206, 16, v105
    v_and_b32 v207, s58, v105
    v_pk_add_f32 v[198:199], v[198:199], v[206:207]
    v_lshlrev_b32 v204, 16, v106
    v_and_b32 v205, s58, v106
    v_pk_add_f32 v[200:201], v[200:201], v[204:205]
    v_lshlrev_b32 v206, 16, v107
    v_and_b32 v207, s58, v107
    v_pk_add_f32 v[202:203], v[202:203], v[206:207]
    v_lshlrev_b32 v204, 16, v108
    v_and_b32 v205, s58, v108
    v_pk_add_f32 v[196:197], v[196:197], v[204:205]
    v_lshlrev_b32 v206, 16, v109
    v_and_b32 v207, s58, v109
    v_pk_add_f32 v[198:199], v[198:199], v[206:207]
    v_lshlrev_b32 v204, 16, v110
    v_and_b32 v205, s58, v110
    v_pk_add_f32 v[200:201], v[200:201], v[204:205]
    v_lshlrev_b32 v206, 16, v111
    v_and_b32 v207, s58, v111
    v_pk_add_f32 v[202:203], v[202:203], v[206:207]
    v_lshlrev_b32 v204, 16, v112
    v_and_b32 v205, s58, v112
    v_pk_add_f32 v[196:197], v[196:197], v[204:205]
    v_lshlrev_b32 v206, 16, v113
    v_and_b32 v207, s58, v113
    v_pk_add_f32 v[198:199], v[198:199], v[206:207]
    v_lshlrev_b32 v204, 16, v114
    v_and_b32 v205, s58, v114
    v_pk_add_f32 v[200:201], v[200:201], v[204:205]
    v_lshlrev_b32 v206, 16, v115
    v_and_b32 v207, s58, v115
    v_pk_add_f32 v[202:203], v[202:203], v[206:207]
    v_lshlrev_b32 v204, 16, v116
    v_and_b32 v205, s58, v116
    v_pk_add_f32 v[196:197], v[196:197], v[204:205]
    v_lshlrev_b32 v206, 16, v117
    v_and_b32 v207, s58, v117
    v_pk_add_f32 v[198:199], v[198:199], v[206:207]
    v_lshlrev_b32 v204, 16, v118
    v_and_b32 v205, s58, v118
    v_pk_add_f32 v[200:201], v[200:201], v[204:205]
    v_lshlrev_b32 v206, 16, v119
    v_and_b32 v207, s58, v119
    v_pk_add_f32 v[202:203], v[202:203], v[206:207]
    v_cvt_pk_bf16_f32 v220, v196, v197
    v_cvt_pk_bf16_f32 v221, v198, v199
    v_cvt_pk_bf16_f32 v222, v200, v201
    v_cvt_pk_bf16_f32 v223, v202, v203
    s_lshl_b32 s32, s57, 1
    s_add_u32 s32, s32, 16
    s_mul_i32 s37, s32, 37
    s_lshr_b32 s37, s37, 8
    s_mul_i32 s40, s37, 7
    s_sub_u32 s40, s32, s40
    s_mul_i32 s40, s40, 20480
    s_lshl_b32 s37, s37, 5
    s_add_u32 s40, s40, s37
    buffer_store_dwordx2 v[220:221], v2, s[72:75], s40 offen offset:160
    s_lshl_b32 s32, s57, 1
    s_add_u32 s32, s32, 17
    s_mul_i32 s37, s32, 37
    s_lshr_b32 s37, s37, 8
    s_mul_i32 s40, s37, 7
    s_sub_u32 s40, s32, s40
    s_mul_i32 s40, s40, 20480
    s_lshl_b32 s37, s37, 5
    s_add_u32 s40, s40, s37
    s_bitcmp1_b32 s97, 0
    s_cbranch_scc1 L_red1_done
    buffer_store_dwordx2 v[222:223], v2, s[72:75], s40 offen offset:160
L_red1_done:
L_end:
    s_endpgm
L_slowP:
    s_nop 1
    s_mov_b32 s50, 2
    s_movk_i32 s32, 8192
    s_branch L_slow_body
L_slowE:
    s_nop 1
    v_swap_b32 v240, v247
    v_swap_b32 v241, v248
    v_swap_b32 v242, v249
    v_swap_b32 v243, v250
    v_swap_b32 v244, v251
    v_swap_b32 v245, v252
    v_swap_b32 v246, v253
    s_mov_b32 s50, 0
    s_lshl_b32 s32, s41, 13
    s_branch L_slow_body
L_slowO:
    s_nop 1
    s_mov_b32 s50, 1
    s_lshl_b32 s32, s41, 13
    s_add_u32 s32, s32, 8192
L_slow_body:
    v_and_b32 v18, 15, v0
    v_lshrrev_b32 v19, 4, v0
    v_lshlrev_b32 v18, 8, v18
    v_lshl_add_u32 v18, v19, 6, v18
    s_add_u32 s39, s32, 4096
    s_nop 7
    buffer_load_dwordx4 v[136:139], v18, s[12:15], s32 offen offset:0
    buffer_load_dwordx4 v[140:143], v18, s[12:15], s32 offen offset:16
    buffer_load_dwordx4 v[144:147], v18, s[12:15], s32 offen offset:32
    buffer_load_dwordx4 v[148:151], v18, s[12:15], s32 offen offset:48
    buffer_load_dwordx4 v[152:155], v18, s[12:15], s39 offen offset:0
    buffer_load_dwordx4 v[156:159], v18, s[12:15], s39 offen offset:16
    buffer_load_dwordx4 v[160:163], v18, s[12:15], s39 offen offset:32
    buffer_load_dwordx4 v[164:167], v18, s[12:15], s39 offen offset:48
    s_waitcnt vmcnt(0)
    v_mfma_f32_16x16x32_bf16 v[168:171], v[136:139], v[24:27], 0
    v_mfma_f32_16x16x32_bf16 v[168:171], v[140:143], v[28:31], v[168:171]
    v_mfma_f32_16x16x32_bf16 v[168:171], v[144:147], v[32:35], v[168:171]
    v_mfma_f32_16x16x32_bf16 v[168:171], v[148:151], v[36:39], v[168:171]
    v_mfma_f32_16x16x32_bf16 v[172:175], v[152:155], v[24:27], 0
    v_mfma_f32_16x16x32_bf16 v[172:175], v[156:159], v[28:31], v[172:175]
    v_mfma_f32_16x16x32_bf16 v[172:175], v[160:163], v[32:35], v[172:175]
    v_mfma_f32_16x16x32_bf16 v[172:175], v[164:167], v[36:39], v[172:175]
    v_mfma_f32_16x16x32_bf16 v[176:179], v[136:139], v[40:43], 0
    s_nop 2
    v_max3_f32 v18, v168, v169, v170
    s_nop 2
    v_max3_f32 v18, v18, v171, v172
    v_max3_f32 v18, v18, v173, v174
    v_max_f32 v18, v18, v175
    v_mov_b32 v19, v18
    s_nop 1
    v_permlane16_swap_b32 v18, v19
    v_max_f32 v18, v18, v19
    v_mov_b32 v19, v18
    s_nop 1
    v_permlane32_swap_b32 v18, v19
    v_max_f32 v18, v18, v19
    v_sub_f32 v18, 0, v18
    v_min_f32 v18, v18, v212
    v_sub_f32 v19, v18, v212
    v_exp_f32 v19, v19
    v_mov_b32 v212, v18
    v_mov_b32 v213, v18
    v_mov_b32 v214, v18
    v_mov_b32 v215, v18
    v_mfma_f32_16x16x32_bf16 v[176:179], v[140:143], v[44:47], v[176:179]
    v_mul_f32 v240, v240, v19
    v_accvgpr_read_b32 v20, a0
    v_mul_f32 v20, v20, v19
    v_accvgpr_write_b32 a0, v20
    v_accvgpr_read_b32 v21, a1
    v_mul_f32 v21, v21, v19
    v_accvgpr_write_b32 a1, v21
    v_accvgpr_read_b32 v20, a2
    v_mul_f32 v20, v20, v19
    v_accvgpr_write_b32 a2, v20
    v_accvgpr_read_b32 v21, a3
    v_mul_f32 v21, v21, v19
    v_accvgpr_write_b32 a3, v21
    v_accvgpr_read_b32 v20, a28
    v_mul_f32 v20, v20, v19
    v_accvgpr_write_b32 a28, v20
    v_accvgpr_read_b32 v21, a29
    v_mul_f32 v21, v21, v19
    v_mfma_f32_16x16x32_bf16 v[176:179], v[144:147], v[48:51], v[176:179]
    v_accvgpr_write_b32 a29, v21
    v_accvgpr_read_b32 v20, a30
    v_mul_f32 v20, v20, v19
    v_accvgpr_write_b32 a30, v20
    v_accvgpr_read_b32 v21, a31
    v_mul_f32 v21, v21, v19
    v_accvgpr_write_b32 a31, v21
    v_accvgpr_read_b32 v20, a56
    v_mul_f32 v20, v20, v19
    v_accvgpr_write_b32 a56, v20
    v_accvgpr_read_b32 v21, a57
    v_mul_f32 v21, v21, v19
    v_accvgpr_write_b32 a57, v21
    v_accvgpr_read_b32 v20, a58
    v_mul_f32 v20, v20, v19
    v_accvgpr_write_b32 a58, v20
    v_accvgpr_read_b32 v21, a59
    v_mul_f32 v21, v21, v19
    v_mfma_f32_16x16x32_bf16 v[176:179], v[148:151], v[52:55], v[176:179]
    v_accvgpr_write_b32 a59, v21
    v_accvgpr_read_b32 v20, a84
    v_mul_f32 v20, v20, v19
    v_accvgpr_write_b32 a84, v20
    v_accvgpr_read_b32 v21, a85
    v_mul_f32 v21, v21, v19
    v_accvgpr_write_b32 a85, v21
    v_accvgpr_read_b32 v20, a86
    v_mul_f32 v20, v20, v19
    v_accvgpr_write_b32 a86, v20
    v_accvgpr_read_b32 v21, a87
    v_mul_f32 v21, v21, v19
    v_accvgpr_write_b32 a87, v21
    v_accvgpr_read_b32 v20, a112
    v_mul_f32 v20, v20, v19
    v_accvgpr_write_b32 a112, v20
    v_accvgpr_read_b32 v21, a113
    v_mul_f32 v21, v21, v19
    v_mfma_f32_16x16x32_bf16 v[180:183], v[152:155], v[40:43], 0
    v_accvgpr_write_b32 a113, v21
    v_accvgpr_read_b32 v20, a114
    v_mul_f32 v20, v20, v19
    v_accvgpr_write_b32 a114, v20
    v_accvgpr_read_b32 v21, a115
    v_mul_f32 v21, v21, v19
    v_accvgpr_write_b32 a115, v21
    v_accvgpr_read_b32 v20, a140
    v_mul_f32 v20, v20, v19
    v_accvgpr_write_b32 a140, v20
    v_accvgpr_read_b32 v21, a141
    v_mul_f32 v21, v21, v19
    v_accvgpr_write_b32 a141, v21
    v_accvgpr_read_b32 v20, a142
    v_mul_f32 v20, v20, v19
    v_accvgpr_write_b32 a142, v20
    v_accvgpr_read_b32 v21, a143
    v_mul_f32 v21, v21, v19
    v_mfma_f32_16x16x32_bf16 v[180:183], v[156:159], v[44:47], v[180:183]
    v_accvgpr_write_b32 a143, v21
    v_accvgpr_read_b32 v20, a168
    v_mul_f32 v20, v20, v19
    v_accvgpr_write_b32 a168, v20
    v_accvgpr_read_b32 v21, a169
    v_mul_f32 v21, v21, v19
    v_accvgpr_write_b32 a169, v21
    v_accvgpr_read_b32 v20, a170
    v_mul_f32 v20, v20, v19
    v_accvgpr_write_b32 a170, v20
    v_accvgpr_read_b32 v21, a171
    v_mul_f32 v21, v21, v19
    v_accvgpr_write_b32 a171, v21
    v_accvgpr_read_b32 v20, a196
    v_mul_f32 v20, v20, v19
    v_accvgpr_write_b32 a196, v20
    v_accvgpr_read_b32 v21, a197
    v_mul_f32 v21, v21, v19
    v_mfma_f32_16x16x32_bf16 v[180:183], v[160:163], v[48:51], v[180:183]
    v_accvgpr_write_b32 a197, v21
    v_accvgpr_read_b32 v20, a198
    v_mul_f32 v20, v20, v19
    v_accvgpr_write_b32 a198, v20
    v_accvgpr_read_b32 v21, a199
    v_mul_f32 v21, v21, v19
    v_accvgpr_write_b32 a199, v21
    v_add_f32 v168, v168, v212
    v_add_f32 v169, v169, v212
    v_add_f32 v170, v170, v212
    v_add_f32 v171, v171, v212
    v_add_f32 v172, v172, v212
    v_add_f32 v173, v173, v212
    v_add_f32 v174, v174, v212
    v_add_f32 v175, v175, v212
    v_exp_f32 v168, v168
    v_exp_f32 v169, v169
    v_exp_f32 v170, v170
    v_mfma_f32_16x16x32_bf16 v[180:183], v[164:167], v[52:55], v[180:183]
    v_add_f32 v20, v168, v169
    v_exp_f32 v171, v171
    v_exp_f32 v172, v172
    v_add_f32 v21, v170, v171
    v_exp_f32 v173, v173
    v_add_f32 v20, v20, v21
    v_exp_f32 v174, v174
    v_add_f32 v22, v172, v173
    v_exp_f32 v175, v175
    v_add_f32 v20, v20, v240
    v_cvt_pk_bf16_f32 v184, v168, v169
    v_add_f32 v247, v174, v175
    v_cvt_pk_bf16_f32 v185, v170, v171
    v_add_f32 v247, v247, v22
    v_cvt_pk_bf16_f32 v186, v172, v173
    v_add_f32 v247, v247, v20
    v_cvt_pk_bf16_f32 v187, v174, v175
    v_mfma_f32_16x16x32_bf16 v[168:171], v[136:139], v[56:59], 0
    v_max3_f32 v18, v176, v177, v178
    v_max3_f32 v18, v18, v179, v180
    v_max3_f32 v18, v18, v181, v182
    v_max_f32 v18, v18, v183
    v_mov_b32 v19, v18
    s_nop 1
    v_permlane16_swap_b32 v18, v19
    v_max_f32 v18, v18, v19
    v_mov_b32 v19, v18
    s_nop 1
    v_permlane32_swap_b32 v18, v19
    v_max_f32 v18, v18, v19
    v_sub_f32 v18, 0, v18
    v_min_f32 v18, v18, v216
    v_sub_f32 v19, v18, v216
    v_exp_f32 v19, v19
    v_mov_b32 v216, v18
    v_mov_b32 v217, v18
    v_mov_b32 v218, v18
    v_mov_b32 v219, v18
    v_mfma_f32_16x16x32_bf16 v[168:171], v[140:143], v[60:63], v[168:171]
    v_mul_f32 v241, v241, v19
    v_accvgpr_read_b32 v20, a4
    v_mul_f32 v20, v20, v19
    v_accvgpr_write_b32 a4, v20
    v_accvgpr_read_b32 v21, a5
    v_mul_f32 v21, v21, v19
    v_accvgpr_write_b32 a5, v21
    v_accvgpr_read_b32 v20, a6
    v_mul_f32 v20, v20, v19
    v_accvgpr_write_b32 a6, v20
    v_accvgpr_read_b32 v21, a7
    v_mul_f32 v21, v21, v19
    v_accvgpr_write_b32 a7, v21
    v_accvgpr_read_b32 v20, a32
    v_mul_f32 v20, v20, v19
    v_accvgpr_write_b32 a32, v20
    v_accvgpr_read_b32 v21, a33
    v_mul_f32 v21, v21, v19
    v_mfma_f32_16x16x32_bf16 v[168:171], v[144:147], v[64:67], v[168:171]
    v_accvgpr_write_b32 a33, v21
    v_accvgpr_read_b32 v20, a34
    v_mul_f32 v20, v20, v19
    v_accvgpr_write_b32 a34, v20
    v_accvgpr_read_b32 v21, a35
    v_mul_f32 v21, v21, v19
    v_accvgpr_write_b32 a35, v21
    v_accvgpr_read_b32 v20, a60
    v_mul_f32 v20, v20, v19
    v_accvgpr_write_b32 a60, v20
    v_accvgpr_read_b32 v21, a61
    v_mul_f32 v21, v21, v19
    v_accvgpr_write_b32 a61, v21
    v_accvgpr_read_b32 v20, a62
    v_mul_f32 v20, v20, v19
    v_accvgpr_write_b32 a62, v20
    v_accvgpr_read_b32 v21, a63
    v_mul_f32 v21, v21, v19
    v_mfma_f32_16x16x32_bf16 v[168:171], v[148:151], v[68:71], v[168:171]
    v_accvgpr_write_b32 a63, v21
    v_accvgpr_read_b32 v20, a88
    v_mul_f32 v20, v20, v19
    v_accvgpr_write_b32 a88, v20
    v_accvgpr_read_b32 v21, a89
    v_mul_f32 v21, v21, v19
    v_accvgpr_write_b32 a89, v21
    v_accvgpr_read_b32 v20, a90
    v_mul_f32 v20, v20, v19
    v_accvgpr_write_b32 a90, v20
    v_accvgpr_read_b32 v21, a91
    v_mul_f32 v21, v21, v19
    v_accvgpr_write_b32 a91, v21
    v_accvgpr_read_b32 v20, a116
    v_mul_f32 v20, v20, v19
    v_accvgpr_write_b32 a116, v20
    v_accvgpr_read_b32 v21, a117
    v_mul_f32 v21, v21, v19
    v_mfma_f32_16x16x32_bf16 v[172:175], v[152:155], v[56:59], 0
    v_accvgpr_write_b32 a117, v21
    v_accvgpr_read_b32 v20, a118
    v_mul_f32 v20, v20, v19
    v_accvgpr_write_b32 a118, v20
    v_accvgpr_read_b32 v21, a119
    v_mul_f32 v21, v21, v19
    v_accvgpr_write_b32 a119, v21
    v_accvgpr_read_b32 v20, a144
    v_mul_f32 v20, v20, v19
    v_accvgpr_write_b32 a144, v20
    v_accvgpr_read_b32 v21, a145
    v_mul_f32 v21, v21, v19
    v_accvgpr_write_b32 a145, v21
    v_accvgpr_read_b32 v20, a146
    v_mul_f32 v20, v20, v19
    v_accvgpr_write_b32 a146, v20
    v_accvgpr_read_b32 v21, a147
    v_mul_f32 v21, v21, v19
    v_mfma_f32_16x16x32_bf16 v[172:175], v[156:159], v[60:63], v[172:175]
    v_accvgpr_write_b32 a147, v21
    v_accvgpr_read_b32 v20, a172
    v_mul_f32 v20, v20, v19
    v_accvgpr_write_b32 a172, v20
    v_accvgpr_read_b32 v21, a173
    v_mul_f32 v21, v21, v19
    v_accvgpr_write_b32 a173, v21
    v_accvgpr_read_b32 v20, a174
    v_mul_f32 v20, v20, v19
    v_accvgpr_write_b32 a174, v20
    v_accvgpr_read_b32 v21, a175
    v_mul_f32 v21, v21, v19
    v_accvgpr_write_b32 a175, v21
    v_accvgpr_read_b32 v20, a200
    v_mul_f32 v20, v20, v19
    v_accvgpr_write_b32 a200, v20
    v_accvgpr_read_b32 v21, a201
    v_mul_f32 v21, v21, v19
    v_mfma_f32_16x16x32_bf16 v[172:175], v[160:163], v[64:67], v[172:175]
    v_accvgpr_write_b32 a201, v21
    v_accvgpr_read_b32 v20, a202
    v_mul_f32 v20, v20, v19
    v_accvgpr_write_b32 a202, v20
    v_accvgpr_read_b32 v21, a203
    v_mul_f32 v21, v21, v19
    v_accvgpr_write_b32 a203, v21
    v_add_f32 v176, v176, v216
    v_add_f32 v177, v177, v216
    v_add_f32 v178, v178, v216
    v_add_f32 v179, v179, v216
    v_add_f32 v180, v180, v216
    v_add_f32 v181, v181, v216
    v_add_f32 v182, v182, v216
    v_add_f32 v183, v183, v216
    v_exp_f32 v176, v176
    v_exp_f32 v177, v177
    v_exp_f32 v178, v178
    v_mfma_f32_16x16x32_bf16 v[172:175], v[164:167], v[68:71], v[172:175]
    v_add_f32 v20, v176, v177
    v_exp_f32 v179, v179
    v_exp_f32 v180, v180
    v_add_f32 v21, v178, v179
    v_exp_f32 v181, v181
    v_add_f32 v20, v20, v21
    v_exp_f32 v182, v182
    v_add_f32 v22, v180, v181
    v_exp_f32 v183, v183
    v_add_f32 v20, v20, v241
    v_cvt_pk_bf16_f32 v188, v176, v177
    v_add_f32 v248, v182, v183
    v_cvt_pk_bf16_f32 v189, v178, v179
    v_add_f32 v248, v248, v22
    v_cvt_pk_bf16_f32 v190, v180, v181
    v_add_f32 v248, v248, v20
    v_cvt_pk_bf16_f32 v191, v182, v183
    v_mfma_f32_16x16x32_bf16 v[176:179], v[136:139], v[72:75], 0
    v_max3_f32 v18, v168, v169, v170
    v_max3_f32 v18, v18, v171, v172
    v_max3_f32 v18, v18, v173, v174
    v_max_f32 v18, v18, v175
    v_mov_b32 v19, v18
    s_nop 1
    v_permlane16_swap_b32 v18, v19
    v_max_f32 v18, v18, v19
    v_mov_b32 v19, v18
    s_nop 1
    v_permlane32_swap_b32 v18, v19
    v_max_f32 v18, v18, v19
    v_sub_f32 v18, 0, v18
    v_min_f32 v18, v18, v220
    v_sub_f32 v19, v18, v220
    v_exp_f32 v19, v19
    v_mov_b32 v220, v18
    v_mov_b32 v221, v18
    v_mov_b32 v222, v18
    v_mov_b32 v223, v18
    v_mfma_f32_16x16x32_bf16 v[176:179], v[140:143], v[76:79], v[176:179]
    v_mul_f32 v242, v242, v19
    v_accvgpr_read_b32 v20, a8
    v_mul_f32 v20, v20, v19
    v_accvgpr_write_b32 a8, v20
    v_accvgpr_read_b32 v21, a9
    v_mul_f32 v21, v21, v19
    v_accvgpr_write_b32 a9, v21
    v_accvgpr_read_b32 v20, a10
    v_mul_f32 v20, v20, v19
    v_accvgpr_write_b32 a10, v20
    v_accvgpr_read_b32 v21, a11
    v_mul_f32 v21, v21, v19
    v_accvgpr_write_b32 a11, v21
    v_accvgpr_read_b32 v20, a36
    v_mul_f32 v20, v20, v19
    v_accvgpr_write_b32 a36, v20
    v_accvgpr_read_b32 v21, a37
    v_mul_f32 v21, v21, v19
    v_mfma_f32_16x16x32_bf16 v[176:179], v[144:147], v[80:83], v[176:179]
    v_accvgpr_write_b32 a37, v21
    v_accvgpr_read_b32 v20, a38
    v_mul_f32 v20, v20, v19
    v_accvgpr_write_b32 a38, v20
    v_accvgpr_read_b32 v21, a39
    v_mul_f32 v21, v21, v19
    v_accvgpr_write_b32 a39, v21
    v_accvgpr_read_b32 v20, a64
    v_mul_f32 v20, v20, v19
    v_accvgpr_write_b32 a64, v20
    v_accvgpr_read_b32 v21, a65
    v_mul_f32 v21, v21, v19
    v_accvgpr_write_b32 a65, v21
    v_accvgpr_read_b32 v20, a66
    v_mul_f32 v20, v20, v19
    v_accvgpr_write_b32 a66, v20
    v_accvgpr_read_b32 v21, a67
    v_mul_f32 v21, v21, v19
    v_mfma_f32_16x16x32_bf16 v[176:179], v[148:151], v[84:87], v[176:179]
    v_accvgpr_write_b32 a67, v21
    v_accvgpr_read_b32 v20, a92
    v_mul_f32 v20, v20, v19
    v_accvgpr_write_b32 a92, v20
    v_accvgpr_read_b32 v21, a93
    v_mul_f32 v21, v21, v19
    v_accvgpr_write_b32 a93, v21
    v_accvgpr_read_b32 v20, a94
    v_mul_f32 v20, v20, v19
    v_accvgpr_write_b32 a94, v20
    v_accvgpr_read_b32 v21, a95
    v_mul_f32 v21, v21, v19
    v_accvgpr_write_b32 a95, v21
    v_accvgpr_read_b32 v20, a120
    v_mul_f32 v20, v20, v19
    v_accvgpr_write_b32 a120, v20
    v_accvgpr_read_b32 v21, a121
    v_mul_f32 v21, v21, v19
    v_mfma_f32_16x16x32_bf16 v[180:183], v[152:155], v[72:75], 0
    v_accvgpr_write_b32 a121, v21
    v_accvgpr_read_b32 v20, a122
    v_mul_f32 v20, v20, v19
    v_accvgpr_write_b32 a122, v20
    v_accvgpr_read_b32 v21, a123
    v_mul_f32 v21, v21, v19
    v_accvgpr_write_b32 a123, v21
    v_accvgpr_read_b32 v20, a148
    v_mul_f32 v20, v20, v19
    v_accvgpr_write_b32 a148, v20
    v_accvgpr_read_b32 v21, a149
    v_mul_f32 v21, v21, v19
    v_accvgpr_write_b32 a149, v21
    v_accvgpr_read_b32 v20, a150
    v_mul_f32 v20, v20, v19
    v_accvgpr_write_b32 a150, v20
    v_accvgpr_read_b32 v21, a151
    v_mul_f32 v21, v21, v19
    v_mfma_f32_16x16x32_bf16 v[180:183], v[156:159], v[76:79], v[180:183]
    v_accvgpr_write_b32 a151, v21
    v_accvgpr_read_b32 v20, a176
    v_mul_f32 v20, v20, v19
    v_accvgpr_write_b32 a176, v20
    v_accvgpr_read_b32 v21, a177
    v_mul_f32 v21, v21, v19
    v_accvgpr_write_b32 a177, v21
    v_accvgpr_read_b32 v20, a178
    v_mul_f32 v20, v20, v19
    v_accvgpr_write_b32 a178, v20
    v_accvgpr_read_b32 v21, a179
    v_mul_f32 v21, v21, v19
    v_accvgpr_write_b32 a179, v21
    v_accvgpr_read_b32 v20, a204
    v_mul_f32 v20, v20, v19
    v_accvgpr_write_b32 a204, v20
    v_accvgpr_read_b32 v21, a205
    v_mul_f32 v21, v21, v19
    v_mfma_f32_16x16x32_bf16 v[180:183], v[160:163], v[80:83], v[180:183]
    v_accvgpr_write_b32 a205, v21
    v_accvgpr_read_b32 v20, a206
    v_mul_f32 v20, v20, v19
    v_accvgpr_write_b32 a206, v20
    v_accvgpr_read_b32 v21, a207
    v_mul_f32 v21, v21, v19
    v_accvgpr_write_b32 a207, v21
    v_add_f32 v168, v168, v220
    v_add_f32 v169, v169, v220
    v_add_f32 v170, v170, v220
    v_add_f32 v171, v171, v220
    v_add_f32 v172, v172, v220
    v_add_f32 v173, v173, v220
    v_add_f32 v174, v174, v220
    v_add_f32 v175, v175, v220
    v_exp_f32 v168, v168
    v_exp_f32 v169, v169
    v_exp_f32 v170, v170
    v_mfma_f32_16x16x32_bf16 v[180:183], v[164:167], v[84:87], v[180:183]
    v_add_f32 v20, v168, v169
    v_exp_f32 v171, v171
    v_exp_f32 v172, v172
    v_add_f32 v21, v170, v171
    v_exp_f32 v173, v173
    v_add_f32 v20, v20, v21
    v_exp_f32 v174, v174
    v_add_f32 v22, v172, v173
    v_exp_f32 v175, v175
    v_add_f32 v20, v20, v242
    v_cvt_pk_bf16_f32 v192, v168, v169
    v_add_f32 v249, v174, v175
    v_cvt_pk_bf16_f32 v193, v170, v171
    v_add_f32 v249, v249, v22
    v_cvt_pk_bf16_f32 v194, v172, v173
    v_add_f32 v249, v249, v20
    v_cvt_pk_bf16_f32 v195, v174, v175
    v_mfma_f32_16x16x32_bf16 v[168:171], v[136:139], v[88:91], 0
    v_max3_f32 v18, v176, v177, v178
    v_max3_f32 v18, v18, v179, v180
    v_max3_f32 v18, v18, v181, v182
    v_max_f32 v18, v18, v183
    v_mov_b32 v19, v18
    s_nop 1
    v_permlane16_swap_b32 v18, v19
    v_max_f32 v18, v18, v19
    v_mov_b32 v19, v18
    s_nop 1
    v_permlane32_swap_b32 v18, v19
    v_max_f32 v18, v18, v19
    v_sub_f32 v18, 0, v18
    v_min_f32 v18, v18, v224
    v_sub_f32 v19, v18, v224
    v_exp_f32 v19, v19
    v_mov_b32 v224, v18
    v_mov_b32 v225, v18
    v_mov_b32 v226, v18
    v_mov_b32 v227, v18
    v_mfma_f32_16x16x32_bf16 v[168:171], v[140:143], v[92:95], v[168:171]
    v_mul_f32 v243, v243, v19
    v_accvgpr_read_b32 v20, a12
    v_mul_f32 v20, v20, v19
    v_accvgpr_write_b32 a12, v20
    v_accvgpr_read_b32 v21, a13
    v_mul_f32 v21, v21, v19
    v_accvgpr_write_b32 a13, v21
    v_accvgpr_read_b32 v20, a14
    v_mul_f32 v20, v20, v19
    v_accvgpr_write_b32 a14, v20
    v_accvgpr_read_b32 v21, a15
    v_mul_f32 v21, v21, v19
    v_accvgpr_write_b32 a15, v21
    v_accvgpr_read_b32 v20, a40
    v_mul_f32 v20, v20, v19
    v_accvgpr_write_b32 a40, v20
    v_accvgpr_read_b32 v21, a41
    v_mul_f32 v21, v21, v19
    v_mfma_f32_16x16x32_bf16 v[168:171], v[144:147], v[96:99], v[168:171]
    v_accvgpr_write_b32 a41, v21
    v_accvgpr_read_b32 v20, a42
    v_mul_f32 v20, v20, v19
    v_accvgpr_write_b32 a42, v20
    v_accvgpr_read_b32 v21, a43
    v_mul_f32 v21, v21, v19
    v_accvgpr_write_b32 a43, v21
    v_accvgpr_read_b32 v20, a68
    v_mul_f32 v20, v20, v19
    v_accvgpr_write_b32 a68, v20
    v_accvgpr_read_b32 v21, a69
    v_mul_f32 v21, v21, v19
    v_accvgpr_write_b32 a69, v21
    v_accvgpr_read_b32 v20, a70
    v_mul_f32 v20, v20, v19
    v_accvgpr_write_b32 a70, v20
    v_accvgpr_read_b32 v21, a71
    v_mul_f32 v21, v21, v19
    v_mfma_f32_16x16x32_bf16 v[168:171], v[148:151], v[100:103], v[168:171]
    v_accvgpr_write_b32 a71, v21
    v_accvgpr_read_b32 v20, a96
    v_mul_f32 v20, v20, v19
    v_accvgpr_write_b32 a96, v20
    v_accvgpr_read_b32 v21, a97
    v_mul_f32 v21, v21, v19
    v_accvgpr_write_b32 a97, v21
    v_accvgpr_read_b32 v20, a98
    v_mul_f32 v20, v20, v19
    v_accvgpr_write_b32 a98, v20
    v_accvgpr_read_b32 v21, a99
    v_mul_f32 v21, v21, v19
    v_accvgpr_write_b32 a99, v21
    v_accvgpr_read_b32 v20, a124
    v_mul_f32 v20, v20, v19
    v_accvgpr_write_b32 a124, v20
    v_accvgpr_read_b32 v21, a125
    v_mul_f32 v21, v21, v19
    v_mfma_f32_16x16x32_bf16 v[172:175], v[152:155], v[88:91], 0
    v_accvgpr_write_b32 a125, v21
    v_accvgpr_read_b32 v20, a126
    v_mul_f32 v20, v20, v19
    v_accvgpr_write_b32 a126, v20
    v_accvgpr_read_b32 v21, a127
    v_mul_f32 v21, v21, v19
    v_accvgpr_write_b32 a127, v21
    v_accvgpr_read_b32 v20, a152
    v_mul_f32 v20, v20, v19
    v_accvgpr_write_b32 a152, v20
    v_accvgpr_read_b32 v21, a153
    v_mul_f32 v21, v21, v19
    v_accvgpr_write_b32 a153, v21
    v_accvgpr_read_b32 v20, a154
    v_mul_f32 v20, v20, v19
    v_accvgpr_write_b32 a154, v20
    v_accvgpr_read_b32 v21, a155
    v_mul_f32 v21, v21, v19
    v_mfma_f32_16x16x32_bf16 v[172:175], v[156:159], v[92:95], v[172:175]
    v_accvgpr_write_b32 a155, v21
    v_accvgpr_read_b32 v20, a180
    v_mul_f32 v20, v20, v19
    v_accvgpr_write_b32 a180, v20
    v_accvgpr_read_b32 v21, a181
    v_mul_f32 v21, v21, v19
    v_accvgpr_write_b32 a181, v21
    v_accvgpr_read_b32 v20, a182
    v_mul_f32 v20, v20, v19
    v_accvgpr_write_b32 a182, v20
    v_accvgpr_read_b32 v21, a183
    v_mul_f32 v21, v21, v19
    v_accvgpr_write_b32 a183, v21
    v_accvgpr_read_b32 v20, a208
    v_mul_f32 v20, v20, v19
    v_accvgpr_write_b32 a208, v20
    v_accvgpr_read_b32 v21, a209
    v_mul_f32 v21, v21, v19
    v_mfma_f32_16x16x32_bf16 v[172:175], v[160:163], v[96:99], v[172:175]
    v_accvgpr_write_b32 a209, v21
    v_accvgpr_read_b32 v20, a210
    v_mul_f32 v20, v20, v19
    v_accvgpr_write_b32 a210, v20
    v_accvgpr_read_b32 v21, a211
    v_mul_f32 v21, v21, v19
    v_accvgpr_write_b32 a211, v21
    v_add_f32 v176, v176, v224
    v_add_f32 v177, v177, v224
    v_add_f32 v178, v178, v224
    v_add_f32 v179, v179, v224
    v_add_f32 v180, v180, v224
    v_add_f32 v181, v181, v224
    v_add_f32 v182, v182, v224
    v_add_f32 v183, v183, v224
    v_exp_f32 v176, v176
    v_exp_f32 v177, v177
    v_exp_f32 v178, v178
    v_mfma_f32_16x16x32_bf16 v[172:175], v[164:167], v[100:103], v[172:175]
    v_add_f32 v20, v176, v177
    v_exp_f32 v179, v179
    v_exp_f32 v180, v180
    v_add_f32 v21, v178, v179
    v_exp_f32 v181, v181
    v_add_f32 v20, v20, v21
    v_exp_f32 v182, v182
    v_add_f32 v22, v180, v181
    v_exp_f32 v183, v183
    v_add_f32 v20, v20, v243
    v_cvt_pk_bf16_f32 v196, v176, v177
    v_add_f32 v250, v182, v183
    v_cvt_pk_bf16_f32 v197, v178, v179
    v_add_f32 v250, v250, v22
    v_cvt_pk_bf16_f32 v198, v180, v181
    v_add_f32 v250, v250, v20
    v_cvt_pk_bf16_f32 v199, v182, v183
    v_mfma_f32_16x16x32_bf16 v[176:179], v[136:139], v[104:107], 0
    v_max3_f32 v18, v168, v169, v170
    v_max3_f32 v18, v18, v171, v172
    v_max3_f32 v18, v18, v173, v174
    v_max_f32 v18, v18, v175
    v_mov_b32 v19, v18
    s_nop 1
    v_permlane16_swap_b32 v18, v19
    v_max_f32 v18, v18, v19
    v_mov_b32 v19, v18
    s_nop 1
    v_permlane32_swap_b32 v18, v19
    v_max_f32 v18, v18, v19
    v_sub_f32 v18, 0, v18
    v_min_f32 v18, v18, v228
    v_sub_f32 v19, v18, v228
    v_exp_f32 v19, v19
    v_mov_b32 v228, v18
    v_mov_b32 v229, v18
    v_mov_b32 v230, v18
    v_mov_b32 v231, v18
    v_mfma_f32_16x16x32_bf16 v[176:179], v[140:143], v[108:111], v[176:179]
    v_mul_f32 v244, v244, v19
    v_accvgpr_read_b32 v20, a16
    v_mul_f32 v20, v20, v19
    v_accvgpr_write_b32 a16, v20
    v_accvgpr_read_b32 v21, a17
    v_mul_f32 v21, v21, v19
    v_accvgpr_write_b32 a17, v21
    v_accvgpr_read_b32 v20, a18
    v_mul_f32 v20, v20, v19
    v_accvgpr_write_b32 a18, v20
    v_accvgpr_read_b32 v21, a19
    v_mul_f32 v21, v21, v19
    v_accvgpr_write_b32 a19, v21
    v_accvgpr_read_b32 v20, a44
    v_mul_f32 v20, v20, v19
    v_accvgpr_write_b32 a44, v20
    v_accvgpr_read_b32 v21, a45
    v_mul_f32 v21, v21, v19
    v_mfma_f32_16x16x32_bf16 v[176:179], v[144:147], v[112:115], v[176:179]
    v_accvgpr_write_b32 a45, v21
    v_accvgpr_read_b32 v20, a46
    v_mul_f32 v20, v20, v19
    v_accvgpr_write_b32 a46, v20
    v_accvgpr_read_b32 v21, a47
    v_mul_f32 v21, v21, v19
    v_accvgpr_write_b32 a47, v21
    v_accvgpr_read_b32 v20, a72
    v_mul_f32 v20, v20, v19
    v_accvgpr_write_b32 a72, v20
    v_accvgpr_read_b32 v21, a73
    v_mul_f32 v21, v21, v19
    v_accvgpr_write_b32 a73, v21
    v_accvgpr_read_b32 v20, a74
    v_mul_f32 v20, v20, v19
    v_accvgpr_write_b32 a74, v20
    v_accvgpr_read_b32 v21, a75
    v_mul_f32 v21, v21, v19
    v_mfma_f32_16x16x32_bf16 v[176:179], v[148:151], v[116:119], v[176:179]
    v_accvgpr_write_b32 a75, v21
    v_accvgpr_read_b32 v20, a100
    v_mul_f32 v20, v20, v19
    v_accvgpr_write_b32 a100, v20
    v_accvgpr_read_b32 v21, a101
    v_mul_f32 v21, v21, v19
    v_accvgpr_write_b32 a101, v21
    v_accvgpr_read_b32 v20, a102
    v_mul_f32 v20, v20, v19
    v_accvgpr_write_b32 a102, v20
    v_accvgpr_read_b32 v21, a103
    v_mul_f32 v21, v21, v19
    v_accvgpr_write_b32 a103, v21
    v_accvgpr_read_b32 v20, a128
    v_mul_f32 v20, v20, v19
    v_accvgpr_write_b32 a128, v20
    v_accvgpr_read_b32 v21, a129
    v_mul_f32 v21, v21, v19
    v_mfma_f32_16x16x32_bf16 v[180:183], v[152:155], v[104:107], 0
    v_accvgpr_write_b32 a129, v21
    v_accvgpr_read_b32 v20, a130
    v_mul_f32 v20, v20, v19
    v_accvgpr_write_b32 a130, v20
    v_accvgpr_read_b32 v21, a131
    v_mul_f32 v21, v21, v19
    v_accvgpr_write_b32 a131, v21
    v_accvgpr_read_b32 v20, a156
    v_mul_f32 v20, v20, v19
    v_accvgpr_write_b32 a156, v20
    v_accvgpr_read_b32 v21, a157
    v_mul_f32 v21, v21, v19
    v_accvgpr_write_b32 a157, v21
    v_accvgpr_read_b32 v20, a158
    v_mul_f32 v20, v20, v19
    v_accvgpr_write_b32 a158, v20
    v_accvgpr_read_b32 v21, a159
    v_mul_f32 v21, v21, v19
    v_mfma_f32_16x16x32_bf16 v[180:183], v[156:159], v[108:111], v[180:183]
    v_accvgpr_write_b32 a159, v21
    v_accvgpr_read_b32 v20, a184
    v_mul_f32 v20, v20, v19
    v_accvgpr_write_b32 a184, v20
    v_accvgpr_read_b32 v21, a185
    v_mul_f32 v21, v21, v19
    v_accvgpr_write_b32 a185, v21
    v_accvgpr_read_b32 v20, a186
    v_mul_f32 v20, v20, v19
    v_accvgpr_write_b32 a186, v20
    v_accvgpr_read_b32 v21, a187
    v_mul_f32 v21, v21, v19
    v_accvgpr_write_b32 a187, v21
    v_accvgpr_read_b32 v20, a212
    v_mul_f32 v20, v20, v19
    v_accvgpr_write_b32 a212, v20
    v_accvgpr_read_b32 v21, a213
    v_mul_f32 v21, v21, v19
    v_mfma_f32_16x16x32_bf16 v[180:183], v[160:163], v[112:115], v[180:183]
    v_accvgpr_write_b32 a213, v21
    v_accvgpr_read_b32 v20, a214
    v_mul_f32 v20, v20, v19
    v_accvgpr_write_b32 a214, v20
    v_accvgpr_read_b32 v21, a215
    v_mul_f32 v21, v21, v19
    v_accvgpr_write_b32 a215, v21
    v_add_f32 v168, v168, v228
    v_add_f32 v169, v169, v228
    v_add_f32 v170, v170, v228
    v_add_f32 v171, v171, v228
    v_add_f32 v172, v172, v228
    v_add_f32 v173, v173, v228
    v_add_f32 v174, v174, v228
    v_add_f32 v175, v175, v228
    v_exp_f32 v168, v168
    v_exp_f32 v169, v169
    v_exp_f32 v170, v170
    v_mfma_f32_16x16x32_bf16 v[180:183], v[164:167], v[116:119], v[180:183]
    v_add_f32 v20, v168, v169
    v_exp_f32 v171, v171
    v_exp_f32 v172, v172
    v_add_f32 v21, v170, v171
    v_exp_f32 v173, v173
    v_add_f32 v20, v20, v21
    v_exp_f32 v174, v174
    v_add_f32 v22, v172, v173
    v_exp_f32 v175, v175
    v_add_f32 v20, v20, v244
    v_cvt_pk_bf16_f32 v200, v168, v169
    v_add_f32 v251, v174, v175
    v_cvt_pk_bf16_f32 v201, v170, v171
    v_add_f32 v251, v251, v22
    v_cvt_pk_bf16_f32 v202, v172, v173
    v_add_f32 v251, v251, v20
    v_cvt_pk_bf16_f32 v203, v174, v175
    v_mfma_f32_16x16x32_bf16 v[168:171], v[136:139], v[120:123], 0
    v_max3_f32 v18, v176, v177, v178
    v_max3_f32 v18, v18, v179, v180
    v_max3_f32 v18, v18, v181, v182
    v_max_f32 v18, v18, v183
    v_mov_b32 v19, v18
    s_nop 1
    v_permlane16_swap_b32 v18, v19
    v_max_f32 v18, v18, v19
    v_mov_b32 v19, v18
    s_nop 1
    v_permlane32_swap_b32 v18, v19
    v_max_f32 v18, v18, v19
    v_sub_f32 v18, 0, v18
    v_min_f32 v18, v18, v232
    v_sub_f32 v19, v18, v232
    v_exp_f32 v19, v19
    v_mov_b32 v232, v18
    v_mov_b32 v233, v18
    v_mov_b32 v234, v18
    v_mov_b32 v235, v18
    v_mfma_f32_16x16x32_bf16 v[168:171], v[140:143], v[124:127], v[168:171]
    v_mul_f32 v245, v245, v19
    v_accvgpr_read_b32 v20, a20
    v_mul_f32 v20, v20, v19
    v_accvgpr_write_b32 a20, v20
    v_accvgpr_read_b32 v21, a21
    v_mul_f32 v21, v21, v19
    v_accvgpr_write_b32 a21, v21
    v_accvgpr_read_b32 v20, a22
    v_mul_f32 v20, v20, v19
    v_accvgpr_write_b32 a22, v20
    v_accvgpr_read_b32 v21, a23
    v_mul_f32 v21, v21, v19
    v_accvgpr_write_b32 a23, v21
    v_accvgpr_read_b32 v20, a48
    v_mul_f32 v20, v20, v19
    v_accvgpr_write_b32 a48, v20
    v_accvgpr_read_b32 v21, a49
    v_mul_f32 v21, v21, v19
    v_mfma_f32_16x16x32_bf16 v[168:171], v[144:147], v[128:131], v[168:171]
    v_accvgpr_write_b32 a49, v21
    v_accvgpr_read_b32 v20, a50
    v_mul_f32 v20, v20, v19
    v_accvgpr_write_b32 a50, v20
    v_accvgpr_read_b32 v21, a51
    v_mul_f32 v21, v21, v19
    v_accvgpr_write_b32 a51, v21
    v_accvgpr_read_b32 v20, a76
    v_mul_f32 v20, v20, v19
    v_accvgpr_write_b32 a76, v20
    v_accvgpr_read_b32 v21, a77
    v_mul_f32 v21, v21, v19
    v_accvgpr_write_b32 a77, v21
    v_accvgpr_read_b32 v20, a78
    v_mul_f32 v20, v20, v19
    v_accvgpr_write_b32 a78, v20
    v_accvgpr_read_b32 v21, a79
    v_mul_f32 v21, v21, v19
    v_mfma_f32_16x16x32_bf16 v[168:171], v[148:151], v[132:135], v[168:171]
    v_accvgpr_write_b32 a79, v21
    v_accvgpr_read_b32 v20, a104
    v_mul_f32 v20, v20, v19
    v_accvgpr_write_b32 a104, v20
    v_accvgpr_read_b32 v21, a105
    v_mul_f32 v21, v21, v19
    v_accvgpr_write_b32 a105, v21
    v_accvgpr_read_b32 v20, a106
    v_mul_f32 v20, v20, v19
    v_accvgpr_write_b32 a106, v20
    v_accvgpr_read_b32 v21, a107
    v_mul_f32 v21, v21, v19
    v_accvgpr_write_b32 a107, v21
    v_accvgpr_read_b32 v20, a132
    v_mul_f32 v20, v20, v19
    v_accvgpr_write_b32 a132, v20
    v_accvgpr_read_b32 v21, a133
    v_mul_f32 v21, v21, v19
    v_mfma_f32_16x16x32_bf16 v[172:175], v[152:155], v[120:123], 0
    v_accvgpr_write_b32 a133, v21
    v_accvgpr_read_b32 v20, a134
    v_mul_f32 v20, v20, v19
    v_accvgpr_write_b32 a134, v20
    v_accvgpr_read_b32 v21, a135
    v_mul_f32 v21, v21, v19
    v_accvgpr_write_b32 a135, v21
    v_accvgpr_read_b32 v20, a160
    v_mul_f32 v20, v20, v19
    v_accvgpr_write_b32 a160, v20
    v_accvgpr_read_b32 v21, a161
    v_mul_f32 v21, v21, v19
    v_accvgpr_write_b32 a161, v21
    v_accvgpr_read_b32 v20, a162
    v_mul_f32 v20, v20, v19
    v_accvgpr_write_b32 a162, v20
    v_accvgpr_read_b32 v21, a163
    v_mul_f32 v21, v21, v19
    v_mfma_f32_16x16x32_bf16 v[172:175], v[156:159], v[124:127], v[172:175]
    v_accvgpr_write_b32 a163, v21
    v_accvgpr_read_b32 v20, a188
    v_mul_f32 v20, v20, v19
    v_accvgpr_write_b32 a188, v20
    v_accvgpr_read_b32 v21, a189
    v_mul_f32 v21, v21, v19
    v_accvgpr_write_b32 a189, v21
    v_accvgpr_read_b32 v20, a190
    v_mul_f32 v20, v20, v19
    v_accvgpr_write_b32 a190, v20
    v_accvgpr_read_b32 v21, a191
    v_mul_f32 v21, v21, v19
    v_accvgpr_write_b32 a191, v21
    v_accvgpr_read_b32 v20, a216
    v_mul_f32 v20, v20, v19
    v_accvgpr_write_b32 a216, v20
    v_accvgpr_read_b32 v21, a217
    v_mul_f32 v21, v21, v19
    v_mfma_f32_16x16x32_bf16 v[172:175], v[160:163], v[128:131], v[172:175]
    v_accvgpr_write_b32 a217, v21
    v_accvgpr_read_b32 v20, a218
    v_mul_f32 v20, v20, v19
    v_accvgpr_write_b32 a218, v20
    v_accvgpr_read_b32 v21, a219
    v_mul_f32 v21, v21, v19
    v_accvgpr_write_b32 a219, v21
    v_add_f32 v176, v176, v232
    v_add_f32 v177, v177, v232
    v_add_f32 v178, v178, v232
    v_add_f32 v179, v179, v232
    v_add_f32 v180, v180, v232
    v_add_f32 v181, v181, v232
    v_add_f32 v182, v182, v232
    v_add_f32 v183, v183, v232
    v_exp_f32 v176, v176
    v_exp_f32 v177, v177
    v_exp_f32 v178, v178
    v_mfma_f32_16x16x32_bf16 v[172:175], v[164:167], v[132:135], v[172:175]
    v_add_f32 v20, v176, v177
    v_exp_f32 v179, v179
    v_exp_f32 v180, v180
    v_add_f32 v21, v178, v179
    v_exp_f32 v181, v181
    v_add_f32 v20, v20, v21
    v_exp_f32 v182, v182
    v_add_f32 v22, v180, v181
    v_exp_f32 v183, v183
    v_add_f32 v20, v20, v245
    v_cvt_pk_bf16_f32 v204, v176, v177
    v_add_f32 v252, v182, v183
    v_cvt_pk_bf16_f32 v205, v178, v179
    v_add_f32 v252, v252, v22
    v_cvt_pk_bf16_f32 v206, v180, v181
    v_add_f32 v252, v252, v20
    v_cvt_pk_bf16_f32 v207, v182, v183
    v_max3_f32 v18, v168, v169, v170
    v_max3_f32 v18, v18, v171, v172
    v_max3_f32 v18, v18, v173, v174
    v_max_f32 v18, v18, v175
    v_mov_b32 v19, v18
    s_nop 1
    v_permlane16_swap_b32 v18, v19
    v_max_f32 v18, v18, v19
    v_mov_b32 v19, v18
    s_nop 1
    v_permlane32_swap_b32 v18, v19
    v_max_f32 v18, v18, v19
    v_sub_f32 v18, 0, v18
    v_min_f32 v18, v18, v236
    v_sub_f32 v19, v18, v236
    v_exp_f32 v19, v19
    v_mov_b32 v236, v18
    v_mov_b32 v237, v18
    v_mov_b32 v238, v18
    v_mov_b32 v239, v18
    v_mul_f32 v246, v246, v19
    v_accvgpr_read_b32 v20, a24
    v_mul_f32 v20, v20, v19
    v_accvgpr_write_b32 a24, v20
    v_accvgpr_read_b32 v21, a25
    v_mul_f32 v21, v21, v19
    v_accvgpr_write_b32 a25, v21
    v_accvgpr_read_b32 v20, a26
    v_mul_f32 v20, v20, v19
    v_accvgpr_write_b32 a26, v20
    v_accvgpr_read_b32 v21, a27
    v_mul_f32 v21, v21, v19
    v_accvgpr_write_b32 a27, v21
    v_accvgpr_read_b32 v20, a52
    v_mul_f32 v20, v20, v19
    v_accvgpr_write_b32 a52, v20
    v_accvgpr_read_b32 v21, a53
    v_mul_f32 v21, v21, v19
    v_accvgpr_write_b32 a53, v21
    v_accvgpr_read_b32 v20, a54
    v_mul_f32 v20, v20, v19
    v_accvgpr_write_b32 a54, v20
    v_accvgpr_read_b32 v21, a55
    v_mul_f32 v21, v21, v19
    v_accvgpr_write_b32 a55, v21
    v_accvgpr_read_b32 v20, a80
    v_mul_f32 v20, v20, v19
    v_accvgpr_write_b32 a80, v20
    v_accvgpr_read_b32 v21, a81
    v_mul_f32 v21, v21, v19
    v_accvgpr_write_b32 a81, v21
    v_accvgpr_read_b32 v20, a82
    v_mul_f32 v20, v20, v19
    v_accvgpr_write_b32 a82, v20
    v_accvgpr_read_b32 v21, a83
    v_mul_f32 v21, v21, v19
    v_accvgpr_write_b32 a83, v21
    v_accvgpr_read_b32 v20, a108
    v_mul_f32 v20, v20, v19
    v_accvgpr_write_b32 a108, v20
    v_accvgpr_read_b32 v21, a109
    v_mul_f32 v21, v21, v19
    v_accvgpr_write_b32 a109, v21
    v_accvgpr_read_b32 v20, a110
    v_mul_f32 v20, v20, v19
    v_accvgpr_write_b32 a110, v20
    v_accvgpr_read_b32 v21, a111
    v_mul_f32 v21, v21, v19
    v_accvgpr_write_b32 a111, v21
    v_accvgpr_read_b32 v20, a136
    v_mul_f32 v20, v20, v19
    v_accvgpr_write_b32 a136, v20
    v_accvgpr_read_b32 v21, a137
    v_mul_f32 v21, v21, v19
    v_accvgpr_write_b32 a137, v21
    v_accvgpr_read_b32 v20, a138
    v_mul_f32 v20, v20, v19
    v_accvgpr_write_b32 a138, v20
    v_accvgpr_read_b32 v21, a139
    v_mul_f32 v21, v21, v19
    v_accvgpr_write_b32 a139, v21
    v_accvgpr_read_b32 v20, a164
    v_mul_f32 v20, v20, v19
    v_accvgpr_write_b32 a164, v20
    v_accvgpr_read_b32 v21, a165
    v_mul_f32 v21, v21, v19
    v_accvgpr_write_b32 a165, v21
    v_accvgpr_read_b32 v20, a166
    v_mul_f32 v20, v20, v19
    v_accvgpr_write_b32 a166, v20
    v_accvgpr_read_b32 v21, a167
    v_mul_f32 v21, v21, v19
    v_accvgpr_write_b32 a167, v21
    v_accvgpr_read_b32 v20, a192
    v_mul_f32 v20, v20, v19
    v_accvgpr_write_b32 a192, v20
    v_accvgpr_read_b32 v21, a193
    v_mul_f32 v21, v21, v19
    v_accvgpr_write_b32 a193, v21
    v_accvgpr_read_b32 v20, a194
    v_mul_f32 v20, v20, v19
    v_accvgpr_write_b32 a194, v20
    v_accvgpr_read_b32 v21, a195
    v_mul_f32 v21, v21, v19
    v_accvgpr_write_b32 a195, v21
    v_accvgpr_read_b32 v20, a220
    v_mul_f32 v20, v20, v19
    v_accvgpr_write_b32 a220, v20
    v_accvgpr_read_b32 v21, a221
    v_mul_f32 v21, v21, v19
    v_accvgpr_write_b32 a221, v21
    v_accvgpr_read_b32 v20, a222
    v_mul_f32 v20, v20, v19
    v_accvgpr_write_b32 a222, v20
    v_accvgpr_read_b32 v21, a223
    v_mul_f32 v21, v21, v19
    v_accvgpr_write_b32 a223, v21
    v_add_f32 v168, v168, v236
    v_add_f32 v169, v169, v236
    v_add_f32 v170, v170, v236
    v_add_f32 v171, v171, v236
    v_add_f32 v172, v172, v236
    v_add_f32 v173, v173, v236
    v_add_f32 v174, v174, v236
    v_add_f32 v175, v175, v236
    v_exp_f32 v168, v168
    v_exp_f32 v169, v169
    v_exp_f32 v170, v170
    v_add_f32 v20, v168, v169
    v_exp_f32 v171, v171
    v_exp_f32 v172, v172
    v_add_f32 v21, v170, v171
    v_exp_f32 v173, v173
    v_add_f32 v20, v20, v21
    v_exp_f32 v174, v174
    v_add_f32 v22, v172, v173
    v_exp_f32 v175, v175
    v_add_f32 v20, v20, v246
    v_cvt_pk_bf16_f32 v208, v168, v169
    v_add_f32 v253, v174, v175
    v_cvt_pk_bf16_f32 v209, v170, v171
    v_add_f32 v253, v253, v22
    v_cvt_pk_bf16_f32 v210, v172, v173
    v_add_f32 v253, v253, v20
    v_cvt_pk_bf16_f32 v211, v174, v175
    s_nop 3
    s_cmp_eq_u32 s50, 1
    s_cbranch_scc1 L_slowO_ret
    s_cmp_eq_u32 s50, 2
    s_cbranch_scc1 L_slowP_ret
    v_swap_b32 v240, v247
    v_swap_b32 v241, v248
    v_swap_b32 v242, v249
    v_swap_b32 v243, v250
    v_swap_b32 v244, v251
    v_swap_b32 v245, v252
    v_swap_b32 v246, v253
    s_nop 1
    s_branch L_slowE_ret
.section .rodata,"a"
.p2align 6
.amdhsa_kernel standalone__gqa_block_cached__near_ridge_kernel
  .amdhsa_next_free_vgpr 512
  .amdhsa_next_free_sgpr 102
  .amdhsa_accum_offset 256
  .amdhsa_group_segment_fixed_size 0
  .amdhsa_kernarg_size 64
  .amdhsa_user_sgpr_count 2
  .amdhsa_user_sgpr_kernarg_segment_ptr 1
  .amdhsa_system_sgpr_workgroup_id_x 1
.end_amdhsa_kernel
```
